```python
import torch

def _softmax(x, axis=-1):
    return torch.softmax(x, dim=axis)
def _gelu(x):
    return torch.nn.functional.gelu(x, approximate="tanh")
def _silu(x):
    return torch.nn.functional.silu(x)
def _sigmoid(x):
    return torch.sigmoid(x)
def _layernorm(x, axis=-1, eps=1e-5):
    m = x.mean(dim=axis, keepdim=True)
    v = x.var(dim=axis, keepdim=True, unbiased=False)
    return (x - m) / torch.sqrt(v + eps)
def _scatter_add(tgt, idx, src, axis=0):
    return tgt.clone().index_add_(axis, idx, src)
def _segment_sum(src, seg, n):
    out = torch.zeros((n,) + src.shape[1:], dtype=src.dtype)
    return out.index_add_(0, seg, src)
def _pad(x, pw):
    flat = tuple(v for pair in reversed(pw) for v in pair)
    return torch.nn.functional.pad(x, flat)

kernel_name = 'gated_mix__linear_kernel_hedgehog__glu_gated_swiglu__prompt'

def setup_inputs():

    _w = (lambda a: (lambda t: t.to(torch.bfloat16) if t.is_floating_point() else t)(torch.as_tensor(a)))
    def _A_setup():
        B, S, D, H = 1, 2048, 448, 16
        Dh = D // H
        return {
            "x": _w((lambda *s: torch.randn(*s, dtype=torch.bfloat16) * 0.05)(B, S, D)),
            "wqkv": _w((lambda *s: torch.randn(*s, dtype=torch.bfloat16) * 0.8)(D, 3 * D)),
            "w_phi": _w((lambda *s: torch.randn(*s, dtype=torch.bfloat16) * 0.8)(H, Dh, Dh) * (Dh ** -0.5)),
            "wo": _w((lambda *s: torch.randn(*s, dtype=torch.bfloat16) * 0.05)(D, D)),
        }
    _A_in = _A_setup()

    def _B_setup():
        B, S, D, F = 1, 2048, 448, 1792
        return {
            "x": _w((lambda *s: torch.randn(*s, dtype=torch.bfloat16) * 0.05)(B, S, D)),
            "w1": _w((lambda *s: torch.randn(*s, dtype=torch.bfloat16) * 1.6)(D, F) * (2.0 / D) ** 0.5),
            "w3": _w((lambda *s: torch.randn(*s, dtype=torch.bfloat16) * 1.6)(D, F) * (2.0 / D) ** 0.5),
            "w2": _w((lambda *s: torch.randn(*s, dtype=torch.bfloat16) * 1.6)(F, D) * (2.0 / F) ** 0.5),
        }
    _B_in = _B_setup()

    return {
        "A_x": _A_in["x"],
        "A_wqkv": _A_in["wqkv"],
        "A_w_phi": _A_in["w_phi"],
        "A_wo": _A_in["wo"],
        "B_x": _B_in["x"],
        "B_w1": _B_in["w1"],
        "B_w3": _B_in["w3"],
        "B_w2": _B_in["w2"],
        "gate_w": _w((lambda *s: torch.randn(*s, dtype=torch.bfloat16) * 0.05)(448) * 16.0),
    }

def reference(A_x, A_wqkv, A_w_phi, A_wo, B_x, B_w1, B_w3, B_w2, gate_w):
    def _A_ref(x, wqkv, w_phi, wo):
        B, S, D = x.shape
        H = 16; Dh = D // H
        qkv = (lambda x, *d: x.permute(*d))((x @ wqkv).reshape(B, S, 3, H, Dh), 2, 0, 3, 1, 4)
        q, k, v = qkv[0], qkv[1], qkv[2]
        pq = torch.einsum("bhsd,hdf->bhsf", q, w_phi)
        pk = torch.einsum("bhsd,hdf->bhsf", k, w_phi)
        phi_q = torch.concatenate([_softmax(pq, axis=-1), _softmax(-pq, axis=-1)], axis=-1)
        phi_k = torch.concatenate([_softmax(pk, axis=-1), _softmax(-pk, axis=-1)], axis=-1)
        kv = torch.einsum("bhsf,bhsd->bhfd", phi_k, v)
        z  = torch.einsum("bhsf->bhf", phi_k)
        num = torch.einsum("bhqf,bhfd->bhqd", phi_q, kv)
        den = torch.einsum("bhqf,bhf->bhq", phi_q, z)[..., None] + 1e-6
        o = num / den
        return (lambda x, *d: x.permute(*d))(o, 0, 2, 1, 3).reshape(B, S, D) @ wo

    def _B_ref(x, w1, w3, w2):
        gate = torch.einsum("bsd,df->bsf", x, w1)
        up = torch.einsum("bsd,df->bsf", x, w3)
        h = _silu(gate) * up
        out = torch.einsum("bsf,fd->bsd", h, w2)
        return out

    x = A_x
    g = _sigmoid((x * gate_w).sum(-1, keepdims=True))
    a = _A_ref(x, A_wqkv, A_w_phi, A_wo)
    b = _B_ref(x, B_w1, B_w3, B_w2)
    return g * a + (1 - g) * b
```

```asm
; @launch grid=(256,1,1) block=(512,1,1) lds=163840
.amdgcn_target "amdgcn-amd-amdhsa--gfx950"
.text
.globl gated_mix__linear_kernel_hedgehog__glu_gated_swiglu__prompt_kernel
.p2align 8
.type gated_mix__linear_kernel_hedgehog__glu_gated_swiglu__prompt_kernel,@function
gated_mix__linear_kernel_hedgehog__glu_gated_swiglu__prompt_kernel:
L_code_begin:
    s_cmp_ge_u32 s2, 256
    s_cbranch_scc1 L_exit
    s_load_dwordx16 s[36:51], s[0:1], 0
    s_load_dwordx8 s[52:59], s[0:1], 64
    s_memrealtime s[60:61]
    s_getpc_b64 s[84:85]
L_pf_E:
    s_sub_u32 s84, s84, L_pf_E-L_code_begin
    s_subb_u32 s85, s85, 0
    s_lshr_b32 s79, s2, 3
    s_lshl_b32 s79, s79, 11
    v_lshl_add_u32 v36, v0, 2, s79
    v_min_u32 v36, L_code_end-L_code_begin-4, v36
    global_load_dword v36, v36, s[84:85]
    v_lshrrev_b32 v12, 6, v0
    v_and_b32 v13, 63, v0
    v_readfirstlane_b32 s72, v12
    v_lshlrev_b32 v0, 4, v13
    s_bfe_u32 s3, s2, 0x20003
    s_bfe_u32 s79, s2, 0x20001
    s_lshl2_add_u32 s75, s79, s3
    s_lshr_b32 s77, s2, 5
    s_add_u32 s79, s3, s77
    s_and_b32 s79, s79, 3
    s_mul_i32 s79, s79, 2
    s_bfe_u32 s80, s2, 0x10001
    s_add_u32 s79, s79, s80
    s_mul_i32 s80, s79, 37
    s_lshr_b32 s80, s80, 8
    s_mul_i32 s80, s80, 7
    s_sub_u32 s82, s79, s80
    s_lshl_b32 s88, s82, 7
    s_lshl_b32 s74, s72, 11
    v_lshrrev_b32 v14, 3, v13
    v_lshl_add_u32 v12, s72, 4, v14
    v_mul_u32_u24 v3, 896, v12
    v_lshrrev_b32 v12, 4, v13
    v_xor_b32 v12, v12, v13
    v_and_b32 v12, 7, v12
    v_lshl_add_u32 v3, v12, 4, v3
    v_xor_b32 v4, 64, v3
    v_add_u32 v4, 7168, v4
    s_mul_i32 s80, s75, 114688
    s_and_b32 s76, s2, 1
    s_lshl_b32 s73, s72, 10
    s_mul_i32 s95, s82, 172032
    s_mov_b32 s83, s2
    s_waitcnt lgkmcnt(0)
    s_add_u32 s4, s36, s80
    s_addc_u32 s5, s37, 0
    s_sub_u32 s6, 1835008, s80
    s_mov_b32 s7, 0x20000
    s_add_u32 m0, s74, 0
    s_nop 0
    buffer_load_dwordx4 v3, s[4:7], s88 offen lds
    s_add_u32 m0, s74, 1024
    s_nop 0
    buffer_load_dwordx4 v4, s[4:7], s88 offen lds
    s_mov_b32 s16, s38
    s_mov_b32 s17, s39
    s_mov_b32 s18, 1204224
    s_mov_b32 s19, 0x20000
    s_lshl3_add_u32 s78, s76, s77
    s_and_b32 s45, s72, 3
    v_lshrrev_b32 v12, 2, v13
    v_lshl_add_u32 v2, s45, 4, v12
    v_mul_u32_u24 v2, 2688, v2
    s_mul_i32 s79, s78, 56
    s_and_b32 s79, s79, 0xfff0
    v_and_b32 v12, 48, v0
    s_add_u32 s79, s79, 896
    v_add3_u32 v2, v2, v12, s79
    s_cmp_ge_u32 s72, 4
    s_cbranch_scc1 L_B
    s_mov_b32 s68, s52
    s_mov_b32 s69, s53
    s_mov_b32 s70, 896
    s_mov_b32 s71, 0x20000
    v_add_u32 v23, s82, v14
    v_cmp_lt_u32 vcc, 6, v23
    v_subrev_u32 v24, 7, v23
    s_mov_b32 m0, 155648
    v_cndmask_b32 v23, v23, v24, vcc
    v_and_b32 v24, 0x70, v0
    v_lshl_or_b32 v23, v23, 7, v24
    s_lshl_b32 s79, s72, 4
    s_lshl_b64 exec, 0xffff, s79
    buffer_load_dwordx4 v23, s[68:71], 0 offen lds
    s_mov_b64 exec, -1
    s_add_u32 s79, s88, 128
    s_cmp_eq_u32 s79, 896
    s_cselect_b32 s89, 0, s79
    s_mul_i32 s96, s89, 1344
    s_add_u32 m0, s74, 16384
    s_nop 0
    buffer_load_dwordx4 v3, s[4:7], s89 offen lds
    s_add_u32 m0, s74, 17408
    s_nop 0
    buffer_load_dwordx4 v4, s[4:7], s89 offen lds
    v_lshrrev_b32 v17, 9, v0
    v_bfe_u32 v18, v0, 4, 5
    v_lshl_add_u32 v12, s45, 5, v18
    v_lshlrev_b32 v112, 7, v12
    v_bfe_u32 v12, v18, 1, 3
    v_xor_b32 v12, v12, v17
    v_lshl_or_b32 v112, v12, 4, v112
    v_xor_b32 v115, 32, v112
    v_xor_b32 v118, 64, v112
    v_xor_b32 v121, 96, v112
    s_mov_b32 s86, 0x10000000
    s_mov_b32 s87, 0x10000000
    v_lshlrev_b32 v12, 4, v17
    v_add_u32 v124, 155648, v12
    v_bfe_u32 v19, v0, 6, 2
    v_lshl_add_u32 v21, v17, 3, v19
    v_bfe_u32 v12, v0, 8, 1
    v_bfe_u32 v13, v0, 4, 2
    v_lshl_or_b32 v20, v12, 2, v13
    v_add_u32 v13, s78, v20
    s_and_b32 s79, s78, 14
    v_subrev_u32 v13, s79, v13
    v_and_b32 v13, 7, v13
    v_lshlrev_b32 v13, 3, v13
    v_lshl_or_b32 v8, v21, 6, v13
    v_add_u32 v9, 0x10000, v8
    v_add_u32 v10, 0x20000, v8
    s_add_u32 s79, s89, 128
    s_cmp_eq_u32 s79, 896
    s_cselect_b32 s90, 0, s79
    s_mul_i32 s97, s90, 1344
    s_add_u32 s79, s90, 128
    s_cmp_eq_u32 s79, 896
    s_cselect_b32 s91, 0, s79
    s_mul_i32 s98, s91, 1344
    s_cmp_eq_u32 s77, 7
    s_cbranch_scc1 L_QA
    s_waitcnt vmcnt(2)
    s_barrier
    s_add_u32 m0, s74, 32768
    ds_read_b128 v[144:147], v112 offset:0
    ds_read_b64_tr_b16 v[40:41], v10 offset:16384
    ds_read_b64_tr_b16 v[42:43], v10 offset:16640
    s_mov_b64 exec, s[86:87]
    ds_read_b128 v[40:43], v124 offset:0
    s_mov_b64 exec, -1
    buffer_load_dwordx4 v3, s[4:7], s90 offen lds
    s_add_u32 m0, s74, 33792
    ds_read_b128 v[148:151], v115 offset:0
    ds_read_b64_tr_b16 v[44:45], v10 offset:17408
    ds_read_b64_tr_b16 v[46:47], v10 offset:17664
    s_mov_b64 exec, s[86:87]
    ds_read_b128 v[44:47], v124 offset:32
    s_mov_b64 exec, -1
    buffer_load_dwordx4 v4, s[4:7], s90 offen lds
    s_waitcnt lgkmcnt(4)
    v_mfma_f32_32x32x16_bf16 v[64:79], v[40:43], v[144:147], 0
    ds_read_b128 v[152:155], v118 offset:0
    ds_read_b64_tr_b16 v[48:49], v10 offset:18432
    ds_read_b64_tr_b16 v[50:51], v10 offset:18688
    s_mov_b64 exec, s[86:87]
    ds_read_b128 v[48:51], v124 offset:64
    s_mov_b64 exec, -1
    s_add_u32 s79, s91, 128
    s_cmp_eq_u32 s79, 896
    s_cselect_b32 s92, 0, s79
    s_add_u32 s79, s92, 128
    s_cmp_eq_u32 s79, 896
    s_cselect_b32 s93, 0, s79
    s_waitcnt lgkmcnt(4)
    v_mfma_f32_32x32x16_bf16 v[64:79], v[44:47], v[148:151], v[64:79]
    ds_read_b128 v[156:159], v121 offset:0
    ds_read_b64_tr_b16 v[52:53], v10 offset:19456
    ds_read_b64_tr_b16 v[54:55], v10 offset:19712
    s_mov_b64 exec, s[86:87]
    ds_read_b128 v[52:55], v124 offset:96
    s_mov_b64 exec, -1
    s_add_u32 s79, s93, 128
    s_cmp_eq_u32 s79, 896
    s_cselect_b32 s94, 0, s79
    s_mov_b32 s64, s40
    s_mov_b32 s65, s41
    s_waitcnt lgkmcnt(4)
    v_mfma_f32_32x32x16_bf16 v[64:79], v[48:51], v[152:155], v[64:79]
    s_waitcnt vmcnt(2)
    s_barrier
    s_add_u32 m0, s74, 49152
    ds_read_b128 v[160:163], v112 offset:16384
    ds_read_b64_tr_b16 v[56:57], v10 offset:8192
    ds_read_b64_tr_b16 v[58:59], v10 offset:8448
    s_mov_b64 exec, s[86:87]
    ds_read_b128 v[56:59], v124 offset:128
    s_mov_b64 exec, -1
    buffer_load_dwordx4 v3, s[4:7], s91 offen lds
    s_mov_b32 s66, 25088
    s_mov_b32 s67, 0x20000
    s_mov_b32 s32, s56
    s_mov_b32 s33, s57
    s_mov_b32 s34, 256
    s_waitcnt lgkmcnt(4)
    v_mfma_f32_32x32x16_bf16 v[64:79], v[52:55], v[156:159], v[64:79]
    s_add_u32 m0, s74, 50176
    ds_read_b128 v[164:167], v115 offset:16384
    ds_read_b64_tr_b16 v[60:61], v10 offset:9216
    ds_read_b64_tr_b16 v[62:63], v10 offset:9472
    s_mov_b64 exec, s[86:87]
    ds_read_b128 v[60:63], v124 offset:160
    s_mov_b64 exec, -1
    buffer_load_dwordx4 v4, s[4:7], s91 offen lds
    s_mov_b32 s35, 0x20000
    s_or_b32 s79, s83, s72
    s_cselect_b32 s80, 2147418112, 0
    v_lshl_or_b32 v12, v0, 8, s80
    s_or_b32 s79, s60, 1
    v_mov_b32 v13, s79
    s_waitcnt lgkmcnt(4)
    v_mfma_f32_32x32x16_bf16 v[64:79], v[56:59], v[160:163], v[64:79]
    ds_read_b128 v[168:171], v118 offset:16384
    ds_read_b64_tr_b16 v[40:41], v10 offset:10240
    ds_read_b64_tr_b16 v[42:43], v10 offset:10496
    s_mov_b64 exec, s[86:87]
    ds_read_b128 v[40:43], v124 offset:192
    s_mov_b64 exec, -1
    buffer_store_dword v13, v12, s[32:35], 0 offen sc1
    s_mov_b32 s28, s58
    s_mov_b32 s29, s59
    s_mov_b32 s30, 26345472
    s_mov_b32 s31, 0x20000
    s_waitcnt lgkmcnt(4)
    v_mfma_f32_32x32x16_bf16 v[64:79], v[60:63], v[164:167], v[64:79]
    ds_read_b128 v[172:175], v121 offset:16384
    ds_read_b64_tr_b16 v[44:45], v10 offset:11264
    ds_read_b64_tr_b16 v[46:47], v10 offset:11520
    s_mov_b64 exec, s[86:87]
    ds_read_b128 v[44:47], v124 offset:224
    s_mov_b64 exec, -1
    s_mov_b32 s82, 0x3fb8aa3b
    s_mov_b32 s84, 0
    s_mov_b32 s85, -1
    s_mul_i32 s2, s76, 7
    s_add_u32 s2, s2, s77
    s_waitcnt lgkmcnt(4)
    v_mfma_f32_32x32x16_bf16 v[64:79], v[40:43], v[168:171], v[64:79]
    s_waitcnt vmcnt(3)
    s_barrier
    s_add_u32 m0, s74, 0
    ds_read_b128 v[176:179], v112 offset:32768
    ds_read_b64_tr_b16 v[48:49], v10 offset:0
    ds_read_b64_tr_b16 v[50:51], v10 offset:256
    s_mov_b64 exec, s[86:87]
    ds_read_b128 v[48:51], v124 offset:256
    s_mov_b64 exec, -1
    buffer_load_dwordx4 v3, s[4:7], s92 offen lds
    s_lshl_b32 s44, s2, 8
    s_add_u32 s8, s46, s44
    s_addc_u32 s9, s47, 0
    s_sub_u32 s10, 1605632, s44
    s_mov_b32 s11, 0x20000
    s_waitcnt lgkmcnt(4)
    v_mfma_f32_32x32x16_bf16 v[64:79], v[44:47], v[172:175], v[64:79]
    s_add_u32 m0, s74, 1024
    ds_read_b128 v[180:183], v115 offset:32768
    ds_read_b64_tr_b16 v[52:53], v10 offset:1024
    ds_read_b64_tr_b16 v[54:55], v10 offset:1280
    s_mov_b64 exec, s[86:87]
    ds_read_b128 v[52:55], v124 offset:288
    s_mov_b64 exec, -1
    buffer_load_dwordx4 v4, s[4:7], s92 offen lds
    s_add_u32 s12, s48, s44
    s_addc_u32 s13, s49, 0
    s_sub_u32 s14, 1605632, s44
    s_mov_b32 s15, 0x20000
    v_lshl_add_u32 v16, s72, 3, v14
    s_waitcnt lgkmcnt(4)
    v_mfma_f32_32x32x16_bf16 v[64:79], v[48:51], v[176:179], v[64:79]
    ds_read_b128 v[184:187], v118 offset:32768
    ds_read_b64_tr_b16 v[56:57], v10 offset:2048
    ds_read_b64_tr_b16 v[58:59], v10 offset:2304
    s_mov_b64 exec, s[86:87]
    ds_read_b128 v[56:59], v124 offset:320
    s_mov_b64 exec, -1
    v_mul_u32_u24 v1, 3584, v16
    v_lshrrev_b32 v12, 2, v0
    v_xor_b32 v12, v12, v0
    v_and_b32 v12, 64, v12
    v_and_b32 v13, 48, v0
    s_waitcnt lgkmcnt(4)
    v_mfma_f32_32x32x16_bf16 v[64:79], v[52:55], v[180:183], v[64:79]
    ds_read_b128 v[188:191], v121 offset:32768
    ds_read_b64_tr_b16 v[60:61], v10 offset:3072
    ds_read_b64_tr_b16 v[62:63], v10 offset:3328
    s_mov_b64 exec, s[86:87]
    ds_read_b128 v[60:63], v124 offset:352
    s_mov_b64 exec, -1
    v_add3_u32 v1, v1, v12, v13
    v_lshrrev_b32 v12, 1, v19
    v_lshlrev_b32 v12, 6, v12
    v_lshl_or_b32 v12, v21, 7, v12
    v_lshl_or_b32 v5, v20, 3, v12
    s_waitcnt lgkmcnt(4)
    v_mfma_f32_32x32x16_bf16 v[64:79], v[56:59], v[184:187], v[64:79]
    s_waitcnt vmcnt(3)
    s_barrier
    s_add_u32 m0, s74, 16384
    ds_read_b128 v[192:195], v112 offset:49152
    ds_read_b64_tr_b16 v[40:41], v9 offset:57344
    ds_read_b64_tr_b16 v[42:43], v9 offset:57600
    s_mov_b64 exec, s[86:87]
    ds_read_b128 v[40:43], v124 offset:384
    s_mov_b64 exec, -1
    buffer_load_dwordx4 v3, s[4:7], s93 offen lds
    v_add_u32 v6, 0x10000, v5
    v_add_u32 v7, 0x20000, v5
    s_lshl_b32 s44, s77, 7
    s_add_u32 s24, s42, s44
    s_addc_u32 s25, s43, 0
    s_waitcnt lgkmcnt(4)
    v_mfma_f32_32x32x16_bf16 v[64:79], v[60:63], v[188:191], v[64:79]
    s_add_u32 m0, s74, 17408
    ds_read_b128 v[196:199], v115 offset:49152
    ds_read_b64_tr_b16 v[44:45], v9 offset:58368
    ds_read_b64_tr_b16 v[46:47], v9 offset:58624
    s_mov_b64 exec, s[86:87]
    ds_read_b128 v[44:47], v124 offset:416
    s_mov_b64 exec, -1
    buffer_load_dwordx4 v4, s[4:7], s93 offen lds
    s_sub_u32 s26, 401408, s44
    s_mov_b32 s27, 0x20000
    s_mov_b32 s56, s75
    s_mov_b32 s57, s76
    s_mul_i32 s79, s57, 802816
    s_add_u32 s44, s44, s79
    s_waitcnt lgkmcnt(4)
    v_mfma_f32_32x32x16_bf16 v[64:79], v[40:43], v[192:195], v[64:79]
    ds_read_b128 v[200:203], v118 offset:49152
    ds_read_b64_tr_b16 v[48:49], v9 offset:59392
    ds_read_b64_tr_b16 v[50:51], v9 offset:59648
    s_mov_b64 exec, s[86:87]
    ds_read_b128 v[48:51], v124 offset:448
    s_mov_b64 exec, -1
    s_add_u32 s20, s50, s44
    s_addc_u32 s21, s51, 0
    s_sub_u32 s22, 1605632, s44
    s_mov_b32 s23, 0x20000
    s_lshr_b32 s40, s75, 1
    s_waitcnt lgkmcnt(4)
    v_mfma_f32_32x32x16_bf16 v[64:79], v[44:47], v[196:199], v[64:79]
    ds_read_b128 v[204:207], v121 offset:49152
    ds_read_b64_tr_b16 v[52:53], v9 offset:60416
    ds_read_b64_tr_b16 v[54:55], v9 offset:60672
    s_mov_b64 exec, s[86:87]
    ds_read_b128 v[52:55], v124 offset:480
    s_mov_b64 exec, -1
    s_lshl_b32 s80, s72, 8
    s_add_u32 m0, s80, 156672
    s_mul_i32 s79, s78, 1568
    s_add_u32 s79, s79, s80
    s_mov_b64 exec, 0xffff
    buffer_load_dwordx4 v0, s[64:67], s79 offen lds
    s_mov_b64 exec, -1
    s_mul_i32 s40, s40, 1540096
    s_mul_i32 s80, s75, 32768
    s_add_u32 s40, s40, s80
    s_mul_i32 s80, s45, 8192
    s_add_u32 s40, s40, s80
    s_waitcnt lgkmcnt(4)
    v_mfma_f32_32x32x16_bf16 v[64:79], v[48:51], v[200:203], v[64:79]
    s_waitcnt vmcnt(3)
    s_barrier
    s_add_u32 m0, s74, 32768
    ds_read_b128 v[208:211], v112 offset:0
    ds_read_b64_tr_b16 v[56:57], v10 offset:16384
    ds_read_b64_tr_b16 v[58:59], v10 offset:16640
    s_mov_b64 exec, s[86:87]
    ds_read_b128 v[56:59], v124 offset:512
    s_mov_b64 exec, -1
    buffer_load_dwordx4 v3, s[4:7], s94 offen lds
    s_mul_i32 s80, s2, 114688
    s_add_u32 s40, s40, s80
    v_lshrrev_b32 v37, 2, v0
    v_mov_b32 v38, 2147418112
    v_cndmask_b32 v33, v37, v38, s[84:85]
    s_waitcnt lgkmcnt(4)
    v_mfma_f32_32x32x16_bf16 v[64:79], v[52:55], v[204:207], v[64:79]
    s_add_u32 m0, s74, 33792
    ds_read_b128 v[212:215], v115 offset:0
    ds_read_b64_tr_b16 v[60:61], v10 offset:17408
    ds_read_b64_tr_b16 v[62:63], v10 offset:17664
    s_mov_b64 exec, s[86:87]
    ds_read_b128 v[60:63], v124 offset:544
    s_mov_b64 exec, -1
    buffer_load_dwordx4 v4, s[4:7], s94 offen lds
    v_bfe_u32 v37, v0, 6, 2
    v_lshrrev_b32 v38, 9, v0
    v_lshl_add_u32 v37, v38, 2, v37
    v_mul_u32_u24 v39, 56, v37
    v_bfe_u32 v37, v0, 8, 1
    s_waitcnt lgkmcnt(4)
    v_mfma_f32_32x32x16_bf16 v[64:79], v[56:59], v[208:211], v[64:79]
    ds_read_b128 v[216:219], v118 offset:0
    ds_read_b64_tr_b16 v[40:41], v10 offset:18432
    ds_read_b64_tr_b16 v[42:43], v10 offset:18688
    s_mov_b64 exec, s[86:87]
    ds_read_b128 v[40:43], v124 offset:576
    s_mov_b64 exec, -1
    v_bfe_u32 v38, v0, 4, 2
    v_lshl_or_b32 v37, v37, 2, v38
    v_min_u32 v37, 6, v37
    v_lshl_add_u32 v39, v37, 3, v39
    v_add_u32 v39, 156672, v39
    s_waitcnt lgkmcnt(4)
    v_mfma_f32_32x32x16_bf16 v[64:79], v[60:63], v[212:215], v[64:79]
    ds_read_b128 v[220:223], v121 offset:0
    ds_read_b64_tr_b16 v[44:45], v10 offset:19456
    ds_read_b64_tr_b16 v[46:47], v10 offset:19712
    s_mov_b64 exec, s[86:87]
    ds_read_b128 v[44:47], v124 offset:608
    s_mov_b64 exec, -1
    v_bfe_u32 v37, v0, 4, 5
    v_lshl_add_u32 v35, s45, 5, v37
    v_lshlrev_b32 v35, 7, v35
    v_and_b32 v38, 2, v37
    v_lshl_or_b32 v35, v38, 5, v35
    s_waitcnt lgkmcnt(4)
    v_mfma_f32_32x32x16_bf16 v[64:79], v[40:43], v[216:219], v[64:79]
    s_waitcnt vmcnt(3)
    s_barrier
    ds_read_b128 v[224:227], v112 offset:16384
    ds_read_b64_tr_b16 v[48:49], v10 offset:8192
    ds_read_b64_tr_b16 v[50:51], v10 offset:8448
    s_mov_b64 exec, s[86:87]
    ds_read_b128 v[48:51], v124 offset:640
    s_mov_b64 exec, -1
    v_and_b32 v38, 12, v37
    v_lshl_or_b32 v35, v38, 2, v35
    v_lshrrev_b32 v38, 9, v0
    v_xor_b32 v38, v38, v37
    v_and_b32 v38, 1, v38
    s_waitcnt lgkmcnt(4)
    v_mfma_f32_32x32x16_bf16 v[64:79], v[44:47], v[220:223], v[64:79]
    ds_read_b128 v[228:231], v115 offset:16384
    ds_read_b64_tr_b16 v[52:53], v10 offset:9216
    ds_read_b64_tr_b16 v[54:55], v10 offset:9472
    s_mov_b64 exec, s[86:87]
    ds_read_b128 v[52:55], v124 offset:672
    s_mov_b64 exec, -1
    v_lshl_or_b32 v35, v38, 3, v35
    v_add_u32 v35, 114688, v35
    s_waitcnt lgkmcnt(4)
    v_mfma_f32_32x32x16_bf16 v[64:79], v[48:51], v[224:227], v[64:79]
    ds_read_b128 v[232:235], v118 offset:16384
    ds_read_b64_tr_b16 v[56:57], v10 offset:10240
    ds_read_b64_tr_b16 v[58:59], v10 offset:10496
    s_mov_b64 exec, s[86:87]
    ds_read_b128 v[56:59], v124 offset:704
    s_mov_b64 exec, -1
    s_waitcnt lgkmcnt(4)
    v_mfma_f32_32x32x16_bf16 v[64:79], v[52:55], v[228:231], v[64:79]
    ds_read_b128 v[236:239], v121 offset:16384
    ds_read_b64_tr_b16 v[60:61], v10 offset:11264
    ds_read_b64_tr_b16 v[62:63], v10 offset:11520
    s_mov_b64 exec, s[86:87]
    ds_read_b128 v[60:63], v124 offset:736
    s_mov_b64 exec, -1
    s_waitcnt vmcnt(2)
    s_waitcnt lgkmcnt(4)
    v_mfma_f32_32x32x16_bf16 v[64:79], v[56:59], v[232:235], v[64:79]
    s_waitcnt vmcnt(0)
    s_barrier
    ds_read_b128 v[240:243], v112 offset:32768
    ds_read_b64_tr_b16 v[40:41], v10 offset:0
    ds_read_b64_tr_b16 v[42:43], v10 offset:256
    s_mov_b64 exec, s[86:87]
    ds_read_b128 v[40:43], v124 offset:768
    s_mov_b64 exec, -1
    s_waitcnt lgkmcnt(4)
    v_mfma_f32_32x32x16_bf16 v[64:79], v[60:63], v[236:239], v[64:79]
    ds_read_b128 v[244:247], v115 offset:32768
    ds_read_b64_tr_b16 v[44:45], v10 offset:1024
    ds_read_b64_tr_b16 v[46:47], v10 offset:1280
    s_mov_b64 exec, s[86:87]
    ds_read_b128 v[44:47], v124 offset:800
    s_mov_b64 exec, -1
    s_mov_b32 s95, 0
    s_mov_b32 s96, 0
    s_mov_b32 s97, 114688
    s_mov_b32 s98, 50176
    v_lshrrev_b32 v2, 7, v0
    s_waitcnt lgkmcnt(4)
    v_mfma_f32_32x32x16_bf16 v[64:79], v[40:43], v[240:243], v[64:79]
    ds_read_b128 v[248:251], v118 offset:32768
    ds_read_b64_tr_b16 v[48:49], v10 offset:2048
    ds_read_b64_tr_b16 v[50:51], v10 offset:2304
    s_mov_b64 exec, s[86:87]
    ds_read_b128 v[48:51], v124 offset:832
    s_mov_b64 exec, -1
    v_lshl_add_u32 v2, s72, 3, v2
    v_mul_u32_u24 v2, 896, v2
    v_lshrrev_b32 v3, 2, v0
    v_xor_b32 v3, v3, v0
    v_and_b32 v3, 64, v3
    s_waitcnt lgkmcnt(4)
    v_mfma_f32_32x32x16_bf16 v[64:79], v[44:47], v[244:247], v[64:79]
    ds_read_b128 v[252:255], v121 offset:32768
    ds_read_b64_tr_b16 v[52:53], v10 offset:3072
    ds_read_b64_tr_b16 v[54:55], v10 offset:3328
    s_mov_b64 exec, s[86:87]
    ds_read_b128 v[52:55], v124 offset:864
    s_mov_b64 exec, -1
    v_and_b32 v4, 48, v0
    v_add3_u32 v2, v2, v3, v4
    v_subrev_u32 v3, 0, v2
    s_cmp_eq_u32 s45, 3
    s_cselect_b32 s80, 2147418112, 0
    v_or_b32 v4, s80, v3
    v_cndmask_b32 v3, v3, v4, s[84:85]
    v_xor_b32 v8, 64, v5
    v_xor_b32 v9, 64, v6
    v_xor_b32 v10, 64, v7
    ds_read_b64_tr_b16 v[20:21], v39 offset:0
    ds_read_b64_tr_b16 v[22:23], v39 offset:448
    ds_read_b64_tr_b16 v[24:25], v39 offset:896
    ds_read_b64_tr_b16 v[26:27], v39 offset:1344
    s_waitcnt lgkmcnt(8)
    v_mfma_f32_32x32x16_bf16 v[64:79], v[48:51], v[248:251], v[64:79]
    s_waitcnt lgkmcnt(4)
    v_mfma_f32_32x32x16_bf16 v[64:79], v[52:55], v[252:255], v[64:79]
    s_nop 11
    v_mov_b32 v32, v76
    v_cvt_pk_bf16_f32 v18, v76, v77
    v_cvt_pk_bf16_f32 v19, v78, v79
    v_cvt_pk_bf16_f32 v12, v64, v65
    v_cvt_pk_bf16_f32 v13, v66, v67
    v_cvt_pk_bf16_f32 v14, v68, v69
    v_cvt_pk_bf16_f32 v15, v70, v71
    v_cvt_pk_bf16_f32 v16, v72, v73
    v_cvt_pk_bf16_f32 v17, v74, v75
    v_cndmask_b32 v18, v18, 0, s[84:85]
    v_cndmask_b32 v19, v19, 0, s[84:85]
    s_barrier
    s_waitcnt lgkmcnt(0)
    v_mfma_f32_32x32x16_bf16 v[64:79], v[20:23], v[12:15], 0
    v_mfma_f32_32x32x16_bf16 v[64:79], v[24:27], v[16:19], v[64:79]
    s_nop 11
    v_cndmask_b32 v76, v76, v78, s[84:85]
    v_cndmask_b32 v77, v77, v79, s[84:85]
    v_max3_f32 v28, v64, v65, v66
    v_min3_f32 v29, v64, v65, v66
    v_max3_f32 v30, v67, v68, v69
    v_min3_f32 v31, v67, v68, v69
    v_max3_f32 v28, v28, v70, v71
    v_min3_f32 v29, v29, v70, v71
    v_max3_f32 v30, v30, v72, v73
    v_min3_f32 v31, v31, v72, v73
    v_max3_f32 v28, v28, v74, v75
    v_min3_f32 v29, v29, v74, v75
    v_max3_f32 v30, v30, v76, v77
    v_min3_f32 v31, v31, v76, v77
    v_max_f32 v28, v28, v30
    v_min_f32 v29, v29, v31
    v_mul_f32 v28, s82, v28
    v_mul_f32 v29, 0xbfb8aa3b, v29
    s_nop 1
    v_permlane32_swap_b32 v28, v29
    v_max_f32 v28, v28, v29
    v_mov_b32 v29, v28
    s_nop 1
    v_permlane32_swap_b32 v28, v29
    v_fma_f32 v12, v64, s82, -v28
    v_fma_f32 v13, v65, s82, -v28
    v_fma_f32 v64, -v64, s82, -v29
    v_fma_f32 v65, -v65, s82, -v29
    v_exp_f32 v12, v12
    v_fma_f32 v14, v66, s82, -v28
    v_exp_f32 v13, v13
    v_fma_f32 v15, v67, s82, -v28
    v_exp_f32 v64, v64
    v_fma_f32 v66, -v66, s82, -v29
    v_exp_f32 v65, v65
    v_fma_f32 v67, -v67, s82, -v29
    v_exp_f32 v14, v14
    v_fma_f32 v16, v68, s82, -v28
    v_exp_f32 v15, v15
    v_fma_f32 v17, v69, s82, -v28
    v_exp_f32 v66, v66
    v_fma_f32 v68, -v68, s82, -v29
    v_exp_f32 v67, v67
    v_fma_f32 v69, -v69, s82, -v29
    v_exp_f32 v16, v16
    v_fma_f32 v18, v70, s82, -v28
    v_fma_f32 v19, v71, s82, -v28
    v_exp_f32 v17, v17
    v_fma_f32 v70, -v70, s82, -v29
    v_fma_f32 v71, -v71, s82, -v29
    v_exp_f32 v68, v68
    v_add_f32 v26, v12, v14
    v_add_f32 v27, v13, v15
    v_exp_f32 v69, v69
    v_add_f32 v30, v64, v66
    v_add_f32 v31, v65, v67
    v_exp_f32 v18, v18
    v_fma_f32 v20, v72, s82, -v28
    v_fma_f32 v21, v73, s82, -v28
    v_exp_f32 v19, v19
    v_fma_f32 v72, -v72, s82, -v29
    v_fma_f32 v73, -v73, s82, -v29
    v_exp_f32 v70, v70
    s_barrier
    v_add_f32 v26, v26, v16
    v_add_f32 v27, v27, v17
    v_exp_f32 v71, v71
    v_add_f32 v30, v30, v68
    v_add_f32 v31, v31, v69
    v_exp_f32 v20, v20
    v_fma_f32 v22, v74, s82, -v28
    v_fma_f32 v23, v75, s82, -v28
    v_exp_f32 v21, v21
    v_fma_f32 v74, -v74, s82, -v29
    v_fma_f32 v75, -v75, s82, -v29
    v_exp_f32 v72, v72
    v_add_f32 v26, v26, v18
    v_add_f32 v27, v27, v19
    v_exp_f32 v73, v73
    v_add_f32 v30, v30, v70
    v_add_f32 v31, v31, v71
    v_exp_f32 v22, v22
    v_fma_f32 v24, v76, s82, -v28
    v_fma_f32 v25, v77, s82, -v28
    v_exp_f32 v23, v23
    v_fma_f32 v76, -v76, s82, -v29
    v_fma_f32 v77, -v77, s82, -v29
    v_exp_f32 v74, v74
    v_add_f32 v26, v26, v20
    v_add_f32 v27, v27, v21
    v_exp_f32 v75, v75
    v_add_f32 v30, v30, v72
    v_add_f32 v31, v31, v73
    v_exp_f32 v24, v24
    v_add_f32 v26, v26, v22
    v_exp_f32 v25, v25
    v_add_f32 v27, v27, v23
    v_exp_f32 v76, v76
    v_add_f32 v30, v30, v74
    v_exp_f32 v77, v77
    v_add_f32 v31, v31, v75
    v_add_f32 v26, v26, v24
    v_add_f32 v27, v27, v25
    v_add_f32 v30, v30, v76
    v_add_f32 v31, v31, v77
    v_add_f32 v28, v26, v27
    v_add_f32 v29, v30, v31
    s_nop 1
    v_permlane32_swap_b32 v28, v29
    v_add_f32 v28, v28, v29
    v_rcp_f32 v28, v28
    s_nop 0
    v_mov_b32 v29, v28
    s_nop 1
    v_permlane32_swap_b32 v28, v29
    v_mul_f32 v64, v64, v29
    v_mul_f32 v65, v65, v29
    v_mul_f32 v66, v66, v29
    v_mul_f32 v67, v67, v29
    v_mul_f32 v68, v68, v29
    v_mul_f32 v69, v69, v29
    v_cvt_pk_bf16_f32 v64, v64, v65
    v_mul_f32 v70, v70, v29
    v_mul_f32 v71, v71, v29
    v_cvt_pk_bf16_f32 v65, v66, v67
    v_mul_f32 v72, v72, v29
    v_mul_f32 v73, v73, v29
    v_cvt_pk_bf16_f32 v66, v68, v69
    v_mul_f32 v74, v74, v29
    v_mul_f32 v75, v75, v29
    v_cvt_pk_bf16_f32 v67, v70, v71
    v_mul_f32 v76, v76, v29
    v_mul_f32 v77, v77, v29
    v_cvt_pk_bf16_f32 v68, v72, v73
    v_mul_f32 v12, v12, v28
    v_mul_f32 v13, v13, v28
    v_cvt_pk_bf16_f32 v69, v74, v75
    v_mul_f32 v14, v14, v28
    v_mul_f32 v15, v15, v28
    v_cvt_pk_bf16_f32 v70, v76, v77
    v_mul_f32 v16, v16, v28
    v_mul_f32 v17, v17, v28
    v_cvt_pk_bf16_f32 v72, v12, v13
    v_mul_f32 v18, v18, v28
    v_mul_f32 v19, v19, v28
    v_cvt_pk_bf16_f32 v73, v14, v15
    v_mul_f32 v20, v20, v28
    v_mul_f32 v21, v21, v28
    v_cvt_pk_bf16_f32 v74, v16, v17
    v_mul_f32 v22, v22, v28
    v_mul_f32 v23, v23, v28
    v_cvt_pk_bf16_f32 v75, v18, v19
    v_mul_f32 v24, v24, v28
    v_mul_f32 v25, v25, v28
    v_cvt_pk_bf16_f32 v76, v20, v21
    v_cvt_pk_bf16_f32 v77, v22, v23
    v_cvt_pk_bf16_f32 v78, v24, v25
    v_mov_b32 v71, 0
    v_mov_b32 v79, 0
    v_xor_b32 v37, 64, v35
    ds_write_b64 v37, v[64:65]
    v_xor_b32 v38, 80, v35
    ds_write_b64 v38, v[66:67]
    v_xor_b32 v37, 96, v35
    ds_write_b64 v37, v[68:69]
    v_xor_b32 v38, 112, v35
    ds_write_b64 v38, v[70:71]
    ds_write_b64 v35, v[72:73]
    v_xor_b32 v38, 16, v35
    ds_write_b64 v38, v[74:75]
    v_xor_b32 v37, 32, v35
    ds_write_b64 v37, v[76:77]
    v_xor_b32 v38, 48, v35
    ds_write_b64 v38, v[78:79]
    s_barrier
    ds_read_b64_tr_b16 v[56:57], v5 offset:24576
    ds_read_b64_tr_b16 v[58:59], v5 offset:25088
    ds_read_b64_tr_b16 v[60:61], v5 offset:32768
    ds_read_b64_tr_b16 v[62:63], v5 offset:33280
    ds_read_b64_tr_b16 v[40:41], v8 offset:24576
    ds_read_b64_tr_b16 v[42:43], v8 offset:25088
    ds_read_b64_tr_b16 v[44:45], v8 offset:32768
    ds_read_b64_tr_b16 v[46:47], v8 offset:33280
    s_waitcnt lgkmcnt(6)
    v_mfma_f32_32x32x16_bf16 v[80:95], v[56:59], v[144:147], 0
    ds_read_b64_tr_b16 v[48:49], v5 offset:26624
    ds_read_b64_tr_b16 v[50:51], v5 offset:27136
    s_waitcnt lgkmcnt(6)
    v_mfma_f32_32x32x16_bf16 v[96:111], v[60:63], v[144:147], 0
    ds_read_b64_tr_b16 v[52:53], v5 offset:34816
    ds_read_b64_tr_b16 v[54:55], v5 offset:35328
    s_waitcnt lgkmcnt(6)
    v_mfma_f32_32x32x16_bf16 v[112:127], v[40:43], v[144:147], 0
    ds_read_b64_tr_b16 v[56:57], v8 offset:26624
    ds_read_b64_tr_b16 v[58:59], v8 offset:27136
    s_waitcnt lgkmcnt(6)
    v_mfma_f32_32x32x16_bf16 v[128:143], v[44:47], v[144:147], 0
    ds_read_b64_tr_b16 v[60:61], v8 offset:34816
    ds_read_b64_tr_b16 v[62:63], v8 offset:35328
    s_waitcnt lgkmcnt(6)
    v_mfma_f32_32x32x16_bf16 v[80:95], v[48:51], v[148:151], v[80:95]
    ds_read_b64_tr_b16 v[40:41], v5 offset:28672
    ds_read_b64_tr_b16 v[42:43], v5 offset:29184
    s_waitcnt lgkmcnt(6)
    v_mfma_f32_32x32x16_bf16 v[96:111], v[52:55], v[148:151], v[96:111]
    ds_read_b64_tr_b16 v[44:45], v5 offset:36864
    ds_read_b64_tr_b16 v[46:47], v5 offset:37376
    s_waitcnt lgkmcnt(6)
    v_mfma_f32_32x32x16_bf16 v[112:127], v[56:59], v[148:151], v[112:127]
    ds_read_b64_tr_b16 v[48:49], v8 offset:28672
    ds_read_b64_tr_b16 v[50:51], v8 offset:29184
    s_waitcnt lgkmcnt(6)
    v_mfma_f32_32x32x16_bf16 v[128:143], v[60:63], v[148:151], v[128:143]
    ds_read_b64_tr_b16 v[52:53], v8 offset:36864
    ds_read_b64_tr_b16 v[54:55], v8 offset:37376
    s_waitcnt lgkmcnt(6)
    v_mfma_f32_32x32x16_bf16 v[80:95], v[40:43], v[152:155], v[80:95]
    ds_read_b64_tr_b16 v[56:57], v5 offset:30720
    ds_read_b64_tr_b16 v[58:59], v5 offset:31232
    s_waitcnt lgkmcnt(6)
    v_mfma_f32_32x32x16_bf16 v[96:111], v[44:47], v[152:155], v[96:111]
    ds_read_b64_tr_b16 v[60:61], v5 offset:38912
    ds_read_b64_tr_b16 v[62:63], v5 offset:39424
    s_waitcnt lgkmcnt(6)
    v_mfma_f32_32x32x16_bf16 v[112:127], v[48:51], v[152:155], v[112:127]
    ds_read_b64_tr_b16 v[40:41], v8 offset:30720
    ds_read_b64_tr_b16 v[42:43], v8 offset:31232
    s_waitcnt lgkmcnt(6)
    v_mfma_f32_32x32x16_bf16 v[128:143], v[52:55], v[152:155], v[128:143]
    ds_read_b64_tr_b16 v[44:45], v8 offset:38912
    ds_read_b64_tr_b16 v[46:47], v8 offset:39424
    s_waitcnt lgkmcnt(6)
    v_mfma_f32_32x32x16_bf16 v[80:95], v[56:59], v[156:159], v[80:95]
    s_barrier
    ds_read_b64_tr_b16 v[48:49], v5 offset:57344
    ds_read_b64_tr_b16 v[50:51], v5 offset:57856
    s_waitcnt lgkmcnt(6)
    v_mfma_f32_32x32x16_bf16 v[96:111], v[60:63], v[156:159], v[96:111]
    ds_read_b64_tr_b16 v[52:53], v6 offset:0
    ds_read_b64_tr_b16 v[54:55], v6 offset:512
    s_waitcnt lgkmcnt(6)
    v_mfma_f32_32x32x16_bf16 v[112:127], v[40:43], v[156:159], v[112:127]
    ds_read_b64_tr_b16 v[56:57], v8 offset:57344
    ds_read_b64_tr_b16 v[58:59], v8 offset:57856
    s_waitcnt lgkmcnt(6)
    v_mfma_f32_32x32x16_bf16 v[128:143], v[44:47], v[156:159], v[128:143]
    ds_read_b64_tr_b16 v[60:61], v9 offset:0
    ds_read_b64_tr_b16 v[62:63], v9 offset:512
    s_waitcnt lgkmcnt(6)
    v_mfma_f32_32x32x16_bf16 v[80:95], v[48:51], v[160:163], v[80:95]
    ds_read_b64_tr_b16 v[40:41], v5 offset:59392
    ds_read_b64_tr_b16 v[42:43], v5 offset:59904
    s_waitcnt lgkmcnt(6)
    v_mfma_f32_32x32x16_bf16 v[96:111], v[52:55], v[160:163], v[96:111]
    ds_read_b64_tr_b16 v[44:45], v6 offset:2048
    ds_read_b64_tr_b16 v[46:47], v6 offset:2560
    s_waitcnt lgkmcnt(6)
    v_mfma_f32_32x32x16_bf16 v[112:127], v[56:59], v[160:163], v[112:127]
    ds_read_b64_tr_b16 v[48:49], v8 offset:59392
    ds_read_b64_tr_b16 v[50:51], v8 offset:59904
    s_waitcnt lgkmcnt(6)
    v_mfma_f32_32x32x16_bf16 v[128:143], v[60:63], v[160:163], v[128:143]
    ds_read_b64_tr_b16 v[52:53], v9 offset:2048
    ds_read_b64_tr_b16 v[54:55], v9 offset:2560
    s_waitcnt lgkmcnt(6)
    v_mfma_f32_32x32x16_bf16 v[80:95], v[40:43], v[164:167], v[80:95]
    ds_read_b64_tr_b16 v[56:57], v5 offset:61440
    ds_read_b64_tr_b16 v[58:59], v5 offset:61952
    s_waitcnt lgkmcnt(6)
    v_mfma_f32_32x32x16_bf16 v[96:111], v[44:47], v[164:167], v[96:111]
    ds_read_b64_tr_b16 v[60:61], v6 offset:4096
    ds_read_b64_tr_b16 v[62:63], v6 offset:4608
    s_waitcnt lgkmcnt(6)
    v_mfma_f32_32x32x16_bf16 v[112:127], v[48:51], v[164:167], v[112:127]
    ds_read_b64_tr_b16 v[40:41], v8 offset:61440
    ds_read_b64_tr_b16 v[42:43], v8 offset:61952
    s_waitcnt lgkmcnt(6)
    v_mfma_f32_32x32x16_bf16 v[128:143], v[52:55], v[164:167], v[128:143]
    ds_read_b64_tr_b16 v[44:45], v9 offset:4096
    ds_read_b64_tr_b16 v[46:47], v9 offset:4608
    s_waitcnt lgkmcnt(6)
    v_mfma_f32_32x32x16_bf16 v[80:95], v[56:59], v[168:171], v[80:95]
    ds_read_b64_tr_b16 v[48:49], v5 offset:63488
    ds_read_b64_tr_b16 v[50:51], v5 offset:64000
    s_waitcnt lgkmcnt(6)
    v_mfma_f32_32x32x16_bf16 v[96:111], v[60:63], v[168:171], v[96:111]
    ds_read_b64_tr_b16 v[52:53], v6 offset:6144
    ds_read_b64_tr_b16 v[54:55], v6 offset:6656
    s_waitcnt lgkmcnt(6)
    v_mfma_f32_32x32x16_bf16 v[112:127], v[40:43], v[168:171], v[112:127]
    ds_read_b64_tr_b16 v[56:57], v8 offset:63488
    ds_read_b64_tr_b16 v[58:59], v8 offset:64000
    s_waitcnt lgkmcnt(6)
    v_mfma_f32_32x32x16_bf16 v[128:143], v[44:47], v[168:171], v[128:143]
    ds_read_b64_tr_b16 v[60:61], v9 offset:6144
    ds_read_b64_tr_b16 v[62:63], v9 offset:6656
    s_waitcnt lgkmcnt(6)
    v_mfma_f32_32x32x16_bf16 v[80:95], v[48:51], v[172:175], v[80:95]
    s_barrier
    ds_read_b64_tr_b16 v[40:41], v5 offset:0
    ds_read_b64_tr_b16 v[42:43], v5 offset:512
    s_waitcnt lgkmcnt(6)
    v_mfma_f32_32x32x16_bf16 v[96:111], v[52:55], v[172:175], v[96:111]
    ds_read_b64_tr_b16 v[44:45], v5 offset:8192
    ds_read_b64_tr_b16 v[46:47], v5 offset:8704
    s_waitcnt lgkmcnt(6)
    v_mfma_f32_32x32x16_bf16 v[112:127], v[56:59], v[172:175], v[112:127]
    ds_read_b64_tr_b16 v[48:49], v8 offset:0
    ds_read_b64_tr_b16 v[50:51], v8 offset:512
    s_waitcnt lgkmcnt(6)
    v_mfma_f32_32x32x16_bf16 v[128:143], v[60:63], v[172:175], v[128:143]
    ds_read_b64_tr_b16 v[52:53], v8 offset:8192
    ds_read_b64_tr_b16 v[54:55], v8 offset:8704
    s_waitcnt lgkmcnt(6)
    v_mfma_f32_32x32x16_bf16 v[80:95], v[40:43], v[176:179], v[80:95]
    ds_read_b64_tr_b16 v[56:57], v5 offset:2048
    ds_read_b64_tr_b16 v[58:59], v5 offset:2560
    s_waitcnt lgkmcnt(6)
    v_mfma_f32_32x32x16_bf16 v[96:111], v[44:47], v[176:179], v[96:111]
    ds_read_b64_tr_b16 v[60:61], v5 offset:10240
    ds_read_b64_tr_b16 v[62:63], v5 offset:10752
    s_waitcnt lgkmcnt(6)
    v_mfma_f32_32x32x16_bf16 v[112:127], v[48:51], v[176:179], v[112:127]
    ds_read_b64_tr_b16 v[40:41], v8 offset:2048
    ds_read_b64_tr_b16 v[42:43], v8 offset:2560
    s_waitcnt lgkmcnt(6)
    v_mfma_f32_32x32x16_bf16 v[128:143], v[52:55], v[176:179], v[128:143]
    ds_read_b64_tr_b16 v[44:45], v8 offset:10240
    ds_read_b64_tr_b16 v[46:47], v8 offset:10752
    s_waitcnt lgkmcnt(6)
    v_mfma_f32_32x32x16_bf16 v[80:95], v[56:59], v[180:183], v[80:95]
    ds_read_b64_tr_b16 v[48:49], v5 offset:4096
    ds_read_b64_tr_b16 v[50:51], v5 offset:4608
    s_waitcnt lgkmcnt(6)
    v_mfma_f32_32x32x16_bf16 v[96:111], v[60:63], v[180:183], v[96:111]
    ds_read_b64_tr_b16 v[52:53], v5 offset:12288
    ds_read_b64_tr_b16 v[54:55], v5 offset:12800
    s_waitcnt lgkmcnt(6)
    v_mfma_f32_32x32x16_bf16 v[112:127], v[40:43], v[180:183], v[112:127]
    ds_read_b64_tr_b16 v[56:57], v8 offset:4096
    ds_read_b64_tr_b16 v[58:59], v8 offset:4608
    s_waitcnt lgkmcnt(6)
    v_mfma_f32_32x32x16_bf16 v[128:143], v[44:47], v[180:183], v[128:143]
    ds_read_b64_tr_b16 v[60:61], v8 offset:12288
    ds_read_b64_tr_b16 v[62:63], v8 offset:12800
    s_waitcnt lgkmcnt(6)
    v_mfma_f32_32x32x16_bf16 v[80:95], v[48:51], v[184:187], v[80:95]
    ds_read_b64_tr_b16 v[40:41], v5 offset:6144
    ds_read_b64_tr_b16 v[42:43], v5 offset:6656
    s_waitcnt lgkmcnt(6)
    v_mfma_f32_32x32x16_bf16 v[96:111], v[52:55], v[184:187], v[96:111]
    ds_read_b64_tr_b16 v[44:45], v5 offset:14336
    ds_read_b64_tr_b16 v[46:47], v5 offset:14848
    s_waitcnt lgkmcnt(6)
    v_mfma_f32_32x32x16_bf16 v[112:127], v[56:59], v[184:187], v[112:127]
    ds_read_b64_tr_b16 v[48:49], v8 offset:6144
    ds_read_b64_tr_b16 v[50:51], v8 offset:6656
    s_waitcnt lgkmcnt(6)
    v_mfma_f32_32x32x16_bf16 v[128:143], v[60:63], v[184:187], v[128:143]
    ds_read_b64_tr_b16 v[52:53], v8 offset:14336
    ds_read_b64_tr_b16 v[54:55], v8 offset:14848
    s_waitcnt lgkmcnt(6)
    v_mfma_f32_32x32x16_bf16 v[80:95], v[40:43], v[188:191], v[80:95]
    s_barrier
    ds_read_b64_tr_b16 v[56:57], v6 offset:8192
    ds_read_b64_tr_b16 v[58:59], v6 offset:8704
    s_waitcnt lgkmcnt(6)
    v_mfma_f32_32x32x16_bf16 v[96:111], v[44:47], v[188:191], v[96:111]
    ds_read_b64_tr_b16 v[60:61], v5 offset:16384
    ds_read_b64_tr_b16 v[62:63], v5 offset:16896
    s_waitcnt lgkmcnt(6)
    v_mfma_f32_32x32x16_bf16 v[112:127], v[48:51], v[188:191], v[112:127]
    ds_read_b64_tr_b16 v[40:41], v9 offset:8192
    ds_read_b64_tr_b16 v[42:43], v9 offset:8704
    s_waitcnt lgkmcnt(6)
    v_mfma_f32_32x32x16_bf16 v[128:143], v[52:55], v[188:191], v[128:143]
    ds_read_b64_tr_b16 v[44:45], v8 offset:16384
    ds_read_b64_tr_b16 v[46:47], v8 offset:16896
    s_waitcnt lgkmcnt(6)
    v_mfma_f32_32x32x16_bf16 v[80:95], v[56:59], v[192:195], v[80:95]
    ds_read_b64_tr_b16 v[48:49], v6 offset:10240
    ds_read_b64_tr_b16 v[50:51], v6 offset:10752
    s_waitcnt lgkmcnt(6)
    v_mfma_f32_32x32x16_bf16 v[96:111], v[60:63], v[192:195], v[96:111]
    ds_read_b64_tr_b16 v[52:53], v5 offset:18432
    ds_read_b64_tr_b16 v[54:55], v5 offset:18944
    s_waitcnt lgkmcnt(6)
    v_mfma_f32_32x32x16_bf16 v[112:127], v[40:43], v[192:195], v[112:127]
    ds_read_b64_tr_b16 v[56:57], v9 offset:10240
    ds_read_b64_tr_b16 v[58:59], v9 offset:10752
    s_waitcnt lgkmcnt(6)
    v_mfma_f32_32x32x16_bf16 v[128:143], v[44:47], v[192:195], v[128:143]
    ds_read_b64_tr_b16 v[60:61], v8 offset:18432
    ds_read_b64_tr_b16 v[62:63], v8 offset:18944
    s_waitcnt lgkmcnt(6)
    v_mfma_f32_32x32x16_bf16 v[80:95], v[48:51], v[196:199], v[80:95]
    ds_read_b64_tr_b16 v[40:41], v6 offset:12288
    ds_read_b64_tr_b16 v[42:43], v6 offset:12800
    s_waitcnt lgkmcnt(6)
    v_mfma_f32_32x32x16_bf16 v[96:111], v[52:55], v[196:199], v[96:111]
    ds_read_b64_tr_b16 v[44:45], v5 offset:20480
    ds_read_b64_tr_b16 v[46:47], v5 offset:20992
    s_waitcnt lgkmcnt(6)
    v_mfma_f32_32x32x16_bf16 v[112:127], v[56:59], v[196:199], v[112:127]
    ds_read_b64_tr_b16 v[48:49], v9 offset:12288
    ds_read_b64_tr_b16 v[50:51], v9 offset:12800
    s_waitcnt lgkmcnt(6)
    v_mfma_f32_32x32x16_bf16 v[128:143], v[60:63], v[196:199], v[128:143]
    ds_read_b64_tr_b16 v[52:53], v8 offset:20480
    ds_read_b64_tr_b16 v[54:55], v8 offset:20992
    s_waitcnt lgkmcnt(6)
    v_mfma_f32_32x32x16_bf16 v[80:95], v[40:43], v[200:203], v[80:95]
    ds_read_b64_tr_b16 v[56:57], v6 offset:14336
    ds_read_b64_tr_b16 v[58:59], v6 offset:14848
    s_waitcnt lgkmcnt(6)
    v_mfma_f32_32x32x16_bf16 v[96:111], v[44:47], v[200:203], v[96:111]
    ds_read_b64_tr_b16 v[60:61], v5 offset:22528
    ds_read_b64_tr_b16 v[62:63], v5 offset:23040
    s_waitcnt lgkmcnt(6)
    v_mfma_f32_32x32x16_bf16 v[112:127], v[48:51], v[200:203], v[112:127]
    ds_read_b64_tr_b16 v[40:41], v9 offset:14336
    ds_read_b64_tr_b16 v[42:43], v9 offset:14848
    s_waitcnt lgkmcnt(6)
    v_mfma_f32_32x32x16_bf16 v[128:143], v[52:55], v[200:203], v[128:143]
    ds_read_b64_tr_b16 v[44:45], v8 offset:22528
    ds_read_b64_tr_b16 v[46:47], v8 offset:23040
    s_waitcnt lgkmcnt(6)
    v_mfma_f32_32x32x16_bf16 v[80:95], v[56:59], v[204:207], v[80:95]
    s_barrier
    ds_read_b64_tr_b16 v[48:49], v6 offset:16384
    ds_read_b64_tr_b16 v[50:51], v6 offset:16896
    s_waitcnt lgkmcnt(6)
    v_mfma_f32_32x32x16_bf16 v[96:111], v[60:63], v[204:207], v[96:111]
    ds_read_b64_tr_b16 v[52:53], v6 offset:24576
    ds_read_b64_tr_b16 v[54:55], v6 offset:25088
    s_waitcnt lgkmcnt(6)
    v_mfma_f32_32x32x16_bf16 v[112:127], v[40:43], v[204:207], v[112:127]
    ds_read_b64_tr_b16 v[56:57], v9 offset:16384
    ds_read_b64_tr_b16 v[58:59], v9 offset:16896
    s_waitcnt lgkmcnt(6)
    v_mfma_f32_32x32x16_bf16 v[128:143], v[44:47], v[204:207], v[128:143]
    ds_read_b64_tr_b16 v[60:61], v9 offset:24576
    ds_read_b64_tr_b16 v[62:63], v9 offset:25088
    s_waitcnt lgkmcnt(6)
    v_mfma_f32_32x32x16_bf16 v[80:95], v[48:51], v[208:211], v[80:95]
    ds_read_b64_tr_b16 v[40:41], v6 offset:18432
    ds_read_b64_tr_b16 v[42:43], v6 offset:18944
    s_waitcnt lgkmcnt(6)
    v_mfma_f32_32x32x16_bf16 v[96:111], v[52:55], v[208:211], v[96:111]
    ds_read_b64_tr_b16 v[44:45], v6 offset:26624
    ds_read_b64_tr_b16 v[46:47], v6 offset:27136
    s_waitcnt lgkmcnt(6)
    v_mfma_f32_32x32x16_bf16 v[112:127], v[56:59], v[208:211], v[112:127]
    ds_read_b64_tr_b16 v[48:49], v9 offset:18432
    ds_read_b64_tr_b16 v[50:51], v9 offset:18944
    s_waitcnt lgkmcnt(6)
    v_mfma_f32_32x32x16_bf16 v[128:143], v[60:63], v[208:211], v[128:143]
    ds_read_b64_tr_b16 v[52:53], v9 offset:26624
    ds_read_b64_tr_b16 v[54:55], v9 offset:27136
    s_waitcnt lgkmcnt(6)
    v_mfma_f32_32x32x16_bf16 v[80:95], v[40:43], v[212:215], v[80:95]
    ds_read_b64_tr_b16 v[56:57], v6 offset:20480
    ds_read_b64_tr_b16 v[58:59], v6 offset:20992
    s_waitcnt lgkmcnt(6)
    v_mfma_f32_32x32x16_bf16 v[96:111], v[44:47], v[212:215], v[96:111]
    ds_read_b64_tr_b16 v[60:61], v6 offset:28672
    ds_read_b64_tr_b16 v[62:63], v6 offset:29184
    s_waitcnt lgkmcnt(6)
    v_mfma_f32_32x32x16_bf16 v[112:127], v[48:51], v[212:215], v[112:127]
    ds_read_b64_tr_b16 v[40:41], v9 offset:20480
    ds_read_b64_tr_b16 v[42:43], v9 offset:20992
    s_waitcnt lgkmcnt(6)
    v_mfma_f32_32x32x16_bf16 v[128:143], v[52:55], v[212:215], v[128:143]
    ds_read_b64_tr_b16 v[44:45], v9 offset:28672
    ds_read_b64_tr_b16 v[46:47], v9 offset:29184
    s_waitcnt lgkmcnt(6)
    v_mfma_f32_32x32x16_bf16 v[80:95], v[56:59], v[216:219], v[80:95]
    ds_read_b64_tr_b16 v[48:49], v6 offset:22528
    ds_read_b64_tr_b16 v[50:51], v6 offset:23040
    s_waitcnt lgkmcnt(6)
    v_mfma_f32_32x32x16_bf16 v[96:111], v[60:63], v[216:219], v[96:111]
    ds_read_b64_tr_b16 v[52:53], v6 offset:30720
    ds_read_b64_tr_b16 v[54:55], v6 offset:31232
    s_waitcnt lgkmcnt(6)
    v_mfma_f32_32x32x16_bf16 v[112:127], v[40:43], v[216:219], v[112:127]
    ds_read_b64_tr_b16 v[56:57], v9 offset:22528
    ds_read_b64_tr_b16 v[58:59], v9 offset:23040
    s_waitcnt lgkmcnt(6)
    v_mfma_f32_32x32x16_bf16 v[128:143], v[44:47], v[216:219], v[128:143]
    ds_read_b64_tr_b16 v[60:61], v9 offset:30720
    ds_read_b64_tr_b16 v[62:63], v9 offset:31232
    s_waitcnt lgkmcnt(6)
    v_mfma_f32_32x32x16_bf16 v[80:95], v[48:51], v[220:223], v[80:95]
    ds_read_b64_tr_b16 v[40:41], v6 offset:32768
    ds_read_b64_tr_b16 v[42:43], v6 offset:33280
    s_waitcnt lgkmcnt(6)
    v_mfma_f32_32x32x16_bf16 v[96:111], v[52:55], v[220:223], v[96:111]
    ds_read_b64_tr_b16 v[44:45], v6 offset:40960
    ds_read_b64_tr_b16 v[46:47], v6 offset:41472
    s_waitcnt lgkmcnt(6)
    v_mfma_f32_32x32x16_bf16 v[112:127], v[56:59], v[220:223], v[112:127]
    ds_read_b64_tr_b16 v[48:49], v9 offset:32768
    ds_read_b64_tr_b16 v[50:51], v9 offset:33280
    s_waitcnt lgkmcnt(6)
    v_mfma_f32_32x32x16_bf16 v[128:143], v[60:63], v[220:223], v[128:143]
    ds_read_b64_tr_b16 v[52:53], v9 offset:40960
    ds_read_b64_tr_b16 v[54:55], v9 offset:41472
    s_waitcnt lgkmcnt(6)
    v_mfma_f32_32x32x16_bf16 v[80:95], v[40:43], v[224:227], v[80:95]
    ds_read_b64_tr_b16 v[56:57], v6 offset:34816
    ds_read_b64_tr_b16 v[58:59], v6 offset:35328
    s_waitcnt lgkmcnt(6)
    v_mfma_f32_32x32x16_bf16 v[96:111], v[44:47], v[224:227], v[96:111]
    ds_read_b64_tr_b16 v[60:61], v6 offset:43008
    ds_read_b64_tr_b16 v[62:63], v6 offset:43520
    s_waitcnt lgkmcnt(6)
    v_mfma_f32_32x32x16_bf16 v[112:127], v[48:51], v[224:227], v[112:127]
    ds_read_b64_tr_b16 v[40:41], v9 offset:34816
    ds_read_b64_tr_b16 v[42:43], v9 offset:35328
    s_waitcnt lgkmcnt(6)
    v_mfma_f32_32x32x16_bf16 v[128:143], v[52:55], v[224:227], v[128:143]
    ds_read_b64_tr_b16 v[44:45], v9 offset:43008
    ds_read_b64_tr_b16 v[46:47], v9 offset:43520
    s_waitcnt lgkmcnt(6)
    v_mfma_f32_32x32x16_bf16 v[80:95], v[56:59], v[228:231], v[80:95]
    ds_read_b64_tr_b16 v[48:49], v6 offset:36864
    ds_read_b64_tr_b16 v[50:51], v6 offset:37376
    s_waitcnt lgkmcnt(6)
    v_mfma_f32_32x32x16_bf16 v[96:111], v[60:63], v[228:231], v[96:111]
    ds_read_b64_tr_b16 v[52:53], v6 offset:45056
    ds_read_b64_tr_b16 v[54:55], v6 offset:45568
    s_waitcnt lgkmcnt(6)
    v_mfma_f32_32x32x16_bf16 v[112:127], v[40:43], v[228:231], v[112:127]
    ds_read_b64_tr_b16 v[56:57], v9 offset:36864
    ds_read_b64_tr_b16 v[58:59], v9 offset:37376
    s_waitcnt lgkmcnt(6)
    v_mfma_f32_32x32x16_bf16 v[128:143], v[44:47], v[228:231], v[128:143]
    ds_read_b64_tr_b16 v[60:61], v9 offset:45056
    ds_read_b64_tr_b16 v[62:63], v9 offset:45568
    s_waitcnt lgkmcnt(6)
    v_mfma_f32_32x32x16_bf16 v[80:95], v[48:51], v[232:235], v[80:95]
    ds_read_b64_tr_b16 v[40:41], v6 offset:38912
    ds_read_b64_tr_b16 v[42:43], v6 offset:39424
    s_waitcnt lgkmcnt(6)
    v_mfma_f32_32x32x16_bf16 v[96:111], v[52:55], v[232:235], v[96:111]
    ds_read_b64_tr_b16 v[44:45], v6 offset:47104
    ds_read_b64_tr_b16 v[46:47], v6 offset:47616
    s_waitcnt lgkmcnt(6)
    v_mfma_f32_32x32x16_bf16 v[112:127], v[56:59], v[232:235], v[112:127]
    ds_read_b64_tr_b16 v[48:49], v9 offset:38912
    ds_read_b64_tr_b16 v[50:51], v9 offset:39424
    s_waitcnt lgkmcnt(6)
    v_mfma_f32_32x32x16_bf16 v[128:143], v[60:63], v[232:235], v[128:143]
    ds_read_b64_tr_b16 v[52:53], v9 offset:47104
    ds_read_b64_tr_b16 v[54:55], v9 offset:47616
    s_waitcnt lgkmcnt(6)
    v_mfma_f32_32x32x16_bf16 v[80:95], v[40:43], v[236:239], v[80:95]
    ds_read_b64_tr_b16 v[56:57], v5 offset:24576
    ds_read_b64_tr_b16 v[58:59], v5 offset:25088
    s_waitcnt lgkmcnt(6)
    v_mfma_f32_32x32x16_bf16 v[96:111], v[44:47], v[236:239], v[96:111]
    ds_read_b64_tr_b16 v[60:61], v5 offset:32768
    ds_read_b64_tr_b16 v[62:63], v5 offset:33280
    s_waitcnt lgkmcnt(6)
    v_mfma_f32_32x32x16_bf16 v[112:127], v[48:51], v[236:239], v[112:127]
    ds_read_b64_tr_b16 v[40:41], v8 offset:24576
    ds_read_b64_tr_b16 v[42:43], v8 offset:25088
    s_waitcnt lgkmcnt(6)
    v_mfma_f32_32x32x16_bf16 v[128:143], v[52:55], v[236:239], v[128:143]
    ds_read_b64_tr_b16 v[44:45], v8 offset:32768
    ds_read_b64_tr_b16 v[46:47], v8 offset:33280
    s_waitcnt lgkmcnt(6)
    v_mfma_f32_32x32x16_bf16 v[80:95], v[56:59], v[240:243], v[80:95]
    ds_read_b64_tr_b16 v[48:49], v5 offset:26624
    ds_read_b64_tr_b16 v[50:51], v5 offset:27136
    s_waitcnt lgkmcnt(6)
    v_mfma_f32_32x32x16_bf16 v[96:111], v[60:63], v[240:243], v[96:111]
    ds_read_b64_tr_b16 v[52:53], v5 offset:34816
    ds_read_b64_tr_b16 v[54:55], v5 offset:35328
    s_waitcnt lgkmcnt(6)
    v_mfma_f32_32x32x16_bf16 v[112:127], v[40:43], v[240:243], v[112:127]
    ds_read_b64_tr_b16 v[56:57], v8 offset:26624
    ds_read_b64_tr_b16 v[58:59], v8 offset:27136
    s_waitcnt lgkmcnt(6)
    v_mfma_f32_32x32x16_bf16 v[128:143], v[44:47], v[240:243], v[128:143]
    ds_read_b64_tr_b16 v[60:61], v8 offset:34816
    ds_read_b64_tr_b16 v[62:63], v8 offset:35328
    s_waitcnt lgkmcnt(6)
    v_mfma_f32_32x32x16_bf16 v[80:95], v[48:51], v[244:247], v[80:95]
    ds_read_b64_tr_b16 v[40:41], v5 offset:28672
    ds_read_b64_tr_b16 v[42:43], v5 offset:29184
    s_waitcnt lgkmcnt(6)
    v_mfma_f32_32x32x16_bf16 v[96:111], v[52:55], v[244:247], v[96:111]
    ds_read_b64_tr_b16 v[44:45], v5 offset:36864
    ds_read_b64_tr_b16 v[46:47], v5 offset:37376
    s_waitcnt lgkmcnt(6)
    v_mfma_f32_32x32x16_bf16 v[112:127], v[56:59], v[244:247], v[112:127]
    ds_read_b64_tr_b16 v[48:49], v8 offset:28672
    ds_read_b64_tr_b16 v[50:51], v8 offset:29184
    s_waitcnt lgkmcnt(6)
    v_mfma_f32_32x32x16_bf16 v[128:143], v[60:63], v[244:247], v[128:143]
    ds_read_b64_tr_b16 v[52:53], v8 offset:36864
    ds_read_b64_tr_b16 v[54:55], v8 offset:37376
    s_waitcnt lgkmcnt(6)
    v_mfma_f32_32x32x16_bf16 v[80:95], v[40:43], v[248:251], v[80:95]
    ds_read_b64_tr_b16 v[56:57], v5 offset:30720
    ds_read_b64_tr_b16 v[58:59], v5 offset:31232
    s_waitcnt lgkmcnt(6)
    v_mfma_f32_32x32x16_bf16 v[96:111], v[44:47], v[248:251], v[96:111]
    ds_read_b64_tr_b16 v[60:61], v5 offset:38912
    ds_read_b64_tr_b16 v[62:63], v5 offset:39424
    s_waitcnt lgkmcnt(6)
    v_mfma_f32_32x32x16_bf16 v[112:127], v[48:51], v[248:251], v[112:127]
    ds_read_b64_tr_b16 v[40:41], v8 offset:30720
    ds_read_b64_tr_b16 v[42:43], v8 offset:31232
    s_waitcnt lgkmcnt(6)
    v_mfma_f32_32x32x16_bf16 v[128:143], v[52:55], v[248:251], v[128:143]
    ds_read_b64_tr_b16 v[44:45], v8 offset:38912
    ds_read_b64_tr_b16 v[46:47], v8 offset:39424
    s_waitcnt lgkmcnt(6)
    v_mfma_f32_32x32x16_bf16 v[80:95], v[56:59], v[252:255], v[80:95]
    s_barrier
    s_waitcnt lgkmcnt(4)
    v_mfma_f32_32x32x16_bf16 v[96:111], v[60:63], v[252:255], v[96:111]
    s_waitcnt lgkmcnt(2)
    v_mfma_f32_32x32x16_bf16 v[112:127], v[40:43], v[252:255], v[112:127]
    s_waitcnt lgkmcnt(0)
    v_mfma_f32_32x32x16_bf16 v[128:143], v[44:47], v[252:255], v[128:143]
    v_mul_f32 v37, 0x3fb8aa3b, v32
    v_exp_f32 v37, v37
    s_nop 0
    v_add_f32 v37, 1.0, v37
    v_min_f32 v37, 0x7149f2ca, v37
    v_mov_b32 v32, v37
    s_nop 1
    v_permlane32_swap_b32 v37, v32
    v_mov_b32 v35, 2147418112
    v_writelane_b32 v35, 0, 0
    buffer_load_dword v36, v35, s[32:35], 0 offen sc1
    v_add_u32 v28, 114688, v1
    v_add_u32 v29, 28672, v2
    v_add_u32 v30, 25088, v3
    v_mul_f32 v20, 0xbfb8aa3b, v80
    s_mulk_i32 s88, 1792
    s_mulk_i32 s89, 1792
    s_mulk_i32 s90, 1792
    s_mulk_i32 s91, 1792
    s_mulk_i32 s92, 1792
    s_mulk_i32 s93, 1792
    s_mulk_i32 s94, 1792
    v_add_u32 v28, 114688, v1
    v_mul_f32 v21, 0xbfb8aa3b, v81
    v_mul_f32 v80, v80, v96
    v_mul_f32 v81, v81, v97
    v_exp_f32 v20, v20
    v_exp_f32 v21, v21
    v_mul_f32 v22, 0xbfb8aa3b, v82
    v_mul_f32 v23, 0xbfb8aa3b, v83
    v_mul_f32 v82, v82, v98
    v_mul_f32 v83, v83, v99
    v_fma_f32 v20, v20, v32, v32
    v_fma_f32 v21, v21, v32, v32
    v_exp_f32 v22, v22
    v_exp_f32 v23, v23
    v_rcp_f32 v20, v20
    v_rcp_f32 v21, v21
    v_mul_f32 v24, 0xbfb8aa3b, v84
    v_mul_f32 v25, 0xbfb8aa3b, v85
    v_mul_f32 v84, v84, v100
    v_mul_f32 v85, v85, v101
    v_fma_f32 v22, v22, v32, v32
    v_fma_f32 v23, v23, v32, v32
    v_add_u32 v1, 128, v1
    v_add_u32 v28, 114688, v1
    v_mul_f32 v80, v80, v20
    v_mul_f32 v81, v81, v21
    v_exp_f32 v24, v24
    v_exp_f32 v25, v25
    v_rcp_f32 v22, v22
    v_rcp_f32 v23, v23
    v_cvt_pk_bf16_f32 v12, v80, v81
    v_mul_f32 v26, 0xbfb8aa3b, v86
    v_mul_f32 v27, 0xbfb8aa3b, v87
    v_mul_f32 v86, v86, v102
    v_mul_f32 v87, v87, v103
    v_fma_f32 v24, v24, v32, v32
    v_fma_f32 v25, v25, v32, v32
    v_mul_f32 v82, v82, v22
    v_mul_f32 v83, v83, v23
    v_exp_f32 v26, v26
    v_exp_f32 v27, v27
    v_rcp_f32 v24, v24
    v_rcp_f32 v25, v25
    s_add_u32 m0, s73, 16384
    v_cvt_pk_bf16_f32 v13, v82, v83
    buffer_load_dwordx4 v1, s[8:11], s94 offen lds
    v_mul_f32 v20, 0xbfb8aa3b, v88
    v_mul_f32 v21, 0xbfb8aa3b, v89
    v_mul_f32 v88, v88, v104
    v_mul_f32 v89, v89, v105
    v_fma_f32 v26, v26, v32, v32
    v_fma_f32 v27, v27, v32, v32
    v_mul_f32 v84, v84, v24
    v_mul_f32 v85, v85, v25
    v_exp_f32 v20, v20
    v_exp_f32 v21, v21
    v_rcp_f32 v26, v26
    v_rcp_f32 v27, v27
    v_cvt_pk_bf16_f32 v14, v84, v85
    v_mul_f32 v22, 0xbfb8aa3b, v90
    v_mul_f32 v23, 0xbfb8aa3b, v91
    v_mul_f32 v90, v90, v106
    v_mul_f32 v91, v91, v107
    v_fma_f32 v20, v20, v32, v32
    v_fma_f32 v21, v21, v32, v32
    v_mul_f32 v86, v86, v26
    s_add_u32 m0, s73, 20480
    v_mul_f32 v87, v87, v27
    buffer_load_dwordx4 v28, s[8:11], s94 offen lds
    v_exp_f32 v22, v22
    v_exp_f32 v23, v23
    v_rcp_f32 v20, v20
    v_rcp_f32 v21, v21
    v_cvt_pk_bf16_f32 v15, v86, v87
    buffer_store_dwordx4 v[12:15], v0, s[28:31], s40 offen offset:0 sc1
    v_mul_f32 v24, 0xbfb8aa3b, v92
    v_mul_f32 v25, 0xbfb8aa3b, v93
    v_mul_f32 v92, v92, v108
    v_mul_f32 v93, v93, v109
    v_fma_f32 v22, v22, v32, v32
    v_fma_f32 v23, v23, v32, v32
    v_mul_f32 v88, v88, v20
    v_mul_f32 v89, v89, v21
    v_exp_f32 v24, v24
    v_exp_f32 v25, v25
    v_rcp_f32 v22, v22
    v_rcp_f32 v23, v23
    v_cvt_pk_bf16_f32 v16, v88, v89
    s_add_u32 m0, s73, 73728
    v_mul_f32 v26, 0xbfb8aa3b, v94
    buffer_load_dwordx4 v1, s[12:15], s94 offen lds
    v_mul_f32 v27, 0xbfb8aa3b, v95
    v_mul_f32 v94, v94, v110
    v_mul_f32 v95, v95, v111
    v_fma_f32 v24, v24, v32, v32
    v_fma_f32 v25, v25, v32, v32
    v_mul_f32 v90, v90, v22
    v_mul_f32 v91, v91, v23
    v_exp_f32 v26, v26
    v_exp_f32 v27, v27
    v_rcp_f32 v24, v24
    v_rcp_f32 v25, v25
    v_cvt_pk_bf16_f32 v17, v90, v91
    v_fma_f32 v26, v26, v32, v32
    v_fma_f32 v27, v27, v32, v32
    v_mul_f32 v92, v92, v24
    v_mul_f32 v93, v93, v25
    v_rcp_f32 v26, v26
    v_rcp_f32 v27, v27
    v_cvt_pk_bf16_f32 v18, v92, v93
    v_mul_f32 v94, v94, v26
    s_add_u32 m0, s73, 77824
    v_mul_f32 v95, v95, v27
    buffer_load_dwordx4 v28, s[12:15], s94 offen lds
    v_cvt_pk_bf16_f32 v19, v94, v95
    buffer_store_dwordx4 v[16:19], v0, s[28:31], s40 offen offset:1024 sc1
    v_mul_f32 v20, 0xbfb8aa3b, v112
    v_mul_f32 v21, 0xbfb8aa3b, v113
    v_mul_f32 v112, v112, v128
    v_mul_f32 v113, v113, v129
    v_exp_f32 v20, v20
    v_exp_f32 v21, v21
    v_mul_f32 v22, 0xbfb8aa3b, v114
    v_mul_f32 v23, 0xbfb8aa3b, v115
    v_mul_f32 v114, v114, v130
    v_mul_f32 v115, v115, v131
    v_fma_f32 v20, v20, v32, v32
    v_fma_f32 v21, v21, v32, v32
    v_exp_f32 v22, v22
    v_exp_f32 v23, v23
    v_rcp_f32 v20, v20
    v_rcp_f32 v21, v21
    v_mul_f32 v24, 0xbfb8aa3b, v116
    v_mul_f32 v25, 0xbfb8aa3b, v117
    s_add_u32 m0, s73, 81920
    v_mul_f32 v116, v116, v132
    buffer_load_dwordx4 v2, s[20:23], s95 offen lds
    v_mul_f32 v117, v117, v133
    v_fma_f32 v22, v22, v32, v32
    v_fma_f32 v23, v23, v32, v32
    v_mul_f32 v112, v112, v20
    v_mul_f32 v113, v113, v21
    v_exp_f32 v24, v24
    v_exp_f32 v25, v25
    s_add_u32 m0, s73, 86016
    s_nop 0
    buffer_load_dwordx4 v29, s[20:23], s95 offen lds
    s_add_u32 s95, s95, s97
    s_add_u32 m0, s73, 90112
    s_nop 0
    buffer_load_dwordx4 v2, s[20:23], s95 offen lds
    s_add_u32 m0, s73, 94208
    s_nop 0
    buffer_load_dwordx4 v29, s[20:23], s95 offen lds
    s_add_u32 s95, s95, s97
    s_barrier
    v_rcp_f32 v22, v22
    v_rcp_f32 v23, v23
    v_cvt_pk_bf16_f32 v12, v112, v113
    v_mul_f32 v26, 0xbfb8aa3b, v118
    v_mul_f32 v27, 0xbfb8aa3b, v119
    v_mul_f32 v118, v118, v134
    v_mul_f32 v119, v119, v135
    v_fma_f32 v24, v24, v32, v32
    v_fma_f32 v25, v25, v32, v32
    v_mul_f32 v114, v114, v22
    v_mul_f32 v115, v115, v23
    v_exp_f32 v26, v26
    v_exp_f32 v27, v27
    s_add_u32 m0, s73, 24576
    v_rcp_f32 v24, v24
    buffer_load_dwordx4 v2, s[20:23], s95 offen lds
    v_rcp_f32 v25, v25
    v_cvt_pk_bf16_f32 v13, v114, v115
    v_mul_f32 v20, 0xbfb8aa3b, v120
    v_mul_f32 v21, 0xbfb8aa3b, v121
    v_mul_f32 v120, v120, v136
    v_mul_f32 v121, v121, v137
    v_fma_f32 v26, v26, v32, v32
    v_fma_f32 v27, v27, v32, v32
    v_mul_f32 v116, v116, v24
    v_mul_f32 v117, v117, v25
    v_exp_f32 v20, v20
    v_exp_f32 v21, v21
    v_rcp_f32 v26, v26
    v_rcp_f32 v27, v27
    v_cvt_pk_bf16_f32 v14, v116, v117
    v_mul_f32 v22, 0xbfb8aa3b, v122
    v_mul_f32 v23, 0xbfb8aa3b, v123
    v_mul_f32 v122, v122, v138
    v_mul_f32 v123, v123, v139
    v_fma_f32 v20, v20, v32, v32
    s_add_u32 m0, s73, 28672
    v_fma_f32 v21, v21, v32, v32
    buffer_load_dwordx4 v29, s[20:23], s95 offen lds
    s_add_u32 s95, s95, s97
    v_mul_f32 v118, v118, v26
    v_mul_f32 v119, v119, v27
    v_exp_f32 v22, v22
    v_exp_f32 v23, v23
    v_rcp_f32 v20, v20
    v_rcp_f32 v21, v21
    v_cvt_pk_bf16_f32 v15, v118, v119
    buffer_store_dwordx4 v[12:15], v0, s[28:31], s40 offen offset:2048 sc1
    v_mul_f32 v24, 0xbfb8aa3b, v124
    v_mul_f32 v25, 0xbfb8aa3b, v125
    v_mul_f32 v124, v124, v140
    v_mul_f32 v125, v125, v141
    v_fma_f32 v22, v22, v32, v32
    v_fma_f32 v23, v23, v32, v32
    v_mul_f32 v120, v120, v20
    v_mul_f32 v121, v121, v21
    v_exp_f32 v24, v24
    v_exp_f32 v25, v25
    v_rcp_f32 v22, v22
    s_add_u32 m0, s73, 32768
    v_rcp_f32 v23, v23
    buffer_load_dwordx4 v2, s[20:23], s95 offen lds
    v_cvt_pk_bf16_f32 v16, v120, v121
    v_mul_f32 v26, 0xbfb8aa3b, v126
    v_mul_f32 v27, 0xbfb8aa3b, v127
    v_mul_f32 v126, v126, v142
    v_mul_f32 v127, v127, v143
    v_fma_f32 v24, v24, v32, v32
    v_fma_f32 v25, v25, v32, v32
    v_mul_f32 v122, v122, v22
    v_mul_f32 v123, v123, v23
    v_exp_f32 v26, v26
    v_exp_f32 v27, v27
    v_rcp_f32 v24, v24
    v_rcp_f32 v25, v25
    v_cvt_pk_bf16_f32 v17, v122, v123
    v_fma_f32 v26, v26, v32, v32
    v_fma_f32 v27, v27, v32, v32
    v_mul_f32 v124, v124, v24
    v_mul_f32 v125, v125, v25
    v_rcp_f32 v26, v26
    v_rcp_f32 v27, v27
    s_add_u32 m0, s73, 36864
    v_cvt_pk_bf16_f32 v18, v124, v125
    buffer_load_dwordx4 v29, s[20:23], s95 offen lds
    s_add_u32 s95, s95, s97
    v_mul_f32 v126, v126, v26
    v_mul_f32 v127, v127, v27
    v_cvt_pk_bf16_f32 v19, v126, v127
    buffer_store_dwordx4 v[16:19], v0, s[28:31], s40 offen offset:3072 sc1
    s_waitcnt vmcnt(16)
    s_mov_b32 s83, 0
L_FA_spin1:
    v_cmp_eq_u32 vcc, 0, v36
    s_nop 0
    s_and_b64 vcc, vcc, 1
    s_cbranch_vccz L_FA_ok2
    buffer_load_dword v36, v35, s[32:35], 0 offen sc1
    s_add_u32 s83, s83, 1
    s_cmp_lt_u32 s83, 1000000
    s_waitcnt vmcnt(0)
    s_cbranch_scc1 L_FA_spin1
L_FA_ok2:
    v_readfirstlane_b32 s81, v36
    s_nop 1
    v_mov_b32 v34, s81
    s_mov_b32 s59, 0
    s_mov_b32 s60, s54
    s_mov_b32 s61, s55
    s_mov_b32 s62, 1835008
    s_mov_b32 s63, 0x20000
    s_mov_b32 s58, 0x3fff
    s_bitset0_b32 s58, s2
    s_lshl2_add_u32 s79, s75, s45
    s_lshl4_add_u32 s79, s79, s2
    s_mul_i32 s46, s79, 128
    s_add_u32 s46, s46, 18087936
    s_and_b32 s44, s45, 1
    s_add_u32 m0, s73, 40960
    s_nop 0
    buffer_load_dwordx4 v2, s[20:23], s95 offen lds
    s_add_u32 m0, s73, 45056
    s_nop 0
    buffer_load_dwordx4 v29, s[20:23], s95 offen lds
    s_add_u32 s95, s95, s97
    s_add_u32 m0, s73, 49152
    s_nop 0
    buffer_load_dwordx4 v2, s[20:23], s95 offen lds
    s_add_u32 m0, s73, 53248
    s_nop 0
    buffer_load_dwordx4 v29, s[20:23], s95 offen lds
    s_add_u32 s95, s95, s97
    s_add_u32 m0, s73, 57344
    s_nop 0
    buffer_load_dwordx4 v2, s[20:23], s95 offen lds
    s_add_u32 m0, s73, 61440
    s_nop 0
    buffer_load_dwordx4 v29, s[20:23], s95 offen lds
    s_add_u32 s95, s95, s97
    s_mov_b32 s95, 57344
    s_add_u32 m0, s73, 65536
    s_nop 0
    buffer_load_dwordx4 v2, s[20:23], s95 offen lds
    s_add_u32 m0, s73, 69632
    s_nop 0
    buffer_load_dwordx4 v29, s[20:23], s95 offen lds
    s_add_u32 s95, s95, s97
    s_barrier
    s_waitcnt vmcnt(8)
    buffer_store_dword v34, v33, s[28:31], s46 offen sc1
    s_add_u32 m0, s73, 0
    s_nop 0
    buffer_load_dwordx4 v2, s[20:23], s95 offen lds
    s_add_u32 m0, s73, 4096
    s_nop 0
    buffer_load_dwordx4 v29, s[20:23], s95 offen lds
    s_add_u32 s95, s95, s97
    s_add_u32 m0, s73, 8192
    s_nop 0
    buffer_load_dwordx4 v2, s[20:23], s95 offen lds
    s_add_u32 m0, s73, 12288
    s_nop 0
    buffer_load_dwordx4 v29, s[20:23], s95 offen lds
    s_add_u32 s95, s95, s97
    s_add_u32 m0, s73, 98304
    s_nop 0
    buffer_load_dwordx4 v2, s[20:23], s95 offen lds
    s_add_u32 m0, s73, 102400
    s_nop 0
    buffer_load_dwordx4 v29, s[20:23], s95 offen lds
    s_add_u32 s95, s95, s97
    s_add_u32 m0, s73, 106496
    s_nop 0
    buffer_load_dwordx4 v2, s[20:23], s95 offen lds
    s_add_u32 m0, s73, 110592
    s_nop 0
    buffer_load_dwordx4 v29, s[20:23], s95 offen lds
    s_add_u32 s95, s95, s97
    s_barrier
    s_lshr_b32 s41, s56, 1
    s_add_u32 m0, s73, 114688
    s_nop 0
    buffer_load_dwordx4 v2, s[20:23], s95 offen lds
    s_mul_i32 s41, s41, 1540096
    s_mul_i32 s80, s56, 32768
    s_add_u32 s41, s41, s80
    s_mul_i32 s80, s57, 786432
    s_add_u32 s41, s41, s80
    s_mul_i32 s80, s44, 7168
    s_add_u32 s41, s41, s80
    s_mul_i32 s80, s45, 1024
    s_add_u32 s41, s41, s80
    s_add_u32 s41, s41, 16384
    s_lshl2_add_u32 s79, s56, s45
    s_mul_i32 s47, s79, 2048
    s_mul_i32 s80, s57, 896
    s_add_u32 s47, s47, s80
    s_add_u32 m0, s73, 118784
    s_add_u32 s47, s47, 18087936
    buffer_load_dwordx4 v29, s[20:23], s95 offen lds
    s_add_u32 s95, s95, s97
    s_lshl1_add_u32 s44, s56, s57
    s_mul_i32 s49, s44, 57344
    s_mul_i32 s80, s77, 128
    s_add_u32 s49, s49, s80
    s_mul_i32 s50, s44, 3584
    s_mul_i32 s80, s77, 512
    s_add_u32 s50, s50, s80
    s_mul_i32 s80, s45, 128
    s_add_u32 s50, s50, s80
    s_mul_i32 s48, s50, 1
    s_mul_i32 s80, s57, -7168
    s_add_u32 s48, s48, s80
    s_add_u32 m0, s73, 122880
    s_add_u32 s48, s48, 3584
    buffer_load_dwordx4 v2, s[20:23], s95 offen lds
    s_mul_i32 s53, s50, 32
    s_add_u32 s53, s53, 22020096
    s_add_u32 s50, s50, 26214400
    s_mul_i32 s52, s48, 32
    s_add_u32 s52, s52, 22020096
    s_add_u32 s48, s48, 26214400
    s_add_u32 m0, s73, 126976
    s_nop 0
    buffer_load_dwordx4 v29, s[20:23], s95 offen lds
    s_add_u32 s95, s95, s97
    s_mov_b32 s95, 0
    s_add_u32 m0, s73, 131072
    s_nop 0
    buffer_load_dwordx4 v3, s[24:27], s95 offen lds
    s_add_u32 m0, s73, 135168
    s_nop 0
    buffer_load_dwordx4 v30, s[24:27], s95 offen lds
    s_add_u32 s95, s95, s98
    s_add_u32 m0, s73, 139264
    s_nop 0
    buffer_load_dwordx4 v3, s[24:27], s95 offen lds
    s_add_u32 m0, s73, 143360
    s_nop 0
    buffer_load_dwordx4 v30, s[24:27], s95 offen lds
    s_add_u32 s95, s95, s98
    s_barrier
    v_add_u32 v4, s41, v0
    s_add_u32 m0, s73, 147456
    s_nop 0
    buffer_load_dwordx4 v3, s[24:27], s95 offen lds
    v_bfe_u32 v37, v0, 6, 2
    v_lshrrev_b32 v38, 9, v0
    v_lshl_add_u32 v38, v38, 2, v37
    v_lshlrev_b32 v39, 7, v38
    v_and_b32 v37, 0x78, v5
    v_or_b32 v39, v37, v39
    v_lshl_add_u32 v39, s45, 11, v39
    v_and_b32 v39, 0xf7ff, v39
    s_add_u32 m0, s73, 151552
    s_nop 0
    buffer_load_dwordx4 v30, s[24:27], s95 offen lds
    s_add_u32 s95, s95, s98
    s_add_u32 m0, s73, 155648
    s_nop 0
    buffer_load_dwordx4 v3, s[24:27], s95 offen lds
    s_add_u32 m0, s73, 159744
    s_nop 0
    buffer_load_dwordx4 v30, s[24:27], s95 offen lds
    s_add_u32 s95, s95, s98
    s_lshl_b32 s80, s45, 3
    s_lshr_b32 s80, 100992003, s80
    s_and_b32 s80, s80, 0xff
    s_lshl_b32 s80, s80, 13
    v_bfe_u32 v16, v0, 4, 5
    v_lshl_add_u32 v12, v16, 8, s80
    v_lshrrev_b32 v17, 9, v0
    v_xor_b32 v17, v17, v16
    v_and_b32 v17, 7, v17
    v_lshl_or_b32 v12, v17, 4, v12
    v_xor_b32 v13, 32, v12
    v_xor_b32 v14, 64, v12
    v_xor_b32 v15, 96, v12
    v_lshrrev_b32 v16, 7, v0
    v_bfe_u32 v17, v0, 4, 3
    v_lshlrev_b32 v17, 1, v17
    v_xor_b32 v17, v17, v16
    v_lshl_add_u32 v24, s45, 3, v16
    v_lshlrev_b32 v18, 8, v24
    v_lshl_or_b32 v18, v17, 4, v18
    v_xor_b32 v21, 16, v18
    v_add_u32 v19, 0x10000, v18
    v_add_u32 v20, 0x20000, v18
    v_add_u32 v22, 0x10000, v21
    v_add_u32 v23, 0x20000, v21
    v_mul_u32_u24 v24, 896, v24
    v_and_b32 v17, 0x70, v0
    v_add_u32 v24, v24, v17
    s_barrier
    s_add_u32 s100, s28, s47
    s_addc_u32 s101, s29, 0
    s_load_dword s4, s[100:101], 0 glc
    s_load_dword s5, s[100:101], 128 glc
    s_load_dword s6, s[100:101], 256 glc
    s_load_dword s7, s[100:101], 384 glc
    s_load_dword s16, s[100:101], 512 glc
    s_load_dword s17, s[100:101], 640 glc
    s_load_dword s18, s[100:101], 768 glc
    s_add_u32 m0, s73, 16384
    s_nop 0
    buffer_load_dwordx4 v3, s[24:27], s95 offen lds
    s_add_u32 m0, s73, 20480
    s_nop 0
    buffer_load_dwordx4 v30, s[24:27], s95 offen lds
    s_add_u32 s95, s95, s98
    s_add_u32 m0, s73, 73728
    s_nop 0
    buffer_load_dwordx4 v3, s[24:27], s95 offen lds
    s_add_u32 m0, s73, 77824
    s_nop 0
    buffer_load_dwordx4 v30, s[24:27], s95 offen lds
    s_add_u32 s95, s95, s98
    s_mov_b32 s83, 0
L_FA_sspin3:
    s_waitcnt lgkmcnt(0)
    s_xor_b32 s79, s4, s81
    s_xor_b32 s80, s5, s81
    s_or_b32 s79, s79, s80
    s_xor_b32 s80, s6, s81
    s_or_b32 s79, s79, s80
    s_xor_b32 s80, s7, s81
    s_or_b32 s79, s79, s80
    s_xor_b32 s80, s16, s81
    s_or_b32 s79, s79, s80
    s_xor_b32 s80, s17, s81
    s_or_b32 s79, s79, s80
    s_xor_b32 s80, s18, s81
    s_or_b32 s79, s79, s80
    s_cbranch_scc0 L_FA_sok4
    s_sleep 2
    s_load_dword s4, s[100:101], 0 glc
    s_load_dword s5, s[100:101], 128 glc
    s_load_dword s6, s[100:101], 256 glc
    s_load_dword s7, s[100:101], 384 glc
    s_load_dword s16, s[100:101], 512 glc
    s_load_dword s17, s[100:101], 640 glc
    s_load_dword s18, s[100:101], 768 glc
    s_add_u32 s83, s83, 1
    s_cmp_lt_u32 s83, 1000000
    s_cbranch_scc1 L_FA_sspin3
    s_waitcnt lgkmcnt(0)
L_FA_sok4:
    s_waitcnt vmcnt(25)
    s_barrier
    buffer_load_dwordx4 v[144:147], v4, s[28:31], s96 offen offset:0 sc1
    buffer_load_dwordx4 v[148:151], v4, s[28:31], s96 offen offset:1024 sc1
    s_add_u32 s96, s96, s97
    buffer_load_dwordx4 v[152:155], v4, s[28:31], s96 offen offset:0 sc1
    buffer_load_dwordx4 v[156:159], v4, s[28:31], s96 offen offset:1024 sc1
    s_add_u32 s96, s96, s97
    buffer_load_dwordx4 v[160:163], v4, s[28:31], s96 offen offset:0 sc1
    buffer_load_dwordx4 v[164:167], v4, s[28:31], s96 offen offset:1024 sc1
    s_add_u32 s96, s96, s97
    v_add_u32 v5, 0, v39
    v_add_u32 v6, 65536, v39
    v_add_u32 v7, 131072, v39
    v_xor_b32 v8, 64, v5
    v_xor_b32 v9, 64, v6
    v_xor_b32 v10, 64, v7
    ds_read_b64_tr_b16 v[48:49], v6 offset:16384
    ds_read_b64_tr_b16 v[50:51], v6 offset:17408
    ds_read_b64_tr_b16 v[52:53], v9 offset:16384
    ds_read_b64_tr_b16 v[54:55], v9 offset:17408
    ds_read_b64_tr_b16 v[56:57], v6 offset:18432
    ds_read_b64_tr_b16 v[58:59], v6 offset:19456
    ds_read_b64_tr_b16 v[60:61], v9 offset:18432
    ds_read_b64_tr_b16 v[62:63], v9 offset:19456
    s_waitcnt vmcnt(5)
    s_waitcnt lgkmcnt(6)
    v_mfma_f32_32x32x16_bf16 v[112:127], v[48:51], v[144:147], 0
    ds_read_b64_tr_b16 v[40:41], v6 offset:24576
    ds_read_b64_tr_b16 v[42:43], v6 offset:25600
    buffer_load_dwordx4 v[168:171], v4, s[28:31], s96 offen offset:0 sc1
    s_waitcnt lgkmcnt(6)
    v_mfma_f32_32x32x16_bf16 v[128:143], v[52:55], v[144:147], 0
    ds_read_b64_tr_b16 v[44:45], v9 offset:24576
    ds_read_b64_tr_b16 v[46:47], v9 offset:25600
    buffer_load_dwordx4 v[172:175], v4, s[28:31], s96 offen offset:1024 sc1
    s_add_u32 s96, s96, s97
    s_waitcnt vmcnt(6)
    s_waitcnt lgkmcnt(6)
    v_mfma_f32_32x32x16_bf16 v[112:127], v[56:59], v[148:151], v[112:127]
    ds_read_b64_tr_b16 v[48:49], v6 offset:26624
    ds_read_b64_tr_b16 v[50:51], v6 offset:27648
    buffer_load_dwordx4 v[176:179], v4, s[28:31], s96 offen offset:0 sc1
    s_waitcnt lgkmcnt(6)
    v_mfma_f32_32x32x16_bf16 v[128:143], v[60:63], v[148:151], v[128:143]
    ds_read_b64_tr_b16 v[52:53], v9 offset:26624
    ds_read_b64_tr_b16 v[54:55], v9 offset:27648
    buffer_load_dwordx4 v[180:183], v4, s[28:31], s96 offen offset:1024 sc1
    s_add_u32 s96, s96, s97
    s_waitcnt vmcnt(7)
    s_waitcnt lgkmcnt(6)
    v_mfma_f32_32x32x16_bf16 v[112:127], v[40:43], v[152:155], v[112:127]
    ds_read_b64_tr_b16 v[56:57], v5 offset:24576
    ds_read_b64_tr_b16 v[58:59], v5 offset:25600
    buffer_load_dwordx4 v[184:187], v4, s[28:31], s96 offen offset:0 sc1
    s_waitcnt lgkmcnt(6)
    v_mfma_f32_32x32x16_bf16 v[128:143], v[44:47], v[152:155], v[128:143]
    ds_read_b64_tr_b16 v[60:61], v8 offset:24576
    ds_read_b64_tr_b16 v[62:63], v8 offset:25600
    buffer_load_dwordx4 v[188:191], v4, s[28:31], s96 offen offset:1024 sc1
    s_add_u32 s96, s96, s97
    s_waitcnt vmcnt(8)
    s_waitcnt lgkmcnt(6)
    v_mfma_f32_32x32x16_bf16 v[112:127], v[48:51], v[156:159], v[112:127]
    ds_read_b64_tr_b16 v[40:41], v5 offset:26624
    ds_read_b64_tr_b16 v[42:43], v5 offset:27648
    buffer_load_dwordx4 v[192:195], v4, s[28:31], s96 offen offset:0 sc1
    s_waitcnt lgkmcnt(6)
    v_mfma_f32_32x32x16_bf16 v[128:143], v[52:55], v[156:159], v[128:143]
    ds_read_b64_tr_b16 v[44:45], v8 offset:26624
    ds_read_b64_tr_b16 v[46:47], v8 offset:27648
    buffer_load_dwordx4 v[196:199], v4, s[28:31], s96 offen offset:1024 sc1
    s_mov_b32 s96, 4096
    s_waitcnt vmcnt(9)
    s_waitcnt lgkmcnt(6)
    v_mfma_f32_32x32x16_bf16 v[112:127], v[56:59], v[160:163], v[112:127]
    ds_read_b64_tr_b16 v[48:49], v5 offset:32768
    ds_read_b64_tr_b16 v[50:51], v5 offset:33792
    s_waitcnt lgkmcnt(6)
    v_mfma_f32_32x32x16_bf16 v[128:143], v[60:63], v[160:163], v[128:143]
    ds_read_b64_tr_b16 v[52:53], v8 offset:32768
    ds_read_b64_tr_b16 v[54:55], v8 offset:33792
    s_waitcnt vmcnt(8)
    s_waitcnt lgkmcnt(6)
    v_mfma_f32_32x32x16_bf16 v[112:127], v[40:43], v[164:167], v[112:127]
    ds_read_b64_tr_b16 v[56:57], v5 offset:34816
    ds_read_b64_tr_b16 v[58:59], v5 offset:35840
    s_waitcnt lgkmcnt(6)
    v_mfma_f32_32x32x16_bf16 v[128:143], v[44:47], v[164:167], v[128:143]
    ds_read_b64_tr_b16 v[60:61], v8 offset:34816
    ds_read_b64_tr_b16 v[62:63], v8 offset:35840
    s_waitcnt vmcnt(7)
    s_waitcnt lgkmcnt(6)
    v_mfma_f32_32x32x16_bf16 v[112:127], v[48:51], v[168:171], v[112:127]
    ds_read_b64_tr_b16 v[40:41], v5 offset:40960
    ds_read_b64_tr_b16 v[42:43], v5 offset:41984
    s_waitcnt lgkmcnt(6)
    v_mfma_f32_32x32x16_bf16 v[128:143], v[52:55], v[168:171], v[128:143]
    ds_read_b64_tr_b16 v[44:45], v8 offset:40960
    ds_read_b64_tr_b16 v[46:47], v8 offset:41984
    s_waitcnt vmcnt(6)
    s_waitcnt lgkmcnt(6)
    v_mfma_f32_32x32x16_bf16 v[112:127], v[56:59], v[172:175], v[112:127]
    ds_read_b64_tr_b16 v[48:49], v5 offset:43008
    ds_read_b64_tr_b16 v[50:51], v5 offset:44032
    s_waitcnt lgkmcnt(6)
    v_mfma_f32_32x32x16_bf16 v[128:143], v[60:63], v[172:175], v[128:143]
    ds_read_b64_tr_b16 v[52:53], v8 offset:43008
    ds_read_b64_tr_b16 v[54:55], v8 offset:44032
    s_waitcnt vmcnt(5)
    s_waitcnt lgkmcnt(6)
    v_mfma_f32_32x32x16_bf16 v[112:127], v[40:43], v[176:179], v[112:127]
    ds_read_b64_tr_b16 v[56:57], v5 offset:49152
    ds_read_b64_tr_b16 v[58:59], v5 offset:50176
    s_waitcnt lgkmcnt(6)
    v_mfma_f32_32x32x16_bf16 v[128:143], v[44:47], v[176:179], v[128:143]
    ds_read_b64_tr_b16 v[60:61], v8 offset:49152
    ds_read_b64_tr_b16 v[62:63], v8 offset:50176
    s_waitcnt vmcnt(4)
    s_waitcnt lgkmcnt(6)
    v_mfma_f32_32x32x16_bf16 v[112:127], v[48:51], v[180:183], v[112:127]
    ds_read_b64_tr_b16 v[40:41], v5 offset:51200
    ds_read_b64_tr_b16 v[42:43], v5 offset:52224
    s_waitcnt lgkmcnt(6)
    v_mfma_f32_32x32x16_bf16 v[128:143], v[52:55], v[180:183], v[128:143]
    ds_read_b64_tr_b16 v[44:45], v8 offset:51200
    ds_read_b64_tr_b16 v[46:47], v8 offset:52224
    s_waitcnt vmcnt(3)
    s_waitcnt lgkmcnt(6)
    v_mfma_f32_32x32x16_bf16 v[112:127], v[56:59], v[184:187], v[112:127]
    ds_read_b64_tr_b16 v[48:49], v5 offset:57344
    ds_read_b64_tr_b16 v[50:51], v5 offset:58368
    s_waitcnt lgkmcnt(6)
    v_mfma_f32_32x32x16_bf16 v[128:143], v[60:63], v[184:187], v[128:143]
    ds_read_b64_tr_b16 v[52:53], v8 offset:57344
    ds_read_b64_tr_b16 v[54:55], v8 offset:58368
    s_waitcnt vmcnt(2)
    s_waitcnt lgkmcnt(6)
    v_mfma_f32_32x32x16_bf16 v[112:127], v[40:43], v[188:191], v[112:127]
    ds_read_b64_tr_b16 v[56:57], v5 offset:59392
    ds_read_b64_tr_b16 v[58:59], v5 offset:60416
    s_waitcnt lgkmcnt(6)
    v_mfma_f32_32x32x16_bf16 v[128:143], v[44:47], v[188:191], v[128:143]
    ds_read_b64_tr_b16 v[60:61], v8 offset:59392
    ds_read_b64_tr_b16 v[62:63], v8 offset:60416
    s_waitcnt vmcnt(1)
    s_waitcnt lgkmcnt(6)
    v_mfma_f32_32x32x16_bf16 v[112:127], v[48:51], v[192:195], v[112:127]
    ds_read_b64_tr_b16 v[40:41], v6 offset:0
    ds_read_b64_tr_b16 v[42:43], v6 offset:1024
    s_waitcnt lgkmcnt(6)
    v_mfma_f32_32x32x16_bf16 v[128:143], v[52:55], v[192:195], v[128:143]
    ds_read_b64_tr_b16 v[44:45], v9 offset:0
    ds_read_b64_tr_b16 v[46:47], v9 offset:1024
    s_waitcnt vmcnt(0)
    s_waitcnt lgkmcnt(6)
    v_mfma_f32_32x32x16_bf16 v[112:127], v[56:59], v[196:199], v[112:127]
    s_barrier
    s_add_u32 m0, s73, 81920
    ds_read_b64_tr_b16 v[48:49], v6 offset:2048
    ds_read_b64_tr_b16 v[50:51], v6 offset:3072
    buffer_load_dwordx4 v3, s[24:27], s95 offen lds
    s_add_u32 s95, s95, s98
    s_waitcnt lgkmcnt(6)
    v_mfma_f32_32x32x16_bf16 v[128:143], v[60:63], v[196:199], v[128:143]
    s_add_u32 m0, s73, 90112
    ds_read_b64_tr_b16 v[52:53], v9 offset:2048
    ds_read_b64_tr_b16 v[54:55], v9 offset:3072
    buffer_load_dwordx4 v3, s[24:27], s95 offen lds
    s_add_u32 s95, s95, s98
    s_and_b32 s79, s45, 1
    s_mul_i32 s79, s79, 2048
    s_mul_i32 s80, s56, 8192
    s_add_u32 s79, s79, s80
    s_mul_i32 s80, s57, -3200
    s_add_u32 s79, s79, s80
    s_add_u32 s79, s79, 18354176
    s_mov_b32 s58, 127
    v_lshl_add_u32 v35, v0, 3, s79
    v_mov_b32 v36, 2147418112
    v_cndmask_b32 v35, v36, v35, s[58:59]
    buffer_load_dword v36, v35, s[28:31], 0 offen sc1
    s_waitcnt vmcnt(0)
    s_mov_b32 s83, 0
L_FA_spin5:
    v_cmp_ne_u32 vcc, v34, v36
    s_nop 0
    s_and_b64 vcc, vcc, s[58:59]
    s_cbranch_vccz L_FA_ok6
    buffer_load_dword v36, v35, s[28:31], 0 offen sc1
    s_add_u32 s83, s83, 1
    s_cmp_lt_u32 s83, 1000000
    s_waitcnt vmcnt(0)
    s_cbranch_scc1 L_FA_spin5
L_FA_ok6:
    buffer_load_dwordx4 v[200:203], v4, s[28:31], s96 offen offset:0 sc1
    buffer_load_dwordx4 v[204:207], v4, s[28:31], s96 offen offset:1024 sc1
    s_add_u32 s96, s96, s97
    buffer_load_dwordx4 v[208:211], v4, s[28:31], s96 offen offset:0 sc1
    buffer_load_dwordx4 v[212:215], v4, s[28:31], s96 offen offset:1024 sc1
    s_add_u32 s96, s96, s97
    buffer_load_dwordx4 v[216:219], v4, s[28:31], s96 offen offset:0 sc1
    buffer_load_dwordx4 v[220:223], v4, s[28:31], s96 offen offset:1024 sc1
    s_add_u32 s96, s96, s97
    buffer_load_dwordx4 v[224:227], v4, s[28:31], s96 offen offset:0 sc1
    buffer_load_dwordx4 v[228:231], v4, s[28:31], s96 offen offset:1024 sc1
    s_add_u32 s96, s96, s97
    s_waitcnt vmcnt(7)
    s_waitcnt lgkmcnt(6)
    v_mfma_f32_32x32x16_bf16 v[112:127], v[40:43], v[200:203], v[112:127]
    ds_read_b64_tr_b16 v[56:57], v5 offset:0
    ds_read_b64_tr_b16 v[58:59], v5 offset:1024
    buffer_load_dwordx4 v[232:235], v4, s[28:31], s96 offen offset:0 sc1
    s_waitcnt lgkmcnt(6)
    v_mfma_f32_32x32x16_bf16 v[128:143], v[44:47], v[200:203], v[128:143]
    ds_read_b64_tr_b16 v[60:61], v8 offset:0
    ds_read_b64_tr_b16 v[62:63], v8 offset:1024
    buffer_load_dwordx4 v[236:239], v4, s[28:31], s96 offen offset:1024 sc1
    s_add_u32 s96, s96, s97
    s_waitcnt vmcnt(8)
    s_waitcnt lgkmcnt(6)
    v_mfma_f32_32x32x16_bf16 v[112:127], v[48:51], v[204:207], v[112:127]
    ds_read_b64_tr_b16 v[40:41], v5 offset:2048
    ds_read_b64_tr_b16 v[42:43], v5 offset:3072
    buffer_load_dwordx4 v[240:243], v4, s[28:31], s96 offen offset:0 sc1
    s_waitcnt lgkmcnt(6)
    v_mfma_f32_32x32x16_bf16 v[128:143], v[52:55], v[204:207], v[128:143]
    ds_read_b64_tr_b16 v[44:45], v8 offset:2048
    ds_read_b64_tr_b16 v[46:47], v8 offset:3072
    buffer_load_dwordx4 v[244:247], v4, s[28:31], s96 offen offset:1024 sc1
    s_add_u32 s96, s96, s97
    s_waitcnt vmcnt(9)
    s_waitcnt lgkmcnt(6)
    v_mfma_f32_32x32x16_bf16 v[112:127], v[56:59], v[208:211], v[112:127]
    ds_read_b64_tr_b16 v[48:49], v5 offset:8192
    ds_read_b64_tr_b16 v[50:51], v5 offset:9216
    buffer_load_dwordx4 v[248:251], v4, s[28:31], s96 offen offset:0 sc1
    s_waitcnt lgkmcnt(6)
    v_mfma_f32_32x32x16_bf16 v[128:143], v[60:63], v[208:211], v[128:143]
    ds_read_b64_tr_b16 v[52:53], v8 offset:8192
    ds_read_b64_tr_b16 v[54:55], v8 offset:9216
    buffer_load_dwordx4 v[252:255], v4, s[28:31], s96 offen offset:1024 sc1
    s_mov_b32 s96, 0
    s_waitcnt vmcnt(10)
    s_waitcnt lgkmcnt(6)
    v_mfma_f32_32x32x16_bf16 v[112:127], v[40:43], v[212:215], v[112:127]
    ds_read_b64_tr_b16 v[56:57], v5 offset:10240
    ds_read_b64_tr_b16 v[58:59], v5 offset:11264
    s_waitcnt lgkmcnt(6)
    v_mfma_f32_32x32x16_bf16 v[128:143], v[44:47], v[212:215], v[128:143]
    ds_read_b64_tr_b16 v[60:61], v8 offset:10240
    ds_read_b64_tr_b16 v[62:63], v8 offset:11264
    s_waitcnt vmcnt(9)
    s_waitcnt lgkmcnt(6)
    v_mfma_f32_32x32x16_bf16 v[112:127], v[48:51], v[216:219], v[112:127]
    ds_read_b64_tr_b16 v[40:41], v6 offset:32768
    ds_read_b64_tr_b16 v[42:43], v6 offset:33792
    s_waitcnt lgkmcnt(6)
    v_mfma_f32_32x32x16_bf16 v[128:143], v[52:55], v[216:219], v[128:143]
    ds_read_b64_tr_b16 v[44:45], v9 offset:32768
    ds_read_b64_tr_b16 v[46:47], v9 offset:33792
    s_waitcnt vmcnt(8)
    s_waitcnt lgkmcnt(6)
    v_mfma_f32_32x32x16_bf16 v[112:127], v[56:59], v[220:223], v[112:127]
    ds_read_b64_tr_b16 v[48:49], v6 offset:34816
    ds_read_b64_tr_b16 v[50:51], v6 offset:35840
    s_waitcnt lgkmcnt(6)
    v_mfma_f32_32x32x16_bf16 v[128:143], v[60:63], v[220:223], v[128:143]
    ds_read_b64_tr_b16 v[52:53], v9 offset:34816
    ds_read_b64_tr_b16 v[54:55], v9 offset:35840
    s_waitcnt vmcnt(7)
    s_waitcnt lgkmcnt(6)
    v_mfma_f32_32x32x16_bf16 v[112:127], v[40:43], v[224:227], v[112:127]
    ds_read_b64_tr_b16 v[56:57], v6 offset:40960
    ds_read_b64_tr_b16 v[58:59], v6 offset:41984
    s_waitcnt lgkmcnt(6)
    v_mfma_f32_32x32x16_bf16 v[128:143], v[44:47], v[224:227], v[128:143]
    ds_read_b64_tr_b16 v[60:61], v9 offset:40960
    ds_read_b64_tr_b16 v[62:63], v9 offset:41984
    s_waitcnt vmcnt(6)
    s_waitcnt lgkmcnt(6)
    v_mfma_f32_32x32x16_bf16 v[112:127], v[48:51], v[228:231], v[112:127]
    ds_read_b64_tr_b16 v[40:41], v6 offset:43008
    ds_read_b64_tr_b16 v[42:43], v6 offset:44032
    s_waitcnt lgkmcnt(6)
    v_mfma_f32_32x32x16_bf16 v[128:143], v[52:55], v[228:231], v[128:143]
    ds_read_b64_tr_b16 v[44:45], v9 offset:43008
    ds_read_b64_tr_b16 v[46:47], v9 offset:44032
    s_waitcnt vmcnt(5)
    s_waitcnt lgkmcnt(6)
    v_mfma_f32_32x32x16_bf16 v[112:127], v[56:59], v[232:235], v[112:127]
    ds_read_b64_tr_b16 v[48:49], v6 offset:49152
    ds_read_b64_tr_b16 v[50:51], v6 offset:50176
    s_waitcnt lgkmcnt(6)
    v_mfma_f32_32x32x16_bf16 v[128:143], v[60:63], v[232:235], v[128:143]
    ds_read_b64_tr_b16 v[52:53], v9 offset:49152
    ds_read_b64_tr_b16 v[54:55], v9 offset:50176
    s_waitcnt vmcnt(4)
    s_waitcnt lgkmcnt(6)
    v_mfma_f32_32x32x16_bf16 v[112:127], v[40:43], v[236:239], v[112:127]
    ds_read_b64_tr_b16 v[56:57], v6 offset:51200
    ds_read_b64_tr_b16 v[58:59], v6 offset:52224
    s_waitcnt lgkmcnt(6)
    v_mfma_f32_32x32x16_bf16 v[128:143], v[44:47], v[236:239], v[128:143]
    ds_read_b64_tr_b16 v[60:61], v9 offset:51200
    ds_read_b64_tr_b16 v[62:63], v9 offset:52224
    s_waitcnt vmcnt(3)
    s_waitcnt lgkmcnt(6)
    v_mfma_f32_32x32x16_bf16 v[112:127], v[48:51], v[240:243], v[112:127]
    s_barrier
    ds_read_b64_tr_b16 v[40:41], v6 offset:57344
    ds_read_b64_tr_b16 v[42:43], v6 offset:58368
    s_waitcnt lgkmcnt(6)
    v_mfma_f32_32x32x16_bf16 v[128:143], v[52:55], v[240:243], v[128:143]
    ds_read_b64_tr_b16 v[44:45], v9 offset:57344
    ds_read_b64_tr_b16 v[46:47], v9 offset:58368
    s_waitcnt vmcnt(2)
    s_waitcnt lgkmcnt(6)
    v_mfma_f32_32x32x16_bf16 v[112:127], v[56:59], v[244:247], v[112:127]
    ds_read_b64_tr_b16 v[48:49], v6 offset:59392
    ds_read_b64_tr_b16 v[50:51], v6 offset:60416
    s_waitcnt lgkmcnt(6)
    v_mfma_f32_32x32x16_bf16 v[128:143], v[60:63], v[244:247], v[128:143]
    ds_read_b64_tr_b16 v[52:53], v9 offset:59392
    ds_read_b64_tr_b16 v[54:55], v9 offset:60416
    s_waitcnt vmcnt(1)
    s_waitcnt lgkmcnt(6)
    v_mfma_f32_32x32x16_bf16 v[112:127], v[40:43], v[248:251], v[112:127]
    s_waitcnt lgkmcnt(4)
    v_mfma_f32_32x32x16_bf16 v[128:143], v[44:47], v[248:251], v[128:143]
    s_waitcnt vmcnt(0)
    s_waitcnt lgkmcnt(2)
    v_mfma_f32_32x32x16_bf16 v[112:127], v[48:51], v[252:255], v[112:127]
    s_waitcnt lgkmcnt(0)
    v_mfma_f32_32x32x16_bf16 v[128:143], v[52:55], v[252:255], v[128:143]
    s_nop 9
    ds_write_b128 v12, v[112:115] offset:0
    ds_write_b128 v13, v[116:119] offset:0
    ds_write_b128 v14, v[120:123] offset:0
    ds_write_b128 v15, v[124:127] offset:0
    ds_write_b128 v12, v[128:131] offset:128
    ds_write_b128 v13, v[132:135] offset:128
    ds_write_b128 v14, v[136:139] offset:128
    ds_write_b128 v15, v[140:143] offset:128
    s_waitcnt lgkmcnt(0)
    s_barrier
    ds_read_b128 v[144:147], v18 offset:24576
    ds_read_b128 v[148:151], v21 offset:24576
    ds_read_b128 v[160:163], v18 offset:40960
    ds_read_b128 v[164:167], v21 offset:40960
    ds_read_b128 v[152:155], v18 offset:32768
    ds_read_b128 v[156:159], v21 offset:32768
    ds_read_b128 v[168:171], v18 offset:49152
    ds_read_b128 v[172:175], v21 offset:49152
    s_waitcnt lgkmcnt(4)
    v_add_f32 v144, v144, v160
    v_add_f32 v145, v145, v161
    v_add_f32 v146, v146, v162
    v_add_f32 v147, v147, v163
    v_add_f32 v148, v148, v164
    v_add_f32 v149, v149, v165
    v_add_f32 v150, v150, v166
    v_add_f32 v151, v151, v167
    v_cvt_pk_bf16_f32 v176, v144, v145
    v_cvt_pk_bf16_f32 v177, v146, v147
    v_cvt_pk_bf16_f32 v178, v148, v149
    v_cvt_pk_bf16_f32 v179, v150, v151
    buffer_store_dwordx4 v[176:179], v0, s[28:31], s52 offen offset:0 sc1
    s_waitcnt lgkmcnt(0)
    v_add_f32 v152, v152, v168
    v_add_f32 v153, v153, v169
    v_add_f32 v154, v154, v170
    v_add_f32 v155, v155, v171
    v_add_f32 v156, v156, v172
    v_add_f32 v157, v157, v173
    v_add_f32 v158, v158, v174
    v_add_f32 v159, v159, v175
    v_cvt_pk_bf16_f32 v180, v152, v153
    v_cvt_pk_bf16_f32 v181, v154, v155
    v_cvt_pk_bf16_f32 v182, v156, v157
    v_cvt_pk_bf16_f32 v183, v158, v159
    buffer_store_dwordx4 v[180:183], v0, s[28:31], s52 offen offset:1024 sc1
    s_waitcnt vmcnt(0)
    buffer_store_dword v34, v33, s[28:31], s48 offen sc1
    s_add_u32 s100, s28, s50
    s_addc_u32 s101, s29, 0
    s_load_dword s4, s[100:101], 0 glc
    s_mov_b32 s83, 0
L_FA_sspin7:
    s_waitcnt lgkmcnt(0)
    s_xor_b32 s79, s4, s81
    s_cbranch_scc0 L_FA_sok8
    s_sleep 2
    s_load_dword s4, s[100:101], 0 glc
    s_add_u32 s83, s83, 1
    s_cmp_lt_u32 s83, 1000000
    s_cbranch_scc1 L_FA_sspin7
    s_waitcnt lgkmcnt(0)
L_FA_sok8:
    buffer_load_dwordx4 v[96:99], v0, s[28:31], s53 offen offset:0 sc1
    buffer_load_dwordx4 v[100:103], v0, s[28:31], s53 offen offset:1024 sc1
    s_barrier
    ds_read_b128 v[144:147], v18 offset:0
    ds_read_b128 v[148:151], v21 offset:0
    ds_read_b128 v[160:163], v18 offset:57344
    ds_read_b128 v[164:167], v21 offset:57344
    ds_read_b128 v[152:155], v18 offset:8192
    ds_read_b128 v[156:159], v21 offset:8192
    ds_read_b128 v[168:171], v19 offset:0
    ds_read_b128 v[172:175], v22 offset:0
    s_waitcnt lgkmcnt(4)
    v_pk_add_f32 v[144:145], v[144:145], v[160:161]
    v_pk_add_f32 v[146:147], v[146:147], v[162:163]
    v_pk_add_f32 v[148:149], v[148:149], v[164:165]
    v_pk_add_f32 v[150:151], v[150:151], v[166:167]
    s_waitcnt vmcnt(0)
    v_lshlrev_b32 v80, 16, v96
    v_and_b32 v81, 0xffff0000, v96
    v_lshlrev_b32 v82, 16, v97
    v_and_b32 v83, 0xffff0000, v97
    v_lshlrev_b32 v84, 16, v98
    v_and_b32 v85, 0xffff0000, v98
    v_lshlrev_b32 v86, 16, v99
    v_and_b32 v87, 0xffff0000, v99
    v_pk_add_f32 v[144:145], v[144:145], v[80:81]
    v_pk_add_f32 v[146:147], v[146:147], v[82:83]
    v_pk_add_f32 v[148:149], v[148:149], v[84:85]
    v_pk_add_f32 v[150:151], v[150:151], v[86:87]
    v_cvt_pk_bf16_f32 v176, v144, v145
    v_cvt_pk_bf16_f32 v177, v146, v147
    v_cvt_pk_bf16_f32 v178, v148, v149
    v_cvt_pk_bf16_f32 v179, v150, v151
    buffer_store_dwordx4 v[176:179], v24, s[60:63], s49 offen sc1
    s_add_u32 s49, s49, 28672
    s_waitcnt lgkmcnt(0)
    v_pk_add_f32 v[152:153], v[152:153], v[168:169]
    v_pk_add_f32 v[154:155], v[154:155], v[170:171]
    v_pk_add_f32 v[156:157], v[156:157], v[172:173]
    v_pk_add_f32 v[158:159], v[158:159], v[174:175]
    v_lshlrev_b32 v88, 16, v100
    v_and_b32 v89, 0xffff0000, v100
    v_lshlrev_b32 v90, 16, v101
    v_and_b32 v91, 0xffff0000, v101
    v_lshlrev_b32 v92, 16, v102
    v_and_b32 v93, 0xffff0000, v102
    v_lshlrev_b32 v94, 16, v103
    v_and_b32 v95, 0xffff0000, v103
    v_pk_add_f32 v[152:153], v[152:153], v[88:89]
    v_pk_add_f32 v[154:155], v[154:155], v[90:91]
    v_pk_add_f32 v[156:157], v[156:157], v[92:93]
    v_pk_add_f32 v[158:159], v[158:159], v[94:95]
    v_cvt_pk_bf16_f32 v180, v152, v153
    v_cvt_pk_bf16_f32 v181, v154, v155
    v_cvt_pk_bf16_f32 v182, v156, v157
    v_cvt_pk_bf16_f32 v183, v158, v159
    buffer_store_dwordx4 v[180:183], v24, s[60:63], s49 offen sc1
    s_add_u32 s49, s49, 28672
    s_endpgm
L_B:
    s_add_u32 m0, s73, 143360
    s_nop 0
    buffer_load_dwordx4 v2, s[16:19], s95 offen lds
    s_add_u32 s79, s88, 128
    s_cmp_eq_u32 s79, 896
    s_cselect_b32 s89, 0, s79
    s_mul_i32 s96, s89, 1344
    s_add_u32 m0, s74, 16384
    s_nop 0
    buffer_load_dwordx4 v3, s[4:7], s89 offen lds
    s_add_u32 m0, s74, 17408
    s_nop 0
    buffer_load_dwordx4 v4, s[4:7], s89 offen lds
    s_add_u32 m0, s73, 135168
    s_nop 0
    buffer_load_dwordx4 v2, s[16:19], s96 offen lds
    v_lshrrev_b32 v17, 9, v0
    v_bfe_u32 v18, v0, 4, 5
    v_lshl_add_u32 v12, s45, 5, v18
    v_lshlrev_b32 v112, 7, v12
    v_bfe_u32 v12, v18, 1, 3
    v_xor_b32 v12, v12, v17
    v_lshl_or_b32 v112, v12, 4, v112
    v_xor_b32 v115, 32, v112
    v_xor_b32 v118, 64, v112
    v_xor_b32 v121, 96, v112
    s_add_u32 s79, s89, 128
    s_cmp_eq_u32 s79, 896
    s_cselect_b32 s90, 0, s79
    s_mul_i32 s97, s90, 1344
    s_add_u32 s79, s90, 128
    s_cmp_eq_u32 s79, 896
    s_cselect_b32 s91, 0, s79
    s_mul_i32 s98, s91, 1344
    s_cmp_eq_u32 s77, 7
    s_cbranch_scc1 L_QB
    s_waitcnt vmcnt(3)
    s_barrier
    s_add_u32 m0, s74, 32768
    ds_read_b128 v[144:147], v112 offset:0
    buffer_load_dwordx4 v3, s[4:7], s90 offen lds
    s_add_u32 m0, s74, 33792
    ds_read_b128 v[148:151], v115 offset:0
    buffer_load_dwordx4 v4, s[4:7], s90 offen lds
    s_waitcnt lgkmcnt(1)
    s_add_u32 m0, s73, 126976
    ds_read_b128 v[152:155], v118 offset:0
    buffer_load_dwordx4 v2, s[16:19], s97 offen lds
    s_add_u32 s79, s91, 128
    s_cmp_eq_u32 s79, 896
    s_cselect_b32 s92, 0, s79
    s_mul_i32 s99, s92, 1344
    s_add_u32 s79, s92, 128
    s_cmp_eq_u32 s79, 896
    s_cselect_b32 s93, 0, s79
    s_waitcnt lgkmcnt(1)
    ds_read_b128 v[156:159], v121 offset:0
    s_mul_i32 s100, s93, 1344
    s_add_u32 s79, s93, 128
    s_cmp_eq_u32 s79, 896
    s_cselect_b32 s94, 0, s79
    s_mul_i32 s101, s94, 1344
    s_mov_b32 s64, s40
    s_waitcnt lgkmcnt(1)
    s_waitcnt vmcnt(3)
    s_barrier
    s_add_u32 m0, s74, 49152
    ds_read_b128 v[160:163], v112 offset:16384
    buffer_load_dwordx4 v3, s[4:7], s91 offen lds
    s_mov_b32 s65, s41
    s_mov_b32 s66, 25088
    s_mov_b32 s67, 0x20000
    s_mov_b32 s32, s56
    s_mov_b32 s33, s57
    s_mov_b32 s34, 256
    s_waitcnt lgkmcnt(1)
    s_add_u32 m0, s74, 50176
    ds_read_b128 v[164:167], v115 offset:16384
    buffer_load_dwordx4 v4, s[4:7], s91 offen lds
    s_mov_b32 s35, 0x20000
    s_mov_b32 s86, 0x10000000
    s_mov_b32 s87, 0x10000000
    v_lshlrev_b32 v12, 4, v17
    v_add_u32 v124, 155648, v12
    v_bfe_u32 v19, v0, 6, 2
    s_waitcnt lgkmcnt(1)
    s_add_u32 m0, s73, 118784
    ds_read_b128 v[168:171], v118 offset:16384
    buffer_load_dwordx4 v2, s[16:19], s98 offen lds
    v_lshl_add_u32 v21, v17, 3, v19
    v_bfe_u32 v12, v0, 8, 1
    v_bfe_u32 v13, v0, 4, 2
    v_lshl_or_b32 v20, v12, 2, v13
    v_add_u32 v13, s78, v20
    s_and_b32 s79, s78, 14
    v_subrev_u32 v13, s79, v13
    s_waitcnt lgkmcnt(1)
    ds_read_b128 v[172:175], v121 offset:16384
    v_and_b32 v13, 7, v13
    v_lshlrev_b32 v13, 3, v13
    v_lshl_or_b32 v8, v21, 6, v13
    v_add_u32 v9, 0x10000, v8
    v_add_u32 v10, 0x20000, v8
    s_mov_b32 s28, s58
    s_waitcnt lgkmcnt(1)
    s_waitcnt vmcnt(3)
    s_barrier
    s_add_u32 m0, s74, 0
    ds_read_b128 v[176:179], v112 offset:32768
    buffer_load_dwordx4 v3, s[4:7], s92 offen lds
    s_mov_b32 s29, s59
    s_mov_b32 s30, 26345472
    s_mov_b32 s31, 0x20000
    s_mov_b32 s82, 0x3fb8aa3b
    s_mov_b32 s84, 0
    s_mov_b32 s85, -1
    s_waitcnt lgkmcnt(1)
    s_add_u32 m0, s74, 1024
    ds_read_b128 v[180:183], v115 offset:32768
    buffer_load_dwordx4 v4, s[4:7], s92 offen lds
    s_mul_i32 s2, s76, 7
    s_add_u32 s2, s2, s77
    s_lshl_b32 s44, s2, 8
    s_add_u32 s8, s46, s44
    s_addc_u32 s9, s47, 0
    s_sub_u32 s10, 1605632, s44
    s_waitcnt lgkmcnt(1)
    s_add_u32 m0, s73, 143360
    ds_read_b128 v[184:187], v118 offset:32768
    buffer_load_dwordx4 v2, s[16:19], s99 offen lds
    s_mov_b32 s11, 0x20000
    s_add_u32 s12, s48, s44
    s_addc_u32 s13, s49, 0
    s_sub_u32 s14, 1605632, s44
    s_mov_b32 s15, 0x20000
    v_lshl_add_u32 v16, s72, 3, v14
    s_waitcnt lgkmcnt(1)
    ds_read_b128 v[188:191], v121 offset:32768
    v_mul_u32_u24 v1, 3584, v16
    v_lshrrev_b32 v12, 2, v0
    v_xor_b32 v12, v12, v0
    v_and_b32 v12, 64, v12
    v_and_b32 v13, 48, v0
    v_add3_u32 v1, v1, v12, v13
    s_waitcnt lgkmcnt(1)
    s_waitcnt vmcnt(3)
    s_barrier
    s_add_u32 m0, s74, 16384
    ds_read_b128 v[192:195], v112 offset:49152
    buffer_load_dwordx4 v3, s[4:7], s93 offen lds
    v_lshrrev_b32 v12, 1, v19
    v_lshlrev_b32 v12, 6, v12
    v_lshl_or_b32 v12, v21, 7, v12
    v_lshl_or_b32 v5, v20, 3, v12
    v_add_u32 v6, 0x10000, v5
    v_add_u32 v7, 0x20000, v5
    s_waitcnt lgkmcnt(1)
    s_add_u32 m0, s74, 17408
    ds_read_b128 v[196:199], v115 offset:49152
    buffer_load_dwordx4 v4, s[4:7], s93 offen lds
    s_lshl2_add_u32 s79, s78, s45
    s_lshl4_add_u32 s79, s79, s75
    s_mul_i32 s53, s79, 128
    s_add_u32 s53, s53, 18677760
    s_lshl4_add_u32 s79, s78, s75
    s_and_b32 s80, s72, 1
    s_lshl1_add_u32 s79, s79, s80
    s_mul_i32 s52, s79, 2048
    s_waitcnt lgkmcnt(1)
    s_add_u32 m0, s73, 135168
    ds_read_b128 v[200:203], v118 offset:49152
    buffer_load_dwordx4 v2, s[16:19], s100 offen lds
    s_add_u32 s52, s52, 19922944
    s_lshl_b32 s44, s77, 7
    s_add_u32 s24, s42, s44
    s_addc_u32 s25, s43, 0
    s_sub_u32 s26, 401408, s44
    s_mov_b32 s27, 0x20000
    s_waitcnt lgkmcnt(1)
    ds_read_b128 v[204:207], v121 offset:49152
    s_lshl_b32 s80, s72, 8
    s_add_u32 m0, s80, 156672
    s_mul_i32 s79, s78, 1568
    s_add_u32 s79, s79, s80
    s_mov_b64 exec, 0xffff
    buffer_load_dwordx4 v0, s[64:67], s79 offen lds
    s_mov_b64 exec, -1
    s_mov_b32 s56, s75
    s_mov_b32 s57, s76
    s_mul_i32 s79, s57, 802816
    s_add_u32 s44, s44, s79
    s_add_u32 s20, s50, s44
    s_addc_u32 s21, s51, 0
    s_waitcnt lgkmcnt(1)
    s_waitcnt vmcnt(4)
    s_barrier
    s_add_u32 m0, s74, 32768
    ds_read_b128 v[208:211], v112 offset:0
    buffer_load_dwordx4 v3, s[4:7], s94 offen lds
    s_sub_u32 s22, 1605632, s44
    s_mov_b32 s23, 0x20000
    v_lshrrev_b32 v37, 2, v0
    v_mov_b32 v38, 2147418112
    v_cndmask_b32 v33, v37, v38, s[84:85]
    v_bfe_u32 v37, v0, 4, 5
    s_waitcnt lgkmcnt(1)
    s_add_u32 m0, s74, 33792
    ds_read_b128 v[212:215], v115 offset:0
    buffer_load_dwordx4 v4, s[4:7], s94 offen lds
    v_lshl_add_u32 v35, s45, 5, v37
    v_lshlrev_b32 v35, 6, v35
    v_bfe_u32 v37, v37, 1, 3
    v_lshrrev_b32 v38, 9, v0
    v_xor_b32 v37, v37, v38
    v_lshl_or_b32 v35, v37, 3, v35
    s_waitcnt lgkmcnt(1)
    s_add_u32 m0, s73, 126976
    ds_read_b128 v[216:219], v118 offset:0
    buffer_load_dwordx4 v2, s[16:19], s101 offen lds
    v_add_u32 v35, 131072, v35
    v_bfe_u32 v27, v0, 6, 2
    v_lshrrev_b32 v37, 9, v0
    v_lshl_add_u32 v38, v37, 3, v27
    v_lshlrev_b32 v28, 7, v38
    v_lshlrev_b32 v30, 6, v38
    s_waitcnt lgkmcnt(1)
    ds_read_b128 v[220:223], v121 offset:0
    v_bfe_u32 v29, v0, 4, 2
    v_bfe_u32 v31, v0, 8, 1
    v_lshl_or_b32 v29, v31, 2, v29
    v_lshrrev_b32 v38, 1, v38
    v_xor_b32 v38, v38, v29
    v_lshl_or_b32 v30, v38, 3, v30
    s_waitcnt lgkmcnt(1)
    s_waitcnt vmcnt(4)
    s_barrier
    ds_read_b128 v[224:227], v112 offset:16384
    v_add_u32 v2, 896, v2
    v_add_u32 v30, 131072, v30
    v_xor_b32 v31, 16, v30
    v_and_b32 v38, 1, v27
    v_lshl_or_b32 v38, v37, 2, v38
    v_lshrrev_b32 v27, 1, v27
    v_xor_b32 v27, s72, v27
    s_waitcnt lgkmcnt(1)
    s_add_u32 m0, s73, 118784
    ds_read_b128 v[228:231], v115 offset:16384
    buffer_load_dwordx4 v2, s[16:19], s95 offen lds
    v_and_b32 v27, 1, v27
    v_lshl_or_b32 v38, v27, 3, v38
    v_xor_b32 v38, v38, v29
    v_lshl_or_b32 v28, v38, 3, v28
    v_add_u32 v28, 114688, v28
    v_xor_b32 v29, 16, v28
    s_waitcnt lgkmcnt(1)
    s_add_u32 m0, s73, 102400
    ds_read_b128 v[232:235], v118 offset:16384
    buffer_load_dwordx4 v2, s[16:19], s96 offen lds
    s_waitcnt lgkmcnt(1)
    ds_read_b128 v[236:239], v121 offset:16384
    s_waitcnt vmcnt(5)
    s_waitcnt lgkmcnt(1)
    s_waitcnt vmcnt(2)
    s_barrier
    s_sub_u32 m0, s73, 4096
    ds_read_b128 v[240:243], v112 offset:32768
    buffer_load_dwordx4 v2, s[16:19], s97 offen lds
    s_waitcnt lgkmcnt(1)
    s_add_u32 m0, s73, 4096
    ds_read_b128 v[244:247], v115 offset:32768
    buffer_load_dwordx4 v2, s[16:19], s98 offen lds
    s_waitcnt lgkmcnt(1)
    ds_read_b128 v[248:251], v118 offset:32768
    s_waitcnt lgkmcnt(1)
    ds_read_b128 v[252:255], v121 offset:32768
    s_waitcnt lgkmcnt(1)
    s_waitcnt lgkmcnt(0)
    s_waitcnt vmcnt(2)
    s_barrier
    s_add_u32 m0, s73, 12288
    ds_read_b64_tr_b16 v[56:57], v9 offset:57344
    ds_read_b64_tr_b16 v[58:59], v9 offset:57600
    s_mov_b64 exec, s[86:87]
    ds_read_b128 v[56:59], v124 offset:0
    s_mov_b64 exec, -1
    buffer_load_dwordx4 v2, s[16:19], s99 offen lds
    ds_read_b64_tr_b16 v[60:61], v9 offset:58368
    ds_read_b64_tr_b16 v[62:63], v9 offset:58624
    s_mov_b64 exec, s[86:87]
    ds_read_b128 v[60:63], v124 offset:32
    s_mov_b64 exec, -1
    s_mulk_i32 s88, 1792
    s_mulk_i32 s89, 1792
    s_mulk_i32 s90, 1792
    s_mulk_i32 s91, 1792
    s_mulk_i32 s92, 1792
    s_mulk_i32 s93, 1792
    s_mulk_i32 s94, 1792
    v_subrev_u32 v24, 114688, v1
    s_add_u32 m0, s73, 24576
    ds_read_b64_tr_b16 v[40:41], v9 offset:59392
    ds_read_b64_tr_b16 v[42:43], v9 offset:59648
    s_mov_b64 exec, s[86:87]
    ds_read_b128 v[40:43], v124 offset:64
    s_mov_b64 exec, -1
    buffer_load_dwordx4 v1, s[8:11], s88 offen lds
    s_waitcnt lgkmcnt(6)
    v_mfma_f32_32x32x16_bf16 v[64:79], v[56:59], v[144:147], 0
    s_add_u32 m0, s73, 20480
    ds_read_b64_tr_b16 v[44:45], v9 offset:60416
    ds_read_b64_tr_b16 v[46:47], v9 offset:60672
    s_mov_b64 exec, s[86:87]
    ds_read_b128 v[44:47], v124 offset:96
    s_mov_b64 exec, -1
    buffer_load_dwordx4 v24, s[8:11], s88 offen lds
    s_waitcnt lgkmcnt(6)
    v_mfma_f32_32x32x16_bf16 v[64:79], v[60:63], v[148:151], v[64:79]
    s_add_u32 m0, s73, 32768
    ds_read_b64_tr_b16 v[48:49], v9 offset:40960
    ds_read_b64_tr_b16 v[50:51], v9 offset:41216
    s_mov_b64 exec, s[86:87]
    ds_read_b128 v[48:51], v124 offset:128
    s_mov_b64 exec, -1
    buffer_load_dwordx4 v1, s[12:15], s88 offen lds
    s_waitcnt lgkmcnt(6)
    v_mfma_f32_32x32x16_bf16 v[64:79], v[40:43], v[152:155], v[64:79]
    s_add_u32 m0, s73, 28672
    ds_read_b64_tr_b16 v[52:53], v9 offset:41984
    ds_read_b64_tr_b16 v[54:55], v9 offset:42240
    s_mov_b64 exec, s[86:87]
    ds_read_b128 v[52:55], v124 offset:160
    s_mov_b64 exec, -1
    buffer_load_dwordx4 v24, s[12:15], s88 offen lds
    s_waitcnt lgkmcnt(6)
    v_mfma_f32_32x32x16_bf16 v[64:79], v[44:47], v[156:159], v[64:79]
    ds_read_b64_tr_b16 v[56:57], v9 offset:43008
    ds_read_b64_tr_b16 v[58:59], v9 offset:43264
    s_mov_b64 exec, s[86:87]
    ds_read_b128 v[56:59], v124 offset:192
    s_mov_b64 exec, -1
    s_waitcnt lgkmcnt(6)
    v_mfma_f32_32x32x16_bf16 v[64:79], v[48:51], v[160:163], v[64:79]
    ds_read_b64_tr_b16 v[60:61], v9 offset:44032
    ds_read_b64_tr_b16 v[62:63], v9 offset:44288
    s_mov_b64 exec, s[86:87]
    ds_read_b128 v[60:63], v124 offset:224
    s_mov_b64 exec, -1
    s_waitcnt lgkmcnt(6)
    v_mfma_f32_32x32x16_bf16 v[64:79], v[52:55], v[164:167], v[64:79]
    s_waitcnt vmcnt(4)
    s_barrier
    s_add_u32 m0, s73, 36864
    ds_read_b64_tr_b16 v[40:41], v8 offset:0
    ds_read_b64_tr_b16 v[42:43], v8 offset:256
    s_mov_b64 exec, s[86:87]
    ds_read_b128 v[40:43], v124 offset:256
    s_mov_b64 exec, -1
    buffer_load_dwordx4 v2, s[16:19], s100 offen lds
    s_waitcnt lgkmcnt(6)
    v_mfma_f32_32x32x16_bf16 v[64:79], v[56:59], v[168:171], v[64:79]
    s_add_u32 m0, s73, 45056
    ds_read_b64_tr_b16 v[44:45], v8 offset:1024
    ds_read_b64_tr_b16 v[46:47], v8 offset:1280
    s_mov_b64 exec, s[86:87]
    ds_read_b128 v[44:47], v124 offset:288
    s_mov_b64 exec, -1
    buffer_load_dwordx4 v2, s[16:19], s101 offen lds
    s_waitcnt lgkmcnt(6)
    v_mfma_f32_32x32x16_bf16 v[64:79], v[60:63], v[172:175], v[64:79]
    s_add_u32 m0, s73, 57344
    ds_read_b64_tr_b16 v[48:49], v8 offset:2048
    ds_read_b64_tr_b16 v[50:51], v8 offset:2304
    s_mov_b64 exec, s[86:87]
    ds_read_b128 v[48:51], v124 offset:320
    s_mov_b64 exec, -1
    buffer_load_dwordx4 v1, s[8:11], s89 offen lds
    s_waitcnt lgkmcnt(6)
    v_mfma_f32_32x32x16_bf16 v[64:79], v[40:43], v[176:179], v[64:79]
    s_add_u32 m0, s73, 53248
    ds_read_b64_tr_b16 v[52:53], v8 offset:3072
    ds_read_b64_tr_b16 v[54:55], v8 offset:3328
    s_mov_b64 exec, s[86:87]
    ds_read_b128 v[52:55], v124 offset:352
    s_mov_b64 exec, -1
    buffer_load_dwordx4 v24, s[8:11], s89 offen lds
    s_waitcnt lgkmcnt(6)
    v_mfma_f32_32x32x16_bf16 v[64:79], v[44:47], v[180:183], v[64:79]
    s_add_u32 m0, s73, 65536
    ds_read_b64_tr_b16 v[56:57], v8 offset:8192
    ds_read_b64_tr_b16 v[58:59], v8 offset:8448
    s_mov_b64 exec, s[86:87]
    ds_read_b128 v[56:59], v124 offset:384
    s_mov_b64 exec, -1
    buffer_load_dwordx4 v1, s[12:15], s89 offen lds
    v_mov_b32 v34, 2147418112
    v_writelane_b32 v34, 0, 0
    buffer_load_dword v36, v34, s[32:35], 0 offen sc1
    s_waitcnt lgkmcnt(6)
    v_mfma_f32_32x32x16_bf16 v[64:79], v[48:51], v[184:187], v[64:79]
    s_add_u32 m0, s73, 61440
    ds_read_b64_tr_b16 v[60:61], v8 offset:9216
    ds_read_b64_tr_b16 v[62:63], v8 offset:9472
    s_mov_b64 exec, s[86:87]
    ds_read_b128 v[60:63], v124 offset:416
    s_mov_b64 exec, -1
    buffer_load_dwordx4 v24, s[12:15], s89 offen lds
    s_waitcnt lgkmcnt(6)
    v_mfma_f32_32x32x16_bf16 v[64:79], v[52:55], v[188:191], v[64:79]
    ds_read_b64_tr_b16 v[40:41], v8 offset:10240
    ds_read_b64_tr_b16 v[42:43], v8 offset:10496
    s_mov_b64 exec, s[86:87]
    ds_read_b128 v[40:43], v124 offset:448
    s_mov_b64 exec, -1
    s_waitcnt lgkmcnt(6)
    v_mfma_f32_32x32x16_bf16 v[64:79], v[56:59], v[192:195], v[64:79]
    ds_read_b64_tr_b16 v[44:45], v8 offset:11264
    ds_read_b64_tr_b16 v[46:47], v8 offset:11520
    s_mov_b64 exec, s[86:87]
    ds_read_b128 v[44:47], v124 offset:480
    s_mov_b64 exec, -1
    s_waitcnt lgkmcnt(6)
    v_mfma_f32_32x32x16_bf16 v[64:79], v[60:63], v[196:199], v[64:79]
    ds_read_b64_tr_b16 v[48:49], v8 offset:16384
    ds_read_b64_tr_b16 v[50:51], v8 offset:16640
    s_mov_b64 exec, s[86:87]
    ds_read_b128 v[48:51], v124 offset:512
    s_mov_b64 exec, -1
    s_waitcnt lgkmcnt(6)
    v_mfma_f32_32x32x16_bf16 v[64:79], v[40:43], v[200:203], v[64:79]
    ds_read_b64_tr_b16 v[52:53], v8 offset:17408
    ds_read_b64_tr_b16 v[54:55], v8 offset:17664
    s_mov_b64 exec, s[86:87]
    ds_read_b128 v[52:55], v124 offset:544
    s_mov_b64 exec, -1
    s_waitcnt lgkmcnt(6)
    v_mfma_f32_32x32x16_bf16 v[64:79], v[44:47], v[204:207], v[64:79]
    ds_read_b64_tr_b16 v[56:57], v8 offset:18432
    ds_read_b64_tr_b16 v[58:59], v8 offset:18688
    s_mov_b64 exec, s[86:87]
    ds_read_b128 v[56:59], v124 offset:576
    s_mov_b64 exec, -1
    s_waitcnt lgkmcnt(6)
    v_mfma_f32_32x32x16_bf16 v[64:79], v[48:51], v[208:211], v[64:79]
    ds_read_b64_tr_b16 v[60:61], v8 offset:19456
    ds_read_b64_tr_b16 v[62:63], v8 offset:19712
    s_mov_b64 exec, s[86:87]
    ds_read_b128 v[60:63], v124 offset:608
    s_mov_b64 exec, -1
    s_setprio 1
    s_waitcnt lgkmcnt(6)
    v_mfma_f32_32x32x16_bf16 v[64:79], v[52:55], v[212:215], v[64:79]
    s_waitcnt vmcnt(6)
    s_barrier
    s_add_u32 m0, s73, 0
    ds_read_b64_tr_b16 v[40:41], v8 offset:40960
    ds_read_b64_tr_b16 v[42:43], v8 offset:41216
    s_mov_b64 exec, s[86:87]
    ds_read_b128 v[40:43], v124 offset:640
    s_mov_b64 exec, -1
    buffer_load_dwordx4 v1, s[8:11], s90 offen lds
    s_waitcnt lgkmcnt(6)
    v_mfma_f32_32x32x16_bf16 v[64:79], v[56:59], v[216:219], v[64:79]
    s_sub_u32 m0, s73, 4096
    ds_read_b64_tr_b16 v[44:45], v8 offset:41984
    ds_read_b64_tr_b16 v[46:47], v8 offset:42240
    s_mov_b64 exec, s[86:87]
    ds_read_b128 v[44:47], v124 offset:672
    s_mov_b64 exec, -1
    buffer_load_dwordx4 v24, s[8:11], s90 offen lds
    s_waitcnt lgkmcnt(6)
    v_mfma_f32_32x32x16_bf16 v[64:79], v[60:63], v[220:223], v[64:79]
    s_add_u32 m0, s73, 8192
    ds_read_b64_tr_b16 v[48:49], v8 offset:43008
    ds_read_b64_tr_b16 v[50:51], v8 offset:43264
    s_mov_b64 exec, s[86:87]
    ds_read_b128 v[48:51], v124 offset:704
    s_mov_b64 exec, -1
    buffer_load_dwordx4 v1, s[12:15], s90 offen lds
    s_waitcnt lgkmcnt(6)
    v_mfma_f32_32x32x16_bf16 v[64:79], v[40:43], v[224:227], v[64:79]
    s_add_u32 m0, s73, 4096
    ds_read_b64_tr_b16 v[52:53], v8 offset:44032
    ds_read_b64_tr_b16 v[54:55], v8 offset:44288
    s_mov_b64 exec, s[86:87]
    ds_read_b128 v[52:55], v124 offset:736
    s_mov_b64 exec, -1
    buffer_load_dwordx4 v24, s[12:15], s90 offen lds
    s_waitcnt lgkmcnt(6)
    v_mfma_f32_32x32x16_bf16 v[64:79], v[44:47], v[228:231], v[64:79]
    s_add_u32 m0, s73, 73728
    s_nop 0
    buffer_load_dwordx4 v1, s[8:11], s91 offen lds
    s_add_u32 m0, s73, 69632
    s_nop 0
    buffer_load_dwordx4 v24, s[8:11], s91 offen lds
    s_waitcnt vmcnt(6)
    s_barrier
    s_add_u32 m0, s73, 16384
    ds_read_b64_tr_b16 v[56:57], v8 offset:49152
    ds_read_b64_tr_b16 v[58:59], v8 offset:49408
    s_mov_b64 exec, s[86:87]
    ds_read_b128 v[56:59], v124 offset:768
    s_mov_b64 exec, -1
    buffer_load_dwordx4 v1, s[12:15], s91 offen lds
    s_waitcnt lgkmcnt(6)
    v_mfma_f32_32x32x16_bf16 v[64:79], v[48:51], v[232:235], v[64:79]
    s_add_u32 m0, s73, 12288
    ds_read_b64_tr_b16 v[60:61], v8 offset:50176
    ds_read_b64_tr_b16 v[62:63], v8 offset:50432
    s_mov_b64 exec, s[86:87]
    ds_read_b128 v[60:63], v124 offset:800
    s_mov_b64 exec, -1
    buffer_load_dwordx4 v24, s[12:15], s91 offen lds
    s_waitcnt lgkmcnt(6)
    v_mfma_f32_32x32x16_bf16 v[64:79], v[52:55], v[236:239], v[64:79]
    s_add_u32 m0, s73, 81920
    ds_read_b64_tr_b16 v[40:41], v8 offset:51200
    ds_read_b64_tr_b16 v[42:43], v8 offset:51456
    s_mov_b64 exec, s[86:87]
    ds_read_b128 v[40:43], v124 offset:832
    s_mov_b64 exec, -1
    buffer_load_dwordx4 v1, s[8:11], s92 offen lds
    s_waitcnt lgkmcnt(6)
    v_mfma_f32_32x32x16_bf16 v[64:79], v[56:59], v[240:243], v[64:79]
    s_add_u32 m0, s73, 77824
    ds_read_b64_tr_b16 v[44:45], v8 offset:52224
    ds_read_b64_tr_b16 v[46:47], v8 offset:52480
    s_mov_b64 exec, s[86:87]
    ds_read_b128 v[44:47], v124 offset:864
    s_mov_b64 exec, -1
    buffer_load_dwordx4 v24, s[8:11], s92 offen lds
    s_waitcnt lgkmcnt(6)
    v_mfma_f32_32x32x16_bf16 v[64:79], v[60:63], v[244:247], v[64:79]
    s_add_u32 m0, s73, 90112
    s_nop 0
    buffer_load_dwordx4 v1, s[12:15], s92 offen lds
    s_waitcnt lgkmcnt(3)
    v_mfma_f32_32x32x16_bf16 v[64:79], v[40:43], v[248:251], v[64:79]
    s_add_u32 m0, s73, 86016
    s_nop 0
    buffer_load_dwordx4 v24, s[12:15], s92 offen lds
    s_waitcnt lgkmcnt(0)
    v_mfma_f32_32x32x16_bf16 v[64:79], v[44:47], v[252:255], v[64:79]
    s_add_u32 m0, s73, 98304
    s_nop 0
    buffer_load_dwordx4 v1, s[8:11], s93 offen lds
    s_nop 8
    v_mul_f32 v37, 0x3fb8aa3b, v76
    s_add_u32 m0, s73, 94208
    s_nop 0
    buffer_load_dwordx4 v24, s[8:11], s93 offen lds
    v_exp_f32 v37, v37
    s_nop 0
    v_add_f32 v37, 1.0, v37
    v_min_f32 v37, 0x7149f2ca, v37
    v_mov_b32 v32, v37
    s_nop 1
    v_permlane32_swap_b32 v37, v32
    v_cvt_pk_bf16_f32 v64, v64, v65
    v_cvt_pk_bf16_f32 v65, v66, v67
    v_cvt_pk_bf16_f32 v66, v68, v69
    v_cvt_pk_bf16_f32 v67, v70, v71
    v_cvt_pk_bf16_f32 v68, v72, v73
    v_cvt_pk_bf16_f32 v69, v74, v75
    v_cvt_pk_bf16_f32 v70, v76, v77
    v_cvt_pk_bf16_f32 v71, v78, v79
    s_add_u32 m0, s73, 106496
    v_mov_b32 v37, 0x3f80
    buffer_load_dwordx4 v1, s[12:15], s93 offen lds
    v_cndmask_b32 v70, v70, v37, s[84:85]
    v_cndmask_b32 v71, v71, 0, s[84:85]
    ds_write_b64 v35, v[64:65]
    v_xor_b32 v38, 16, v35
    ds_write_b64 v38, v[66:67]
    v_xor_b32 v37, 32, v35
    ds_write_b64 v37, v[68:69]
    v_xor_b32 v38, 48, v35
    ds_write_b64 v38, v[70:71]
    s_waitcnt lgkmcnt(0)
    s_add_u32 m0, s73, 102400
    s_nop 0
    buffer_load_dwordx4 v24, s[12:15], s93 offen lds
    s_mul_i32 s79, s56, 50176
    s_mul_i32 s80, s77, 7040
    s_add_u32 s79, s79, s80
    s_mul_i32 s80, s45, 1792
    s_add_u32 s79, s79, s80
    v_lshl_add_u32 v37, v0, 3, s79
    s_mov_b64 exec, 16383
    buffer_load_dword v23, v37, s[20:23], 0 offen
    s_mov_b64 exec, -1
    s_mul_i32 s79, s75, 28672
    s_mul_i32 s80, s76, 14336
    s_add_u32 s79, s79, s80
    s_mul_i32 s80, s77, 1920
    s_add_u32 s79, s79, s80
    s_mul_i32 s80, s45, 512
    s_add_u32 s79, s79, s80
    v_lshl_add_u32 v37, v0, 3, s79
    s_mov_b64 exec, 15
    buffer_load_dword v23, v37, s[24:27], 0 offen
    s_mov_b64 exec, -1
    s_waitcnt vmcnt(14)
    s_barrier
    ds_read_b64_tr_b16 v[80:81], v28 offset:0
    ds_read_b64_tr_b16 v[82:83], v29 offset:512
    ds_read_b64_tr_b16 v[84:85], v30 offset:0
    ds_read_b64_tr_b16 v[86:87], v31 offset:256
    ds_read_b64_tr_b16 v[88:89], v28 offset:2048
    ds_read_b64_tr_b16 v[90:91], v29 offset:2560
    ds_read_b64_tr_b16 v[92:93], v30 offset:1024
    ds_read_b64_tr_b16 v[94:95], v31 offset:1280
    ds_read_b64_tr_b16 v[96:97], v28 offset:4096
    ds_read_b64_tr_b16 v[98:99], v29 offset:4608
    ds_read_b64_tr_b16 v[100:101], v30 offset:2048
    ds_read_b64_tr_b16 v[102:103], v31 offset:2304
    s_waitcnt lgkmcnt(8)
    v_mfma_f32_32x32x16_bf16 v[64:79], v[80:83], v[84:87], 0
    ds_read_b64_tr_b16 v[104:105], v28 offset:6144
    ds_read_b64_tr_b16 v[106:107], v29 offset:6656
    ds_read_b64_tr_b16 v[108:109], v30 offset:3072
    ds_read_b64_tr_b16 v[110:111], v31 offset:3328
    s_add_u32 m0, s73, 24576
    s_waitcnt lgkmcnt(8)
    v_mfma_f32_32x32x16_bf16 v[64:79], v[88:91], v[92:95], v[64:79]
    ds_read_b64_tr_b16 v[80:81], v28 offset:8192
    ds_read_b64_tr_b16 v[82:83], v29 offset:8704
    ds_read_b64_tr_b16 v[84:85], v30 offset:4096
    ds_read_b64_tr_b16 v[86:87], v31 offset:4352
    buffer_load_dwordx4 v1, s[8:11], s94 offen lds
    s_add_u32 m0, s73, 20480
    s_waitcnt lgkmcnt(8)
    v_mfma_f32_32x32x16_bf16 v[64:79], v[96:99], v[100:103], v[64:79]
    ds_read_b64_tr_b16 v[88:89], v28 offset:10240
    ds_read_b64_tr_b16 v[90:91], v29 offset:10752
    ds_read_b64_tr_b16 v[92:93], v30 offset:5120
    ds_read_b64_tr_b16 v[94:95], v31 offset:5376
    buffer_load_dwordx4 v24, s[8:11], s94 offen lds
    s_waitcnt lgkmcnt(8)
    v_mfma_f32_32x32x16_bf16 v[64:79], v[104:107], v[108:111], v[64:79]
    ds_read_b64_tr_b16 v[96:97], v28 offset:12288
    ds_read_b64_tr_b16 v[98:99], v29 offset:12800
    ds_read_b64_tr_b16 v[100:101], v30 offset:6144
    ds_read_b64_tr_b16 v[102:103], v31 offset:6400
    s_add_u32 m0, s73, 32768
    s_waitcnt lgkmcnt(8)
    v_mfma_f32_32x32x16_bf16 v[64:79], v[80:83], v[84:87], v[64:79]
    ds_read_b64_tr_b16 v[104:105], v28 offset:14336
    ds_read_b64_tr_b16 v[106:107], v29 offset:14848
    ds_read_b64_tr_b16 v[108:109], v30 offset:7168
    ds_read_b64_tr_b16 v[110:111], v31 offset:7424
    buffer_load_dwordx4 v1, s[12:15], s94 offen lds
    s_add_u32 m0, s73, 28672
    s_waitcnt lgkmcnt(8)
    v_mfma_f32_32x32x16_bf16 v[64:79], v[88:91], v[92:95], v[64:79]
    buffer_load_dwordx4 v24, s[12:15], s94 offen lds
    s_waitcnt lgkmcnt(4)
    v_mfma_f32_32x32x16_bf16 v[64:79], v[96:99], v[100:103], v[64:79]
    s_waitcnt lgkmcnt(0)
    v_mfma_f32_32x32x16_bf16 v[64:79], v[104:107], v[108:111], v[64:79]
    s_nop 11
    v_cvt_pk_bf16_f32 v64, v64, v65
    v_cvt_pk_bf16_f32 v65, v66, v67
    v_cvt_pk_bf16_f32 v66, v68, v69
    v_cvt_pk_bf16_f32 v67, v70, v71
    v_cvt_pk_bf16_f32 v68, v72, v73
    v_cvt_pk_bf16_f32 v69, v74, v75
    v_cvt_pk_bf16_f32 v70, v76, v77
    v_cvt_pk_bf16_f32 v71, v78, v79
    s_bitcmp1_b32 s72, 1
    s_cbranch_scc1 L_FB_kvhi1
    buffer_store_dwordx4 v[64:67], v0, s[28:31], s52 offen sc1
    s_branch L_FB_kvend2
L_FB_kvhi1:
    buffer_store_dwordx4 v[68:71], v0, s[28:31], s52 offen offset:1024 sc1
L_FB_kvend2:
    s_setprio 0
    s_waitcnt vmcnt(15)
    s_barrier
    s_mov_b32 s83, 0
L_FB_spin3:
    v_cmp_eq_u32 vcc, 0, v36
    s_nop 0
    s_and_b64 vcc, vcc, 1
    s_cbranch_vccz L_FB_ok4
    buffer_load_dword v36, v34, s[32:35], 0 offen sc1
    s_add_u32 s83, s83, 1
    s_cmp_lt_u32 s83, 1000000
    s_waitcnt vmcnt(0)
    s_cbranch_scc1 L_FB_spin3
L_FB_ok4:
    v_readfirstlane_b32 s81, v36
    s_nop 1
    v_mov_b32 v34, s81
    s_mov_b32 s59, 0
    v_add_u32 v1, 128, v1
    v_subrev_u32 v24, 114688, v1
    s_lshr_b32 s40, s75, 1
    s_mul_i32 s40, s40, 1540096
    s_mul_i32 s80, s75, 32768
    s_add_u32 s40, s40, s80
    s_mul_i32 s80, s45, 8192
    s_add_u32 s40, s40, s80
    s_mul_i32 s80, s2, 114688
    s_add_u32 s40, s40, s80
    s_add_u32 s40, s40, 4096
    s_add_u32 m0, s73, 40960
    s_mov_b32 s60, s54
    buffer_load_dwordx4 v1, s[8:11], s88 offen lds
    s_mov_b32 s61, s55
    s_mov_b32 s62, 1835008
    s_mov_b32 s63, 0x20000
    s_mov_b32 s58, 0x3fff
    s_bitset0_b32 s58, s2
    s_lshl2_add_u32 s79, s75, s45
    s_lshl4_add_u32 s79, s79, s2
    s_mul_i32 s46, s79, 128
    s_add_u32 m0, s73, 36864
    s_nop 0
    buffer_load_dwordx4 v24, s[8:11], s88 offen lds
    s_add_u32 m0, s73, 49152
    s_nop 0
    buffer_load_dwordx4 v1, s[12:15], s88 offen lds
    s_add_u32 m0, s73, 45056
    s_nop 0
    buffer_load_dwordx4 v24, s[12:15], s88 offen lds
    s_add_u32 m0, s73, 57344
    s_nop 0
    buffer_load_dwordx4 v1, s[8:11], s89 offen lds
    s_add_u32 m0, s73, 53248
    s_nop 0
    buffer_load_dwordx4 v24, s[8:11], s89 offen lds
    s_add_u32 m0, s73, 65536
    s_nop 0
    buffer_load_dwordx4 v1, s[12:15], s89 offen lds
    s_add_u32 m0, s73, 61440
    s_nop 0
    buffer_load_dwordx4 v24, s[12:15], s89 offen lds
    s_waitcnt vmcnt(9)
    s_barrier
    s_waitcnt vmcnt(8)
    buffer_store_dword v34, v33, s[28:31], s53 offen sc1
    s_mov_b32 s95, 0
    s_mov_b32 s96, 0
    s_mov_b32 s97, 114688
    s_mov_b32 s98, 50176
    v_lshrrev_b32 v2, 7, v0
    s_add_u32 m0, s73, 0
    v_lshl_add_u32 v2, s72, 3, v2
    buffer_load_dwordx4 v1, s[8:11], s90 offen lds
    v_mul_u32_u24 v2, 896, v2
    v_lshrrev_b32 v3, 2, v0
    v_xor_b32 v3, v3, v0
    v_and_b32 v3, 64, v3
    v_and_b32 v4, 48, v0
    v_add3_u32 v2, v2, v3, v4
    v_subrev_u32 v3, 3584, v2
    s_cmp_eq_u32 s45, 3
    s_cselect_b32 s80, 2147418112, 0
    v_or_b32 v4, s80, v3
    v_cndmask_b32 v3, v3, v4, s[84:85]
    v_subrev_u32 v25, 28672, v2
    s_add_u32 s46, s46, 18350080
    s_sub_u32 m0, s73, 4096
    s_and_b32 s44, s45, 1
    buffer_load_dwordx4 v24, s[8:11], s90 offen lds
    s_lshr_b32 s41, s56, 1
    s_mul_i32 s41, s41, 1540096
    s_mul_i32 s80, s56, 32768
    s_add_u32 s41, s41, s80
    s_mul_i32 s80, s57, 819200
    s_add_u32 s41, s41, s80
    s_mul_i32 s80, s44, 7168
    s_add_u32 s41, s41, s80
    s_mul_i32 s80, s45, 1024
    s_add_u32 s41, s41, s80
    s_lshr_b32 s50, s56, 1
    s_mul_i32 s50, s50, 368640
    s_add_u32 m0, s73, 8192
    s_mul_i32 s80, s56, 16384
    s_add_u32 s50, s50, s80
    buffer_load_dwordx4 v1, s[12:15], s90 offen lds
    s_mul_i32 s80, s57, 8192
    s_add_u32 s50, s50, s80
    s_mul_i32 s80, s44, 3072
    s_add_u32 s50, s50, s80
    s_mul_i32 s80, s45, 1024
    s_add_u32 s50, s50, s80
    s_add_u32 s50, s50, 13631488
    s_mul_i32 s48, s56, 2048
    s_mul_i32 s80, s57, 1024
    s_add_u32 s48, s48, s80
    s_mul_i32 s80, s44, 512
    s_add_u32 s48, s48, s80
    s_add_u32 m0, s73, 4096
    s_add_u32 s48, s48, 18612224
    buffer_load_dwordx4 v24, s[12:15], s90 offen lds
    v_xor_b32 v8, 64, v5
    v_xor_b32 v9, 64, v6
    v_xor_b32 v10, 64, v7
    s_add_u32 m0, s73, 114688
    s_nop 0
    buffer_load_dwordx4 v1, s[8:11], s91 offen lds
    s_add_u32 m0, s73, 110592
    s_nop 0
    buffer_load_dwordx4 v24, s[8:11], s91 offen lds
    s_add_u32 m0, s73, 122880
    s_nop 0
    buffer_load_dwordx4 v1, s[12:15], s91 offen lds
    s_add_u32 m0, s73, 118784
    s_nop 0
    buffer_load_dwordx4 v24, s[12:15], s91 offen lds
    s_add_u32 m0, s73, 131072
    s_nop 0
    buffer_load_dwordx4 v1, s[8:11], s92 offen lds
    s_add_u32 m0, s73, 126976
    s_nop 0
    buffer_load_dwordx4 v24, s[8:11], s92 offen lds
    s_add_u32 m0, s73, 139264
    s_nop 0
    buffer_load_dwordx4 v1, s[12:15], s92 offen lds
    s_add_u32 m0, s73, 135168
    s_nop 0
    buffer_load_dwordx4 v24, s[12:15], s92 offen lds
    s_add_u32 m0, s73, 147456
    s_nop 0
    buffer_load_dwordx4 v1, s[8:11], s93 offen lds
    s_add_u32 m0, s73, 143360
    s_nop 0
    buffer_load_dwordx4 v24, s[8:11], s93 offen lds
    s_add_u32 m0, s73, 155648
    s_nop 0
    buffer_load_dwordx4 v1, s[12:15], s93 offen lds
    s_add_u32 m0, s73, 151552
    s_nop 0
    buffer_load_dwordx4 v24, s[12:15], s93 offen lds
    v_add_u32 v4, s41, v0
    v_bfe_u32 v37, v0, 6, 2
    v_lshrrev_b32 v38, 9, v0
    v_lshl_add_u32 v38, v38, 2, v37
    v_lshlrev_b32 v39, 7, v38
    v_and_b32 v37, 0x78, v5
    v_or_b32 v39, v37, v39
    v_lshl_add_u32 v39, s45, 11, v39
    v_and_b32 v39, 0xf7ff, v39
    s_waitcnt vmcnt(12)
    s_barrier
    ds_read_b64_tr_b16 v[48:49], v5 offset:40960
    ds_read_b64_tr_b16 v[50:51], v5 offset:41472
    ds_read_b64_tr_b16 v[52:53], v5 offset:49152
    ds_read_b64_tr_b16 v[54:55], v5 offset:49664
    ds_read_b64_tr_b16 v[56:57], v8 offset:40960
    ds_read_b64_tr_b16 v[58:59], v8 offset:41472
    ds_read_b64_tr_b16 v[60:61], v8 offset:49152
    ds_read_b64_tr_b16 v[62:63], v8 offset:49664
    s_waitcnt lgkmcnt(6)
    v_mfma_f32_32x32x16_bf16 v[80:95], v[48:51], v[144:147], 0
    ds_read_b64_tr_b16 v[40:41], v5 offset:43008
    ds_read_b64_tr_b16 v[42:43], v5 offset:43520
    s_waitcnt lgkmcnt(6)
    v_mfma_f32_32x32x16_bf16 v[96:111], v[52:55], v[144:147], 0
    ds_read_b64_tr_b16 v[44:45], v5 offset:51200
    ds_read_b64_tr_b16 v[46:47], v5 offset:51712
    s_waitcnt lgkmcnt(6)
    v_mfma_f32_32x32x16_bf16 v[112:127], v[56:59], v[144:147], 0
    ds_read_b64_tr_b16 v[48:49], v8 offset:43008
    ds_read_b64_tr_b16 v[50:51], v8 offset:43520
    s_waitcnt lgkmcnt(6)
    v_mfma_f32_32x32x16_bf16 v[128:143], v[60:63], v[144:147], 0
    ds_read_b64_tr_b16 v[52:53], v8 offset:51200
    ds_read_b64_tr_b16 v[54:55], v8 offset:51712
    s_waitcnt lgkmcnt(6)
    v_mfma_f32_32x32x16_bf16 v[80:95], v[40:43], v[148:151], v[80:95]
    ds_read_b64_tr_b16 v[56:57], v5 offset:45056
    ds_read_b64_tr_b16 v[58:59], v5 offset:45568
    s_waitcnt lgkmcnt(6)
    v_mfma_f32_32x32x16_bf16 v[96:111], v[44:47], v[148:151], v[96:111]
    ds_read_b64_tr_b16 v[60:61], v5 offset:53248
    ds_read_b64_tr_b16 v[62:63], v5 offset:53760
    s_waitcnt lgkmcnt(6)
    v_mfma_f32_32x32x16_bf16 v[112:127], v[48:51], v[148:151], v[112:127]
    ds_read_b64_tr_b16 v[40:41], v8 offset:45056
    ds_read_b64_tr_b16 v[42:43], v8 offset:45568
    s_waitcnt lgkmcnt(6)
    v_mfma_f32_32x32x16_bf16 v[128:143], v[52:55], v[148:151], v[128:143]
    ds_read_b64_tr_b16 v[44:45], v8 offset:53248
    ds_read_b64_tr_b16 v[46:47], v8 offset:53760
    s_waitcnt lgkmcnt(6)
    v_mfma_f32_32x32x16_bf16 v[80:95], v[56:59], v[152:155], v[80:95]
    ds_read_b64_tr_b16 v[48:49], v5 offset:47104
    ds_read_b64_tr_b16 v[50:51], v5 offset:47616
    s_waitcnt lgkmcnt(6)
    v_mfma_f32_32x32x16_bf16 v[96:111], v[60:63], v[152:155], v[96:111]
    ds_read_b64_tr_b16 v[52:53], v5 offset:55296
    ds_read_b64_tr_b16 v[54:55], v5 offset:55808
    s_waitcnt lgkmcnt(6)
    v_mfma_f32_32x32x16_bf16 v[112:127], v[40:43], v[152:155], v[112:127]
    ds_read_b64_tr_b16 v[56:57], v8 offset:47104
    ds_read_b64_tr_b16 v[58:59], v8 offset:47616
    s_waitcnt lgkmcnt(6)
    v_mfma_f32_32x32x16_bf16 v[128:143], v[44:47], v[152:155], v[128:143]
    ds_read_b64_tr_b16 v[60:61], v8 offset:55296
    ds_read_b64_tr_b16 v[62:63], v8 offset:55808
    s_waitcnt lgkmcnt(6)
    v_mfma_f32_32x32x16_bf16 v[80:95], v[48:51], v[156:159], v[80:95]
    ds_read_b64_tr_b16 v[40:41], v5 offset:57344
    ds_read_b64_tr_b16 v[42:43], v5 offset:57856
    s_waitcnt lgkmcnt(6)
    v_mfma_f32_32x32x16_bf16 v[96:111], v[52:55], v[156:159], v[96:111]
    ds_read_b64_tr_b16 v[44:45], v6 offset:0
    ds_read_b64_tr_b16 v[46:47], v6 offset:512
    s_waitcnt lgkmcnt(6)
    v_mfma_f32_32x32x16_bf16 v[112:127], v[56:59], v[156:159], v[112:127]
    ds_read_b64_tr_b16 v[48:49], v8 offset:57344
    ds_read_b64_tr_b16 v[50:51], v8 offset:57856
    s_waitcnt lgkmcnt(6)
    v_mfma_f32_32x32x16_bf16 v[128:143], v[60:63], v[156:159], v[128:143]
    ds_read_b64_tr_b16 v[52:53], v9 offset:0
    ds_read_b64_tr_b16 v[54:55], v9 offset:512
    s_waitcnt lgkmcnt(6)
    v_mfma_f32_32x32x16_bf16 v[80:95], v[40:43], v[160:163], v[80:95]
    ds_read_b64_tr_b16 v[56:57], v5 offset:59392
    ds_read_b64_tr_b16 v[58:59], v5 offset:59904
    s_waitcnt lgkmcnt(6)
    v_mfma_f32_32x32x16_bf16 v[96:111], v[44:47], v[160:163], v[96:111]
    ds_read_b64_tr_b16 v[60:61], v6 offset:2048
    ds_read_b64_tr_b16 v[62:63], v6 offset:2560
    s_waitcnt lgkmcnt(6)
    v_mfma_f32_32x32x16_bf16 v[112:127], v[48:51], v[160:163], v[112:127]
    ds_read_b64_tr_b16 v[40:41], v8 offset:59392
    ds_read_b64_tr_b16 v[42:43], v8 offset:59904
    s_waitcnt lgkmcnt(6)
    v_mfma_f32_32x32x16_bf16 v[128:143], v[52:55], v[160:163], v[128:143]
    ds_read_b64_tr_b16 v[44:45], v9 offset:2048
    ds_read_b64_tr_b16 v[46:47], v9 offset:2560
    s_waitcnt lgkmcnt(6)
    v_mfma_f32_32x32x16_bf16 v[80:95], v[56:59], v[164:167], v[80:95]
    ds_read_b64_tr_b16 v[48:49], v5 offset:61440
    ds_read_b64_tr_b16 v[50:51], v5 offset:61952
    s_waitcnt lgkmcnt(6)
    v_mfma_f32_32x32x16_bf16 v[96:111], v[60:63], v[164:167], v[96:111]
    ds_read_b64_tr_b16 v[52:53], v6 offset:4096
    ds_read_b64_tr_b16 v[54:55], v6 offset:4608
    s_waitcnt lgkmcnt(6)
    v_mfma_f32_32x32x16_bf16 v[112:127], v[40:43], v[164:167], v[112:127]
    ds_read_b64_tr_b16 v[56:57], v8 offset:61440
    ds_read_b64_tr_b16 v[58:59], v8 offset:61952
    s_waitcnt lgkmcnt(6)
    v_mfma_f32_32x32x16_bf16 v[128:143], v[44:47], v[164:167], v[128:143]
    ds_read_b64_tr_b16 v[60:61], v9 offset:4096
    ds_read_b64_tr_b16 v[62:63], v9 offset:4608
    s_waitcnt lgkmcnt(6)
    v_mfma_f32_32x32x16_bf16 v[80:95], v[48:51], v[168:171], v[80:95]
    ds_read_b64_tr_b16 v[40:41], v5 offset:63488
    ds_read_b64_tr_b16 v[42:43], v5 offset:64000
    s_waitcnt lgkmcnt(6)
    v_mfma_f32_32x32x16_bf16 v[96:111], v[52:55], v[168:171], v[96:111]
    ds_read_b64_tr_b16 v[44:45], v6 offset:6144
    ds_read_b64_tr_b16 v[46:47], v6 offset:6656
    s_waitcnt lgkmcnt(6)
    v_mfma_f32_32x32x16_bf16 v[112:127], v[56:59], v[168:171], v[112:127]
    ds_read_b64_tr_b16 v[48:49], v8 offset:63488
    ds_read_b64_tr_b16 v[50:51], v8 offset:64000
    s_waitcnt lgkmcnt(6)
    v_mfma_f32_32x32x16_bf16 v[128:143], v[60:63], v[168:171], v[128:143]
    ds_read_b64_tr_b16 v[52:53], v9 offset:6144
    ds_read_b64_tr_b16 v[54:55], v9 offset:6656
    s_waitcnt lgkmcnt(6)
    v_mfma_f32_32x32x16_bf16 v[80:95], v[40:43], v[172:175], v[80:95]
    ds_read_b64_tr_b16 v[56:57], v5 offset:0
    ds_read_b64_tr_b16 v[58:59], v5 offset:512
    s_waitcnt lgkmcnt(6)
    v_mfma_f32_32x32x16_bf16 v[96:111], v[44:47], v[172:175], v[96:111]
    ds_read_b64_tr_b16 v[60:61], v5 offset:8192
    ds_read_b64_tr_b16 v[62:63], v5 offset:8704
    s_waitcnt lgkmcnt(6)
    v_mfma_f32_32x32x16_bf16 v[112:127], v[48:51], v[172:175], v[112:127]
    ds_read_b64_tr_b16 v[40:41], v8 offset:0
    ds_read_b64_tr_b16 v[42:43], v8 offset:512
    s_waitcnt lgkmcnt(6)
    v_mfma_f32_32x32x16_bf16 v[128:143], v[52:55], v[172:175], v[128:143]
    ds_read_b64_tr_b16 v[44:45], v8 offset:8192
    ds_read_b64_tr_b16 v[46:47], v8 offset:8704
    s_waitcnt lgkmcnt(6)
    v_mfma_f32_32x32x16_bf16 v[80:95], v[56:59], v[176:179], v[80:95]
    s_waitcnt vmcnt(4)
    s_barrier
    ds_read_b64_tr_b16 v[48:49], v5 offset:2048
    ds_read_b64_tr_b16 v[50:51], v5 offset:2560
    s_waitcnt lgkmcnt(6)
    v_mfma_f32_32x32x16_bf16 v[96:111], v[60:63], v[176:179], v[96:111]
    ds_read_b64_tr_b16 v[52:53], v5 offset:10240
    ds_read_b64_tr_b16 v[54:55], v5 offset:10752
    s_waitcnt lgkmcnt(6)
    v_mfma_f32_32x32x16_bf16 v[112:127], v[40:43], v[176:179], v[112:127]
    ds_read_b64_tr_b16 v[56:57], v8 offset:2048
    ds_read_b64_tr_b16 v[58:59], v8 offset:2560
    s_waitcnt lgkmcnt(6)
    v_mfma_f32_32x32x16_bf16 v[128:143], v[44:47], v[176:179], v[128:143]
    ds_read_b64_tr_b16 v[60:61], v8 offset:10240
    ds_read_b64_tr_b16 v[62:63], v8 offset:10752
    s_waitcnt lgkmcnt(6)
    v_mfma_f32_32x32x16_bf16 v[80:95], v[48:51], v[180:183], v[80:95]
    ds_read_b64_tr_b16 v[40:41], v5 offset:4096
    ds_read_b64_tr_b16 v[42:43], v5 offset:4608
    s_waitcnt lgkmcnt(6)
    v_mfma_f32_32x32x16_bf16 v[96:111], v[52:55], v[180:183], v[96:111]
    ds_read_b64_tr_b16 v[44:45], v5 offset:12288
    ds_read_b64_tr_b16 v[46:47], v5 offset:12800
    s_waitcnt lgkmcnt(6)
    v_mfma_f32_32x32x16_bf16 v[112:127], v[56:59], v[180:183], v[112:127]
    ds_read_b64_tr_b16 v[48:49], v8 offset:4096
    ds_read_b64_tr_b16 v[50:51], v8 offset:4608
    s_waitcnt lgkmcnt(6)
    v_mfma_f32_32x32x16_bf16 v[128:143], v[60:63], v[180:183], v[128:143]
    ds_read_b64_tr_b16 v[52:53], v8 offset:12288
    ds_read_b64_tr_b16 v[54:55], v8 offset:12800
    s_waitcnt lgkmcnt(6)
    v_mfma_f32_32x32x16_bf16 v[80:95], v[40:43], v[184:187], v[80:95]
    ds_read_b64_tr_b16 v[56:57], v5 offset:6144
    ds_read_b64_tr_b16 v[58:59], v5 offset:6656
    s_waitcnt lgkmcnt(6)
    v_mfma_f32_32x32x16_bf16 v[96:111], v[44:47], v[184:187], v[96:111]
    ds_read_b64_tr_b16 v[60:61], v5 offset:14336
    ds_read_b64_tr_b16 v[62:63], v5 offset:14848
    s_waitcnt lgkmcnt(6)
    v_mfma_f32_32x32x16_bf16 v[112:127], v[48:51], v[184:187], v[112:127]
    ds_read_b64_tr_b16 v[40:41], v8 offset:6144
    ds_read_b64_tr_b16 v[42:43], v8 offset:6656
    s_waitcnt lgkmcnt(6)
    v_mfma_f32_32x32x16_bf16 v[128:143], v[52:55], v[184:187], v[128:143]
    ds_read_b64_tr_b16 v[44:45], v8 offset:14336
    ds_read_b64_tr_b16 v[46:47], v8 offset:14848
    s_waitcnt lgkmcnt(6)
    v_mfma_f32_32x32x16_bf16 v[80:95], v[56:59], v[188:191], v[80:95]
    ds_read_b64_tr_b16 v[48:49], v6 offset:49152
    ds_read_b64_tr_b16 v[50:51], v6 offset:49664
    s_waitcnt lgkmcnt(6)
    v_mfma_f32_32x32x16_bf16 v[96:111], v[60:63], v[188:191], v[96:111]
    ds_read_b64_tr_b16 v[52:53], v6 offset:57344
    ds_read_b64_tr_b16 v[54:55], v6 offset:57856
    s_waitcnt lgkmcnt(6)
    v_mfma_f32_32x32x16_bf16 v[112:127], v[40:43], v[188:191], v[112:127]
    ds_read_b64_tr_b16 v[56:57], v9 offset:49152
    ds_read_b64_tr_b16 v[58:59], v9 offset:49664
    s_waitcnt lgkmcnt(6)
    v_mfma_f32_32x32x16_bf16 v[128:143], v[44:47], v[188:191], v[128:143]
    ds_read_b64_tr_b16 v[60:61], v9 offset:57344
    ds_read_b64_tr_b16 v[62:63], v9 offset:57856
    s_waitcnt lgkmcnt(6)
    v_mfma_f32_32x32x16_bf16 v[80:95], v[48:51], v[192:195], v[80:95]
    ds_read_b64_tr_b16 v[40:41], v6 offset:51200
    ds_read_b64_tr_b16 v[42:43], v6 offset:51712
    s_waitcnt lgkmcnt(6)
    v_mfma_f32_32x32x16_bf16 v[96:111], v[52:55], v[192:195], v[96:111]
    ds_read_b64_tr_b16 v[44:45], v6 offset:59392
    ds_read_b64_tr_b16 v[46:47], v6 offset:59904
    s_waitcnt lgkmcnt(6)
    v_mfma_f32_32x32x16_bf16 v[112:127], v[56:59], v[192:195], v[112:127]
    ds_read_b64_tr_b16 v[48:49], v9 offset:51200
    ds_read_b64_tr_b16 v[50:51], v9 offset:51712
    s_waitcnt lgkmcnt(6)
    v_mfma_f32_32x32x16_bf16 v[128:143], v[60:63], v[192:195], v[128:143]
    ds_read_b64_tr_b16 v[52:53], v9 offset:59392
    ds_read_b64_tr_b16 v[54:55], v9 offset:59904
    s_waitcnt lgkmcnt(6)
    v_mfma_f32_32x32x16_bf16 v[80:95], v[40:43], v[196:199], v[80:95]
    ds_read_b64_tr_b16 v[56:57], v6 offset:53248
    ds_read_b64_tr_b16 v[58:59], v6 offset:53760
    s_waitcnt lgkmcnt(6)
    v_mfma_f32_32x32x16_bf16 v[96:111], v[44:47], v[196:199], v[96:111]
    ds_read_b64_tr_b16 v[60:61], v6 offset:61440
    ds_read_b64_tr_b16 v[62:63], v6 offset:61952
    s_waitcnt lgkmcnt(6)
    v_mfma_f32_32x32x16_bf16 v[112:127], v[48:51], v[196:199], v[112:127]
    ds_read_b64_tr_b16 v[40:41], v9 offset:53248
    ds_read_b64_tr_b16 v[42:43], v9 offset:53760
    s_waitcnt lgkmcnt(6)
    v_mfma_f32_32x32x16_bf16 v[128:143], v[52:55], v[196:199], v[128:143]
    ds_read_b64_tr_b16 v[44:45], v9 offset:61440
    ds_read_b64_tr_b16 v[46:47], v9 offset:61952
    s_waitcnt lgkmcnt(6)
    v_mfma_f32_32x32x16_bf16 v[80:95], v[56:59], v[200:203], v[80:95]
    ds_read_b64_tr_b16 v[48:49], v6 offset:55296
    ds_read_b64_tr_b16 v[50:51], v6 offset:55808
    s_waitcnt lgkmcnt(6)
    v_mfma_f32_32x32x16_bf16 v[96:111], v[60:63], v[200:203], v[96:111]
    ds_read_b64_tr_b16 v[52:53], v6 offset:63488
    ds_read_b64_tr_b16 v[54:55], v6 offset:64000
    s_waitcnt lgkmcnt(6)
    v_mfma_f32_32x32x16_bf16 v[112:127], v[40:43], v[200:203], v[112:127]
    ds_read_b64_tr_b16 v[56:57], v9 offset:55296
    ds_read_b64_tr_b16 v[58:59], v9 offset:55808
    s_waitcnt lgkmcnt(6)
    v_mfma_f32_32x32x16_bf16 v[128:143], v[44:47], v[200:203], v[128:143]
    ds_read_b64_tr_b16 v[60:61], v9 offset:63488
    ds_read_b64_tr_b16 v[62:63], v9 offset:64000
    s_waitcnt lgkmcnt(6)
    v_mfma_f32_32x32x16_bf16 v[80:95], v[48:51], v[204:207], v[80:95]
    ds_read_b64_tr_b16 v[40:41], v7 offset:0
    ds_read_b64_tr_b16 v[42:43], v7 offset:512
    s_waitcnt lgkmcnt(6)
    v_mfma_f32_32x32x16_bf16 v[96:111], v[52:55], v[204:207], v[96:111]
    ds_read_b64_tr_b16 v[44:45], v7 offset:8192
    ds_read_b64_tr_b16 v[46:47], v7 offset:8704
    s_waitcnt lgkmcnt(6)
    v_mfma_f32_32x32x16_bf16 v[112:127], v[56:59], v[204:207], v[112:127]
    ds_read_b64_tr_b16 v[48:49], v10 offset:0
    ds_read_b64_tr_b16 v[50:51], v10 offset:512
    s_waitcnt lgkmcnt(6)
    v_mfma_f32_32x32x16_bf16 v[128:143], v[60:63], v[204:207], v[128:143]
    ds_read_b64_tr_b16 v[52:53], v10 offset:8192
    ds_read_b64_tr_b16 v[54:55], v10 offset:8704
    s_waitcnt lgkmcnt(6)
    v_mfma_f32_32x32x16_bf16 v[80:95], v[40:43], v[208:211], v[80:95]
    s_waitcnt vmcnt(0)
    s_barrier
    ds_read_b64_tr_b16 v[56:57], v7 offset:2048
    ds_read_b64_tr_b16 v[58:59], v7 offset:2560
    s_waitcnt lgkmcnt(6)
    v_mfma_f32_32x32x16_bf16 v[96:111], v[44:47], v[208:211], v[96:111]
    ds_read_b64_tr_b16 v[60:61], v7 offset:10240
    ds_read_b64_tr_b16 v[62:63], v7 offset:10752
    s_waitcnt lgkmcnt(6)
    v_mfma_f32_32x32x16_bf16 v[112:127], v[48:51], v[208:211], v[112:127]
    ds_read_b64_tr_b16 v[40:41], v10 offset:2048
    ds_read_b64_tr_b16 v[42:43], v10 offset:2560
    s_waitcnt lgkmcnt(6)
    v_mfma_f32_32x32x16_bf16 v[128:143], v[52:55], v[208:211], v[128:143]
    ds_read_b64_tr_b16 v[44:45], v10 offset:10240
    ds_read_b64_tr_b16 v[46:47], v10 offset:10752
    s_waitcnt lgkmcnt(6)
    v_mfma_f32_32x32x16_bf16 v[80:95], v[56:59], v[212:215], v[80:95]
    ds_read_b64_tr_b16 v[48:49], v7 offset:4096
    ds_read_b64_tr_b16 v[50:51], v7 offset:4608
    s_waitcnt lgkmcnt(6)
    v_mfma_f32_32x32x16_bf16 v[96:111], v[60:63], v[212:215], v[96:111]
    ds_read_b64_tr_b16 v[52:53], v7 offset:12288
    ds_read_b64_tr_b16 v[54:55], v7 offset:12800
    s_waitcnt lgkmcnt(6)
    v_mfma_f32_32x32x16_bf16 v[112:127], v[40:43], v[212:215], v[112:127]
    ds_read_b64_tr_b16 v[56:57], v10 offset:4096
    ds_read_b64_tr_b16 v[58:59], v10 offset:4608
    s_waitcnt lgkmcnt(6)
    v_mfma_f32_32x32x16_bf16 v[128:143], v[44:47], v[212:215], v[128:143]
    ds_read_b64_tr_b16 v[60:61], v10 offset:12288
    ds_read_b64_tr_b16 v[62:63], v10 offset:12800
    s_waitcnt lgkmcnt(6)
    v_mfma_f32_32x32x16_bf16 v[80:95], v[48:51], v[216:219], v[80:95]
    ds_read_b64_tr_b16 v[40:41], v7 offset:6144
    ds_read_b64_tr_b16 v[42:43], v7 offset:6656
    s_waitcnt lgkmcnt(6)
    v_mfma_f32_32x32x16_bf16 v[96:111], v[52:55], v[216:219], v[96:111]
    ds_read_b64_tr_b16 v[44:45], v7 offset:14336
    ds_read_b64_tr_b16 v[46:47], v7 offset:14848
    s_waitcnt lgkmcnt(6)
    v_mfma_f32_32x32x16_bf16 v[112:127], v[56:59], v[216:219], v[112:127]
    ds_read_b64_tr_b16 v[48:49], v10 offset:6144
    ds_read_b64_tr_b16 v[50:51], v10 offset:6656
    s_waitcnt lgkmcnt(6)
    v_mfma_f32_32x32x16_bf16 v[128:143], v[60:63], v[216:219], v[128:143]
    ds_read_b64_tr_b16 v[52:53], v10 offset:14336
    ds_read_b64_tr_b16 v[54:55], v10 offset:14848
    s_waitcnt lgkmcnt(6)
    v_mfma_f32_32x32x16_bf16 v[80:95], v[40:43], v[220:223], v[80:95]
    ds_read_b64_tr_b16 v[56:57], v7 offset:16384
    ds_read_b64_tr_b16 v[58:59], v7 offset:16896
    s_waitcnt lgkmcnt(6)
    v_mfma_f32_32x32x16_bf16 v[96:111], v[44:47], v[220:223], v[96:111]
    ds_read_b64_tr_b16 v[60:61], v7 offset:24576
    ds_read_b64_tr_b16 v[62:63], v7 offset:25088
    s_waitcnt lgkmcnt(6)
    v_mfma_f32_32x32x16_bf16 v[112:127], v[48:51], v[220:223], v[112:127]
    ds_read_b64_tr_b16 v[40:41], v10 offset:16384
    ds_read_b64_tr_b16 v[42:43], v10 offset:16896
    s_waitcnt lgkmcnt(6)
    v_mfma_f32_32x32x16_bf16 v[128:143], v[52:55], v[220:223], v[128:143]
    ds_read_b64_tr_b16 v[44:45], v10 offset:24576
    ds_read_b64_tr_b16 v[46:47], v10 offset:25088
    s_waitcnt lgkmcnt(6)
    v_mfma_f32_32x32x16_bf16 v[80:95], v[56:59], v[224:227], v[80:95]
    s_barrier
    ds_read_b64_tr_b16 v[48:49], v7 offset:18432
    ds_read_b64_tr_b16 v[50:51], v7 offset:18944
    s_waitcnt lgkmcnt(6)
    v_mfma_f32_32x32x16_bf16 v[96:111], v[60:63], v[224:227], v[96:111]
    ds_read_b64_tr_b16 v[52:53], v7 offset:26624
    ds_read_b64_tr_b16 v[54:55], v7 offset:27136
    s_waitcnt lgkmcnt(6)
    v_mfma_f32_32x32x16_bf16 v[112:127], v[40:43], v[224:227], v[112:127]
    ds_read_b64_tr_b16 v[56:57], v10 offset:18432
    ds_read_b64_tr_b16 v[58:59], v10 offset:18944
    s_waitcnt lgkmcnt(6)
    v_mfma_f32_32x32x16_bf16 v[128:143], v[44:47], v[224:227], v[128:143]
    ds_read_b64_tr_b16 v[60:61], v10 offset:26624
    ds_read_b64_tr_b16 v[62:63], v10 offset:27136
    s_waitcnt lgkmcnt(6)
    v_mfma_f32_32x32x16_bf16 v[80:95], v[48:51], v[228:231], v[80:95]
    ds_read_b64_tr_b16 v[40:41], v7 offset:20480
    ds_read_b64_tr_b16 v[42:43], v7 offset:20992
    s_waitcnt lgkmcnt(6)
    v_mfma_f32_32x32x16_bf16 v[96:111], v[52:55], v[228:231], v[96:111]
    ds_read_b64_tr_b16 v[44:45], v7 offset:28672
    ds_read_b64_tr_b16 v[46:47], v7 offset:29184
    s_waitcnt lgkmcnt(6)
    v_mfma_f32_32x32x16_bf16 v[112:127], v[56:59], v[228:231], v[112:127]
    ds_read_b64_tr_b16 v[48:49], v10 offset:20480
    ds_read_b64_tr_b16 v[50:51], v10 offset:20992
    s_waitcnt lgkmcnt(6)
    v_mfma_f32_32x32x16_bf16 v[128:143], v[60:63], v[228:231], v[128:143]
    ds_read_b64_tr_b16 v[52:53], v10 offset:28672
    ds_read_b64_tr_b16 v[54:55], v10 offset:29184
    s_waitcnt lgkmcnt(6)
    v_mfma_f32_32x32x16_bf16 v[80:95], v[40:43], v[232:235], v[80:95]
    ds_read_b64_tr_b16 v[56:57], v7 offset:22528
    ds_read_b64_tr_b16 v[58:59], v7 offset:23040
    s_waitcnt lgkmcnt(6)
    v_mfma_f32_32x32x16_bf16 v[96:111], v[44:47], v[232:235], v[96:111]
    ds_read_b64_tr_b16 v[60:61], v7 offset:30720
    ds_read_b64_tr_b16 v[62:63], v7 offset:31232
    s_waitcnt lgkmcnt(6)
    v_mfma_f32_32x32x16_bf16 v[112:127], v[48:51], v[232:235], v[112:127]
    ds_read_b64_tr_b16 v[40:41], v10 offset:22528
    ds_read_b64_tr_b16 v[42:43], v10 offset:23040
    s_waitcnt lgkmcnt(6)
    v_mfma_f32_32x32x16_bf16 v[128:143], v[52:55], v[232:235], v[128:143]
    ds_read_b64_tr_b16 v[44:45], v10 offset:30720
    ds_read_b64_tr_b16 v[46:47], v10 offset:31232
    s_waitcnt lgkmcnt(6)
    v_mfma_f32_32x32x16_bf16 v[80:95], v[56:59], v[236:239], v[80:95]
    ds_read_b64_tr_b16 v[48:49], v5 offset:16384
    ds_read_b64_tr_b16 v[50:51], v5 offset:16896
    s_waitcnt lgkmcnt(6)
    v_mfma_f32_32x32x16_bf16 v[96:111], v[60:63], v[236:239], v[96:111]
    ds_read_b64_tr_b16 v[52:53], v6 offset:8192
    ds_read_b64_tr_b16 v[54:55], v6 offset:8704
    s_waitcnt lgkmcnt(6)
    v_mfma_f32_32x32x16_bf16 v[112:127], v[40:43], v[236:239], v[112:127]
    ds_read_b64_tr_b16 v[56:57], v8 offset:16384
    ds_read_b64_tr_b16 v[58:59], v8 offset:16896
    s_waitcnt lgkmcnt(6)
    v_mfma_f32_32x32x16_bf16 v[128:143], v[44:47], v[236:239], v[128:143]
    ds_read_b64_tr_b16 v[60:61], v9 offset:8192
    ds_read_b64_tr_b16 v[62:63], v9 offset:8704
    s_waitcnt lgkmcnt(6)
    v_mfma_f32_32x32x16_bf16 v[80:95], v[48:51], v[240:243], v[80:95]
    s_barrier
    ds_read_b64_tr_b16 v[40:41], v5 offset:18432
    ds_read_b64_tr_b16 v[42:43], v5 offset:18944
    s_waitcnt lgkmcnt(6)
    v_mfma_f32_32x32x16_bf16 v[96:111], v[52:55], v[240:243], v[96:111]
    ds_read_b64_tr_b16 v[44:45], v6 offset:10240
    ds_read_b64_tr_b16 v[46:47], v6 offset:10752
    s_waitcnt lgkmcnt(6)
    v_mfma_f32_32x32x16_bf16 v[112:127], v[56:59], v[240:243], v[112:127]
    ds_read_b64_tr_b16 v[48:49], v8 offset:18432
    ds_read_b64_tr_b16 v[50:51], v8 offset:18944
    s_waitcnt lgkmcnt(6)
    v_mfma_f32_32x32x16_bf16 v[128:143], v[60:63], v[240:243], v[128:143]
    ds_read_b64_tr_b16 v[52:53], v9 offset:10240
    ds_read_b64_tr_b16 v[54:55], v9 offset:10752
    s_waitcnt lgkmcnt(6)
    v_mfma_f32_32x32x16_bf16 v[80:95], v[40:43], v[244:247], v[80:95]
    ds_read_b64_tr_b16 v[56:57], v5 offset:20480
    ds_read_b64_tr_b16 v[58:59], v5 offset:20992
    s_waitcnt lgkmcnt(6)
    v_mfma_f32_32x32x16_bf16 v[96:111], v[44:47], v[244:247], v[96:111]
    ds_read_b64_tr_b16 v[60:61], v6 offset:12288
    ds_read_b64_tr_b16 v[62:63], v6 offset:12800
    s_waitcnt lgkmcnt(6)
    v_mfma_f32_32x32x16_bf16 v[112:127], v[48:51], v[244:247], v[112:127]
    ds_read_b64_tr_b16 v[40:41], v8 offset:20480
    ds_read_b64_tr_b16 v[42:43], v8 offset:20992
    s_waitcnt lgkmcnt(6)
    v_mfma_f32_32x32x16_bf16 v[128:143], v[52:55], v[244:247], v[128:143]
    ds_read_b64_tr_b16 v[44:45], v9 offset:12288
    ds_read_b64_tr_b16 v[46:47], v9 offset:12800
    s_waitcnt lgkmcnt(6)
    v_mfma_f32_32x32x16_bf16 v[80:95], v[56:59], v[248:251], v[80:95]
    ds_read_b64_tr_b16 v[48:49], v5 offset:22528
    ds_read_b64_tr_b16 v[50:51], v5 offset:23040
    s_waitcnt lgkmcnt(6)
    v_mfma_f32_32x32x16_bf16 v[96:111], v[60:63], v[248:251], v[96:111]
    ds_read_b64_tr_b16 v[52:53], v6 offset:14336
    ds_read_b64_tr_b16 v[54:55], v6 offset:14848
    s_waitcnt lgkmcnt(6)
    v_mfma_f32_32x32x16_bf16 v[112:127], v[40:43], v[248:251], v[112:127]
    ds_read_b64_tr_b16 v[56:57], v8 offset:22528
    ds_read_b64_tr_b16 v[58:59], v8 offset:23040
    s_waitcnt lgkmcnt(6)
    v_mfma_f32_32x32x16_bf16 v[128:143], v[44:47], v[248:251], v[128:143]
    ds_read_b64_tr_b16 v[60:61], v9 offset:14336
    ds_read_b64_tr_b16 v[62:63], v9 offset:14848
    s_waitcnt lgkmcnt(6)
    v_mfma_f32_32x32x16_bf16 v[80:95], v[48:51], v[252:255], v[80:95]
    s_waitcnt lgkmcnt(4)
    v_mfma_f32_32x32x16_bf16 v[96:111], v[52:55], v[252:255], v[96:111]
    s_waitcnt lgkmcnt(2)
    v_mfma_f32_32x32x16_bf16 v[112:127], v[56:59], v[252:255], v[112:127]
    s_waitcnt lgkmcnt(0)
    v_mfma_f32_32x32x16_bf16 v[128:143], v[60:63], v[252:255], v[128:143]
    s_barrier
    s_setprio 1
    s_nop 3
    v_pk_mul_f32 v[20:21], v[80:81], s[82:83] op_sel_hi:[1,0] neg_lo:[1,0] neg_hi:[1,0]
    s_nop 0
    v_pk_mul_f32 v[80:81], v[80:81], v[96:97]
    v_exp_f32 v20, v20
    v_exp_f32 v21, v21
    v_pk_mul_f32 v[22:23], v[82:83], s[82:83] op_sel_hi:[1,0] neg_lo:[1,0] neg_hi:[1,0]
    v_pk_mul_f32 v[82:83], v[82:83], v[98:99]
    v_pk_fma_f32 v[20:21], v[20:21], v[32:33], v[32:33] op_sel_hi:[1,0,0]
    v_exp_f32 v22, v22
    v_exp_f32 v23, v23
    v_rcp_f32 v20, v20
    v_rcp_f32 v21, v21
    v_pk_mul_f32 v[24:25], v[84:85], s[82:83] op_sel_hi:[1,0] neg_lo:[1,0] neg_hi:[1,0]
    v_pk_mul_f32 v[84:85], v[84:85], v[100:101]
    v_pk_fma_f32 v[22:23], v[22:23], v[32:33], v[32:33] op_sel_hi:[1,0,0]
    v_pk_mul_f32 v[80:81], v[80:81], v[20:21]
    v_exp_f32 v24, v24
    v_exp_f32 v25, v25
    v_rcp_f32 v22, v22
    v_rcp_f32 v23, v23
    v_cvt_pk_bf16_f32 v12, v80, v81
    v_pk_mul_f32 v[26:27], v[86:87], s[82:83] op_sel_hi:[1,0] neg_lo:[1,0] neg_hi:[1,0]
    v_pk_mul_f32 v[86:87], v[86:87], v[102:103]
    v_pk_fma_f32 v[24:25], v[24:25], v[32:33], v[32:33] op_sel_hi:[1,0,0]
    v_pk_mul_f32 v[82:83], v[82:83], v[22:23]
    v_exp_f32 v26, v26
    v_exp_f32 v27, v27
    v_rcp_f32 v24, v24
    v_rcp_f32 v25, v25
    v_cvt_pk_bf16_f32 v13, v82, v83
    v_pk_mul_f32 v[20:21], v[88:89], s[82:83] op_sel_hi:[1,0] neg_lo:[1,0] neg_hi:[1,0]
    v_pk_mul_f32 v[88:89], v[88:89], v[104:105]
    v_pk_fma_f32 v[26:27], v[26:27], v[32:33], v[32:33] op_sel_hi:[1,0,0]
    v_pk_mul_f32 v[84:85], v[84:85], v[24:25]
    v_exp_f32 v20, v20
    v_exp_f32 v21, v21
    v_rcp_f32 v26, v26
    v_rcp_f32 v27, v27
    v_cvt_pk_bf16_f32 v14, v84, v85
    v_pk_mul_f32 v[22:23], v[90:91], s[82:83] op_sel_hi:[1,0] neg_lo:[1,0] neg_hi:[1,0]
    v_pk_mul_f32 v[90:91], v[90:91], v[106:107]
    v_pk_fma_f32 v[20:21], v[20:21], v[32:33], v[32:33] op_sel_hi:[1,0,0]
    v_pk_mul_f32 v[86:87], v[86:87], v[26:27]
    v_exp_f32 v22, v22
    v_exp_f32 v23, v23
    v_rcp_f32 v20, v20
    v_rcp_f32 v21, v21
    v_cvt_pk_bf16_f32 v15, v86, v87
    buffer_store_dwordx4 v[12:15], v0, s[28:31], s40 offen offset:0 sc1
    v_pk_mul_f32 v[24:25], v[92:93], s[82:83] op_sel_hi:[1,0] neg_lo:[1,0] neg_hi:[1,0]
    v_pk_mul_f32 v[92:93], v[92:93], v[108:109]
    v_pk_fma_f32 v[22:23], v[22:23], v[32:33], v[32:33] op_sel_hi:[1,0,0]
    v_pk_mul_f32 v[88:89], v[88:89], v[20:21]
    v_exp_f32 v24, v24
    v_exp_f32 v25, v25
    v_rcp_f32 v22, v22
    v_rcp_f32 v23, v23
    v_cvt_pk_bf16_f32 v16, v88, v89
    v_pk_mul_f32 v[26:27], v[94:95], s[82:83] op_sel_hi:[1,0] neg_lo:[1,0] neg_hi:[1,0]
    v_pk_mul_f32 v[94:95], v[94:95], v[110:111]
    v_pk_fma_f32 v[24:25], v[24:25], v[32:33], v[32:33] op_sel_hi:[1,0,0]
    v_pk_mul_f32 v[90:91], v[90:91], v[22:23]
    v_exp_f32 v26, v26
    v_exp_f32 v27, v27
    v_rcp_f32 v24, v24
    v_rcp_f32 v25, v25
    v_cvt_pk_bf16_f32 v17, v90, v91
    v_pk_fma_f32 v[26:27], v[26:27], v[32:33], v[32:33] op_sel_hi:[1,0,0]
    v_pk_mul_f32 v[92:93], v[92:93], v[24:25]
    v_rcp_f32 v26, v26
    v_rcp_f32 v27, v27
    v_cvt_pk_bf16_f32 v18, v92, v93
    v_pk_mul_f32 v[94:95], v[94:95], v[26:27]
    v_cvt_pk_bf16_f32 v19, v94, v95
    buffer_store_dwordx4 v[16:19], v0, s[28:31], s40 offen offset:1024 sc1
    v_pk_mul_f32 v[20:21], v[112:113], s[82:83] op_sel_hi:[1,0] neg_lo:[1,0] neg_hi:[1,0]
    v_pk_mul_f32 v[112:113], v[112:113], v[128:129]
    v_exp_f32 v20, v20
    v_exp_f32 v21, v21
    v_pk_mul_f32 v[22:23], v[114:115], s[82:83] op_sel_hi:[1,0] neg_lo:[1,0] neg_hi:[1,0]
    v_pk_mul_f32 v[114:115], v[114:115], v[130:131]
    v_pk_fma_f32 v[20:21], v[20:21], v[32:33], v[32:33] op_sel_hi:[1,0,0]
    v_exp_f32 v22, v22
    v_exp_f32 v23, v23
    v_rcp_f32 v20, v20
    v_rcp_f32 v21, v21
    v_pk_mul_f32 v[24:25], v[116:117], s[82:83] op_sel_hi:[1,0] neg_lo:[1,0] neg_hi:[1,0]
    v_pk_mul_f32 v[116:117], v[116:117], v[132:133]
    v_pk_fma_f32 v[22:23], v[22:23], v[32:33], v[32:33] op_sel_hi:[1,0,0]
    v_pk_mul_f32 v[112:113], v[112:113], v[20:21]
    v_exp_f32 v24, v24
    v_exp_f32 v25, v25
    v_rcp_f32 v22, v22
    v_rcp_f32 v23, v23
    v_cvt_pk_bf16_f32 v12, v112, v113
    v_pk_mul_f32 v[26:27], v[118:119], s[82:83] op_sel_hi:[1,0] neg_lo:[1,0] neg_hi:[1,0]
    v_pk_mul_f32 v[118:119], v[118:119], v[134:135]
    v_pk_fma_f32 v[24:25], v[24:25], v[32:33], v[32:33] op_sel_hi:[1,0,0]
    v_pk_mul_f32 v[114:115], v[114:115], v[22:23]
    v_exp_f32 v26, v26
    v_exp_f32 v27, v27
    v_rcp_f32 v24, v24
    v_rcp_f32 v25, v25
    v_cvt_pk_bf16_f32 v13, v114, v115
    v_pk_mul_f32 v[20:21], v[120:121], s[82:83] op_sel_hi:[1,0] neg_lo:[1,0] neg_hi:[1,0]
    v_pk_mul_f32 v[120:121], v[120:121], v[136:137]
    v_pk_fma_f32 v[26:27], v[26:27], v[32:33], v[32:33] op_sel_hi:[1,0,0]
    v_pk_mul_f32 v[116:117], v[116:117], v[24:25]
    v_exp_f32 v20, v20
    v_exp_f32 v21, v21
    v_rcp_f32 v26, v26
    v_rcp_f32 v27, v27
    v_cvt_pk_bf16_f32 v14, v116, v117
    v_pk_mul_f32 v[22:23], v[122:123], s[82:83] op_sel_hi:[1,0] neg_lo:[1,0] neg_hi:[1,0]
    v_pk_mul_f32 v[122:123], v[122:123], v[138:139]
    v_pk_fma_f32 v[20:21], v[20:21], v[32:33], v[32:33] op_sel_hi:[1,0,0]
    v_pk_mul_f32 v[118:119], v[118:119], v[26:27]
    v_exp_f32 v22, v22
    v_exp_f32 v23, v23
    v_rcp_f32 v20, v20
    v_rcp_f32 v21, v21
    v_cvt_pk_bf16_f32 v15, v118, v119
    buffer_store_dwordx4 v[12:15], v0, s[28:31], s40 offen offset:2048 sc1
    v_pk_mul_f32 v[24:25], v[124:125], s[82:83] op_sel_hi:[1,0] neg_lo:[1,0] neg_hi:[1,0]
    v_pk_mul_f32 v[124:125], v[124:125], v[140:141]
    v_pk_fma_f32 v[22:23], v[22:23], v[32:33], v[32:33] op_sel_hi:[1,0,0]
    v_pk_mul_f32 v[120:121], v[120:121], v[20:21]
    v_exp_f32 v24, v24
    v_exp_f32 v25, v25
    v_rcp_f32 v22, v22
    v_rcp_f32 v23, v23
    v_cvt_pk_bf16_f32 v16, v120, v121
    v_pk_mul_f32 v[26:27], v[126:127], s[82:83] op_sel_hi:[1,0] neg_lo:[1,0] neg_hi:[1,0]
    v_pk_mul_f32 v[126:127], v[126:127], v[142:143]
    v_pk_fma_f32 v[24:25], v[24:25], v[32:33], v[32:33] op_sel_hi:[1,0,0]
    v_pk_mul_f32 v[122:123], v[122:123], v[22:23]
    v_exp_f32 v26, v26
    v_exp_f32 v27, v27
    v_rcp_f32 v24, v24
    v_rcp_f32 v25, v25
    v_cvt_pk_bf16_f32 v17, v122, v123
    v_pk_fma_f32 v[26:27], v[26:27], v[32:33], v[32:33] op_sel_hi:[1,0,0]
    v_pk_mul_f32 v[124:125], v[124:125], v[24:25]
    v_rcp_f32 v26, v26
    v_rcp_f32 v27, v27
    v_cvt_pk_bf16_f32 v18, v124, v125
    v_pk_mul_f32 v[126:127], v[126:127], v[26:27]
    v_cvt_pk_bf16_f32 v19, v126, v127
    buffer_store_dwordx4 v[16:19], v0, s[28:31], s40 offen offset:3072 sc1
    s_barrier
    buffer_load_dwordx4 v[144:147], v4, s[28:31], s96 offen offset:0 sc1
    buffer_load_dwordx4 v[148:151], v4, s[28:31], s96 offen offset:1024 sc1
    s_add_u32 s96, s96, s97
    buffer_load_dwordx4 v[152:155], v4, s[28:31], s96 offen offset:0 sc1
    v_add_u32 v5, 0, v39
    v_add_u32 v6, 65536, v39
    v_add_u32 v7, 131072, v39
    v_xor_b32 v8, 64, v5
    v_xor_b32 v9, 64, v6
    v_xor_b32 v10, 64, v7
    ds_read_b64_tr_b16 v[40:41], v6 offset:16384
    ds_read_b64_tr_b16 v[42:43], v6 offset:17408
    ds_read_b64_tr_b16 v[44:45], v9 offset:16384
    ds_read_b64_tr_b16 v[46:47], v9 offset:17408
    ds_read_b64_tr_b16 v[48:49], v6 offset:18432
    ds_read_b64_tr_b16 v[50:51], v6 offset:19456
    ds_read_b64_tr_b16 v[52:53], v9 offset:18432
    ds_read_b64_tr_b16 v[54:55], v9 offset:19456
    s_waitcnt vmcnt(3)
    buffer_store_dword v34, v33, s[28:31], s46 offen sc1
    buffer_load_dwordx4 v[156:159], v4, s[28:31], s96 offen offset:1024 sc1
    s_add_u32 s96, s96, s97
    buffer_load_dwordx4 v[160:163], v4, s[28:31], s96 offen offset:0 sc1
    buffer_load_dwordx4 v[164:167], v4, s[28:31], s96 offen offset:1024 sc1
    s_add_u32 s96, s96, s97
    s_setprio 0
    s_waitcnt vmcnt(6)
    s_waitcnt lgkmcnt(6)
    v_mfma_f32_32x32x16_bf16 v[112:127], v[40:43], v[144:147], 0
    ds_read_b64_tr_b16 v[56:57], v6 offset:24576
    ds_read_b64_tr_b16 v[58:59], v6 offset:25600
    buffer_load_dwordx4 v[168:171], v4, s[28:31], s96 offen offset:0 sc1
    s_waitcnt lgkmcnt(6)
    v_mfma_f32_32x32x16_bf16 v[128:143], v[44:47], v[144:147], 0
    ds_read_b64_tr_b16 v[60:61], v9 offset:24576
    ds_read_b64_tr_b16 v[62:63], v9 offset:25600
    buffer_load_dwordx4 v[172:175], v4, s[28:31], s96 offen offset:1024 sc1
    s_add_u32 s96, s96, s97
    s_waitcnt vmcnt(7)
    s_waitcnt lgkmcnt(6)
    v_mfma_f32_32x32x16_bf16 v[112:127], v[48:51], v[148:151], v[112:127]
    ds_read_b64_tr_b16 v[40:41], v6 offset:26624
    ds_read_b64_tr_b16 v[42:43], v6 offset:27648
    buffer_load_dwordx4 v[176:179], v4, s[28:31], s96 offen offset:0 sc1
    s_waitcnt lgkmcnt(6)
    v_mfma_f32_32x32x16_bf16 v[128:143], v[52:55], v[148:151], v[128:143]
    ds_read_b64_tr_b16 v[44:45], v9 offset:26624
    ds_read_b64_tr_b16 v[46:47], v9 offset:27648
    buffer_load_dwordx4 v[180:183], v4, s[28:31], s96 offen offset:1024 sc1
    s_add_u32 s96, s96, s97
    s_waitcnt vmcnt(8)
    s_waitcnt lgkmcnt(6)
    v_mfma_f32_32x32x16_bf16 v[112:127], v[56:59], v[152:155], v[112:127]
    ds_read_b64_tr_b16 v[48:49], v5 offset:24576
    ds_read_b64_tr_b16 v[50:51], v5 offset:25600
    buffer_load_dwordx4 v[184:187], v4, s[28:31], s96 offen offset:0 sc1
    s_waitcnt lgkmcnt(6)
    v_mfma_f32_32x32x16_bf16 v[128:143], v[60:63], v[152:155], v[128:143]
    ds_read_b64_tr_b16 v[52:53], v8 offset:24576
    ds_read_b64_tr_b16 v[54:55], v8 offset:25600
    buffer_load_dwordx4 v[188:191], v4, s[28:31], s96 offen offset:1024 sc1
    s_add_u32 s96, s96, s97
    s_waitcnt vmcnt(8)
    s_waitcnt lgkmcnt(6)
    v_mfma_f32_32x32x16_bf16 v[112:127], v[40:43], v[156:159], v[112:127]
    ds_read_b64_tr_b16 v[56:57], v5 offset:26624
    ds_read_b64_tr_b16 v[58:59], v5 offset:27648
    buffer_load_dwordx4 v[192:195], v4, s[28:31], s96 offen offset:0 sc1
    s_waitcnt lgkmcnt(6)
    v_mfma_f32_32x32x16_bf16 v[128:143], v[44:47], v[156:159], v[128:143]
    ds_read_b64_tr_b16 v[60:61], v8 offset:26624
    ds_read_b64_tr_b16 v[62:63], v8 offset:27648
    buffer_load_dwordx4 v[196:199], v4, s[28:31], s96 offen offset:1024 sc1
    s_mov_b32 s96, 4096
    s_waitcnt vmcnt(9)
    s_waitcnt lgkmcnt(6)
    v_mfma_f32_32x32x16_bf16 v[112:127], v[48:51], v[160:163], v[112:127]
    s_barrier
    ds_read_b64_tr_b16 v[40:41], v5 offset:32768
    ds_read_b64_tr_b16 v[42:43], v5 offset:33792
    s_mov_b32 s95, 301056
    s_waitcnt lgkmcnt(6)
    v_mfma_f32_32x32x16_bf16 v[128:143], v[52:55], v[160:163], v[128:143]
    s_add_u32 m0, s73, 81920
    ds_read_b64_tr_b16 v[44:45], v8 offset:32768
    ds_read_b64_tr_b16 v[46:47], v8 offset:33792
    buffer_load_dwordx4 v3, s[24:27], s95 offen lds
    s_add_u32 s95, s95, s98
    s_waitcnt vmcnt(9)
    s_waitcnt lgkmcnt(6)
    v_mfma_f32_32x32x16_bf16 v[112:127], v[56:59], v[164:167], v[112:127]
    s_add_u32 m0, s73, 90112
    ds_read_b64_tr_b16 v[48:49], v5 offset:34816
    ds_read_b64_tr_b16 v[50:51], v5 offset:35840
    buffer_load_dwordx4 v3, s[24:27], s95 offen lds
    s_add_u32 s95, s95, s98
    s_waitcnt lgkmcnt(6)
    v_mfma_f32_32x32x16_bf16 v[128:143], v[60:63], v[164:167], v[128:143]
    ds_read_b64_tr_b16 v[52:53], v8 offset:34816
    ds_read_b64_tr_b16 v[54:55], v8 offset:35840
    s_waitcnt vmcnt(9)
    s_waitcnt lgkmcnt(6)
    v_mfma_f32_32x32x16_bf16 v[112:127], v[40:43], v[168:171], v[112:127]
    ds_read_b64_tr_b16 v[56:57], v5 offset:40960
    ds_read_b64_tr_b16 v[58:59], v5 offset:41984
    s_waitcnt lgkmcnt(6)
    v_mfma_f32_32x32x16_bf16 v[128:143], v[44:47], v[168:171], v[128:143]
    ds_read_b64_tr_b16 v[60:61], v8 offset:40960
    ds_read_b64_tr_b16 v[62:63], v8 offset:41984
    s_waitcnt vmcnt(8)
    s_waitcnt lgkmcnt(6)
    v_mfma_f32_32x32x16_bf16 v[112:127], v[48:51], v[172:175], v[112:127]
    ds_read_b64_tr_b16 v[40:41], v5 offset:43008
    ds_read_b64_tr_b16 v[42:43], v5 offset:44032
    s_waitcnt lgkmcnt(6)
    v_mfma_f32_32x32x16_bf16 v[128:143], v[52:55], v[172:175], v[128:143]
    ds_read_b64_tr_b16 v[44:45], v8 offset:43008
    ds_read_b64_tr_b16 v[46:47], v8 offset:44032
    s_waitcnt vmcnt(7)
    s_waitcnt lgkmcnt(6)
    v_mfma_f32_32x32x16_bf16 v[112:127], v[56:59], v[176:179], v[112:127]
    ds_read_b64_tr_b16 v[48:49], v5 offset:49152
    ds_read_b64_tr_b16 v[50:51], v5 offset:50176
    s_waitcnt lgkmcnt(6)
    v_mfma_f32_32x32x16_bf16 v[128:143], v[60:63], v[176:179], v[128:143]
    ds_read_b64_tr_b16 v[52:53], v8 offset:49152
    ds_read_b64_tr_b16 v[54:55], v8 offset:50176
    s_waitcnt vmcnt(6)
    s_waitcnt lgkmcnt(6)
    v_mfma_f32_32x32x16_bf16 v[112:127], v[40:43], v[180:183], v[112:127]
    ds_read_b64_tr_b16 v[56:57], v5 offset:51200
    ds_read_b64_tr_b16 v[58:59], v5 offset:52224
    s_waitcnt lgkmcnt(6)
    v_mfma_f32_32x32x16_bf16 v[128:143], v[44:47], v[180:183], v[128:143]
    ds_read_b64_tr_b16 v[60:61], v8 offset:51200
    ds_read_b64_tr_b16 v[62:63], v8 offset:52224
    s_and_b32 s79, s45, 1
    s_mul_i32 s79, s79, 2048
    s_mul_i32 s80, s56, 8192
    s_add_u32 s79, s79, s80
    s_mul_i32 s80, s57, 4992
    s_add_u32 s79, s79, s80
    s_add_u32 s79, s79, 18350080
    s_mov_b32 s58, 127
    v_lshl_add_u32 v35, v0, 3, s79
    v_mov_b32 v36, 2147418112
    v_cndmask_b32 v35, v36, v35, s[58:59]
    buffer_load_dword v36, v35, s[28:31], 0 offen sc1
    s_waitcnt vmcnt(6)
    s_waitcnt lgkmcnt(6)
    v_mfma_f32_32x32x16_bf16 v[112:127], v[48:51], v[184:187], v[112:127]
    ds_read_b64_tr_b16 v[40:41], v5 offset:57344
    ds_read_b64_tr_b16 v[42:43], v5 offset:58368
    s_waitcnt lgkmcnt(6)
    v_mfma_f32_32x32x16_bf16 v[128:143], v[52:55], v[184:187], v[128:143]
    ds_read_b64_tr_b16 v[44:45], v8 offset:57344
    ds_read_b64_tr_b16 v[46:47], v8 offset:58368
    s_waitcnt vmcnt(5)
    s_waitcnt lgkmcnt(6)
    v_mfma_f32_32x32x16_bf16 v[112:127], v[56:59], v[188:191], v[112:127]
    ds_read_b64_tr_b16 v[48:49], v5 offset:59392
    ds_read_b64_tr_b16 v[50:51], v5 offset:60416
    s_waitcnt lgkmcnt(6)
    v_mfma_f32_32x32x16_bf16 v[128:143], v[60:63], v[188:191], v[128:143]
    ds_read_b64_tr_b16 v[52:53], v8 offset:59392
    ds_read_b64_tr_b16 v[54:55], v8 offset:60416
    s_waitcnt vmcnt(4)
    s_waitcnt lgkmcnt(6)
    v_mfma_f32_32x32x16_bf16 v[112:127], v[40:43], v[192:195], v[112:127]
    ds_read_b64_tr_b16 v[56:57], v6 offset:0
    ds_read_b64_tr_b16 v[58:59], v6 offset:1024
    s_waitcnt lgkmcnt(6)
    v_mfma_f32_32x32x16_bf16 v[128:143], v[44:47], v[192:195], v[128:143]
    ds_read_b64_tr_b16 v[60:61], v9 offset:0
    ds_read_b64_tr_b16 v[62:63], v9 offset:1024
    s_waitcnt vmcnt(0)
    s_mov_b32 s83, 0
L_FB_spin5:
    v_cmp_ne_u32 vcc, v34, v36
    s_nop 0
    s_and_b64 vcc, vcc, s[58:59]
    s_cbranch_vccz L_FB_ok6
    buffer_load_dword v36, v35, s[28:31], 0 offen sc1
    s_add_u32 s83, s83, 1
    s_cmp_lt_u32 s83, 1000000
    s_waitcnt vmcnt(0)
    s_cbranch_scc1 L_FB_spin5
L_FB_ok6:
    buffer_load_dwordx4 v[200:203], v4, s[28:31], s96 offen offset:0 sc1
    buffer_load_dwordx4 v[204:207], v4, s[28:31], s96 offen offset:1024 sc1
    s_add_u32 s96, s96, s97
    buffer_load_dwordx4 v[208:211], v4, s[28:31], s96 offen offset:0 sc1
    buffer_load_dwordx4 v[212:215], v4, s[28:31], s96 offen offset:1024 sc1
    s_add_u32 s96, s96, s97
    buffer_load_dwordx4 v[216:219], v4, s[28:31], s96 offen offset:0 sc1
    buffer_load_dwordx4 v[220:223], v4, s[28:31], s96 offen offset:1024 sc1
    s_add_u32 s96, s96, s97
    s_waitcnt lgkmcnt(6)
    v_mfma_f32_32x32x16_bf16 v[112:127], v[48:51], v[196:199], v[112:127]
    ds_read_b64_tr_b16 v[40:41], v6 offset:2048
    ds_read_b64_tr_b16 v[42:43], v6 offset:3072
    buffer_load_dwordx4 v[224:227], v4, s[28:31], s96 offen offset:0 sc1
    s_waitcnt lgkmcnt(6)
    v_mfma_f32_32x32x16_bf16 v[128:143], v[52:55], v[196:199], v[128:143]
    ds_read_b64_tr_b16 v[44:45], v9 offset:2048
    ds_read_b64_tr_b16 v[46:47], v9 offset:3072
    buffer_load_dwordx4 v[228:231], v4, s[28:31], s96 offen offset:1024 sc1
    s_add_u32 s96, s96, s97
    s_waitcnt vmcnt(7)
    s_waitcnt lgkmcnt(6)
    v_mfma_f32_32x32x16_bf16 v[112:127], v[56:59], v[200:203], v[112:127]
    ds_read_b64_tr_b16 v[48:49], v5 offset:0
    ds_read_b64_tr_b16 v[50:51], v5 offset:1024
    buffer_load_dwordx4 v[232:235], v4, s[28:31], s96 offen offset:0 sc1
    s_waitcnt lgkmcnt(6)
    v_mfma_f32_32x32x16_bf16 v[128:143], v[60:63], v[200:203], v[128:143]
    ds_read_b64_tr_b16 v[52:53], v8 offset:0
    ds_read_b64_tr_b16 v[54:55], v8 offset:1024
    buffer_load_dwordx4 v[236:239], v4, s[28:31], s96 offen offset:1024 sc1
    s_add_u32 s96, s96, s97
    s_waitcnt vmcnt(8)
    s_waitcnt lgkmcnt(6)
    v_mfma_f32_32x32x16_bf16 v[112:127], v[40:43], v[204:207], v[112:127]
    ds_read_b64_tr_b16 v[56:57], v5 offset:2048
    ds_read_b64_tr_b16 v[58:59], v5 offset:3072
    buffer_load_dwordx4 v[240:243], v4, s[28:31], s96 offen offset:0 sc1
    s_waitcnt lgkmcnt(6)
    v_mfma_f32_32x32x16_bf16 v[128:143], v[44:47], v[204:207], v[128:143]
    ds_read_b64_tr_b16 v[60:61], v8 offset:2048
    ds_read_b64_tr_b16 v[62:63], v8 offset:3072
    buffer_load_dwordx4 v[244:247], v4, s[28:31], s96 offen offset:1024 sc1
    s_add_u32 s96, s96, s97
    s_waitcnt vmcnt(9)
    s_waitcnt lgkmcnt(6)
    v_mfma_f32_32x32x16_bf16 v[112:127], v[48:51], v[208:211], v[112:127]
    buffer_load_dwordx4 v[248:251], v4, s[28:31], s96 offen offset:0 sc1
    buffer_load_dwordx4 v[252:255], v4, s[28:31], s96 offen offset:1024 sc1
    s_mov_b32 s96, 0
    s_barrier
    ds_read_b64_tr_b16 v[40:41], v5 offset:8192
    ds_read_b64_tr_b16 v[42:43], v5 offset:9216
    s_waitcnt lgkmcnt(6)
    v_mfma_f32_32x32x16_bf16 v[128:143], v[52:55], v[208:211], v[128:143]
    ds_read_b64_tr_b16 v[44:45], v8 offset:8192
    ds_read_b64_tr_b16 v[46:47], v8 offset:9216
    s_waitcnt vmcnt(10)
    s_waitcnt lgkmcnt(6)
    v_mfma_f32_32x32x16_bf16 v[112:127], v[56:59], v[212:215], v[112:127]
    ds_read_b64_tr_b16 v[48:49], v5 offset:10240
    ds_read_b64_tr_b16 v[50:51], v5 offset:11264
    s_waitcnt lgkmcnt(6)
    v_mfma_f32_32x32x16_bf16 v[128:143], v[60:63], v[212:215], v[128:143]
    ds_read_b64_tr_b16 v[52:53], v8 offset:10240
    ds_read_b64_tr_b16 v[54:55], v8 offset:11264
    s_waitcnt vmcnt(9)
    s_waitcnt lgkmcnt(6)
    v_mfma_f32_32x32x16_bf16 v[112:127], v[40:43], v[216:219], v[112:127]
    ds_read_b64_tr_b16 v[56:57], v6 offset:32768
    ds_read_b64_tr_b16 v[58:59], v6 offset:33792
    s_waitcnt lgkmcnt(6)
    v_mfma_f32_32x32x16_bf16 v[128:143], v[44:47], v[216:219], v[128:143]
    ds_read_b64_tr_b16 v[60:61], v9 offset:32768
    ds_read_b64_tr_b16 v[62:63], v9 offset:33792
    s_waitcnt vmcnt(8)
    s_waitcnt lgkmcnt(6)
    v_mfma_f32_32x32x16_bf16 v[112:127], v[48:51], v[220:223], v[112:127]
    ds_read_b64_tr_b16 v[40:41], v6 offset:34816
    ds_read_b64_tr_b16 v[42:43], v6 offset:35840
    s_waitcnt lgkmcnt(6)
    v_mfma_f32_32x32x16_bf16 v[128:143], v[52:55], v[220:223], v[128:143]
    ds_read_b64_tr_b16 v[44:45], v9 offset:34816
    ds_read_b64_tr_b16 v[46:47], v9 offset:35840
    s_mov_b32 s58, 15
    v_lshl_add_u32 v35, v0, 3, s48
    v_mov_b32 v36, 2147418112
    v_cndmask_b32 v35, v36, v35, s[58:59]
    buffer_load_dword v36, v35, s[28:31], 0 offen sc1
    s_waitcnt vmcnt(8)
    s_waitcnt lgkmcnt(6)
    v_mfma_f32_32x32x16_bf16 v[112:127], v[56:59], v[224:227], v[112:127]
    s_barrier
    ds_read_b64_tr_b16 v[48:49], v6 offset:40960
    ds_read_b64_tr_b16 v[50:51], v6 offset:41984
    s_waitcnt lgkmcnt(6)
    v_mfma_f32_32x32x16_bf16 v[128:143], v[60:63], v[224:227], v[128:143]
    ds_read_b64_tr_b16 v[52:53], v9 offset:40960
    ds_read_b64_tr_b16 v[54:55], v9 offset:41984
    s_waitcnt vmcnt(7)
    s_waitcnt lgkmcnt(6)
    v_mfma_f32_32x32x16_bf16 v[112:127], v[40:43], v[228:231], v[112:127]
    ds_read_b64_tr_b16 v[56:57], v6 offset:43008
    ds_read_b64_tr_b16 v[58:59], v6 offset:44032
    s_waitcnt lgkmcnt(6)
    v_mfma_f32_32x32x16_bf16 v[128:143], v[44:47], v[228:231], v[128:143]
    ds_read_b64_tr_b16 v[60:61], v9 offset:43008
    ds_read_b64_tr_b16 v[62:63], v9 offset:44032
    s_waitcnt vmcnt(6)
    s_waitcnt lgkmcnt(6)
    v_mfma_f32_32x32x16_bf16 v[112:127], v[48:51], v[232:235], v[112:127]
    ds_read_b64_tr_b16 v[40:41], v6 offset:49152
    ds_read_b64_tr_b16 v[42:43], v6 offset:50176
    s_waitcnt lgkmcnt(6)
    v_mfma_f32_32x32x16_bf16 v[128:143], v[52:55], v[232:235], v[128:143]
    ds_read_b64_tr_b16 v[44:45], v9 offset:49152
    ds_read_b64_tr_b16 v[46:47], v9 offset:50176
    s_waitcnt vmcnt(0)
    s_mov_b32 s83, 0
L_FB_spin7:
    v_cmp_ne_u32 vcc, v34, v36
    s_nop 0
    s_and_b64 vcc, vcc, s[58:59]
    s_cbranch_vccz L_FB_ok8
    buffer_load_dword v36, v35, s[28:31], 0 offen sc1
    s_add_u32 s83, s83, 1
    s_cmp_lt_u32 s83, 1000000
    s_waitcnt vmcnt(0)
    s_cbranch_scc1 L_FB_spin7
L_FB_ok8:
    s_waitcnt lgkmcnt(6)
    v_mfma_f32_32x32x16_bf16 v[112:127], v[56:59], v[236:239], v[112:127]
    ds_read_b64_tr_b16 v[48:49], v6 offset:51200
    ds_read_b64_tr_b16 v[50:51], v6 offset:52224
    v_add_u32 v4, s50, v0
    buffer_load_dwordx4 v[144:147], v4, s[28:31], s96 offen offset:0 sc1
    s_waitcnt lgkmcnt(6)
    v_mfma_f32_32x32x16_bf16 v[128:143], v[60:63], v[236:239], v[128:143]
    ds_read_b64_tr_b16 v[52:53], v9 offset:51200
    ds_read_b64_tr_b16 v[54:55], v9 offset:52224
    buffer_load_dwordx4 v[148:151], v4, s[28:31], s96 offen offset:1024 sc1
    s_mov_b32 s96, 50176
    s_waitcnt lgkmcnt(6)
    v_mfma_f32_32x32x16_bf16 v[112:127], v[40:43], v[240:243], v[112:127]
    ds_read_b64_tr_b16 v[56:57], v6 offset:57344
    ds_read_b64_tr_b16 v[58:59], v6 offset:58368
    buffer_load_dwordx4 v[152:155], v4, s[28:31], s96 offen offset:0 sc1
    s_waitcnt lgkmcnt(6)
    v_mfma_f32_32x32x16_bf16 v[128:143], v[44:47], v[240:243], v[128:143]
    ds_read_b64_tr_b16 v[60:61], v9 offset:57344
    ds_read_b64_tr_b16 v[62:63], v9 offset:58368
    buffer_load_dwordx4 v[156:159], v4, s[28:31], s96 offen offset:1024 sc1
    s_mov_b32 s96, 100352
    s_waitcnt lgkmcnt(6)
    v_mfma_f32_32x32x16_bf16 v[112:127], v[48:51], v[244:247], v[112:127]
    ds_read_b64_tr_b16 v[40:41], v6 offset:59392
    ds_read_b64_tr_b16 v[42:43], v6 offset:60416
    buffer_load_dwordx4 v[160:163], v4, s[28:31], s96 offen offset:0 sc1
    s_waitcnt lgkmcnt(6)
    v_mfma_f32_32x32x16_bf16 v[128:143], v[52:55], v[244:247], v[128:143]
    ds_read_b64_tr_b16 v[44:45], v9 offset:59392
    ds_read_b64_tr_b16 v[46:47], v9 offset:60416
    buffer_load_dwordx4 v[164:167], v4, s[28:31], s96 offen offset:1024 sc1
    s_mov_b32 s96, 150528
    s_waitcnt lgkmcnt(6)
    v_mfma_f32_32x32x16_bf16 v[112:127], v[56:59], v[248:251], v[112:127]
    ds_read_b64_tr_b16 v[48:49], v7 offset:0
    ds_read_b64_tr_b16 v[50:51], v7 offset:1024
    buffer_load_dwordx4 v[168:171], v4, s[28:31], s96 offen offset:0 sc1
    s_waitcnt lgkmcnt(6)
    v_mfma_f32_32x32x16_bf16 v[128:143], v[60:63], v[248:251], v[128:143]
    ds_read_b64_tr_b16 v[52:53], v10 offset:0
    ds_read_b64_tr_b16 v[54:55], v10 offset:1024
    buffer_load_dwordx4 v[172:175], v4, s[28:31], s96 offen offset:1024 sc1
    s_mov_b32 s96, 200704
    s_waitcnt lgkmcnt(6)
    v_mfma_f32_32x32x16_bf16 v[112:127], v[40:43], v[252:255], v[112:127]
    ds_read_b64_tr_b16 v[56:57], v7 offset:2048
    ds_read_b64_tr_b16 v[58:59], v7 offset:3072
    buffer_load_dwordx4 v[176:179], v4, s[28:31], s96 offen offset:0 sc1
    s_waitcnt lgkmcnt(6)
    v_mfma_f32_32x32x16_bf16 v[128:143], v[44:47], v[252:255], v[128:143]
    ds_read_b64_tr_b16 v[60:61], v10 offset:2048
    ds_read_b64_tr_b16 v[62:63], v10 offset:3072
    buffer_load_dwordx4 v[180:183], v4, s[28:31], s96 offen offset:1024 sc1
    s_mov_b32 s96, 250880
    s_waitcnt vmcnt(9)
    s_waitcnt lgkmcnt(6)
    v_mfma_f32_32x32x16_bf16 v[112:127], v[48:51], v[144:147], v[112:127]
    ds_read_b64_tr_b16 v[40:41], v7 offset:8192
    ds_read_b64_tr_b16 v[42:43], v7 offset:9216
    buffer_load_dwordx4 v[184:187], v4, s[28:31], s96 offen offset:0 sc1
    s_waitcnt lgkmcnt(6)
    v_mfma_f32_32x32x16_bf16 v[128:143], v[52:55], v[144:147], v[128:143]
    ds_read_b64_tr_b16 v[44:45], v10 offset:8192
    ds_read_b64_tr_b16 v[46:47], v10 offset:9216
    buffer_load_dwordx4 v[188:191], v4, s[28:31], s96 offen offset:1024 sc1
    s_mov_b32 s96, 301056
    s_waitcnt vmcnt(10)
    s_waitcnt lgkmcnt(6)
    v_mfma_f32_32x32x16_bf16 v[112:127], v[56:59], v[148:151], v[112:127]
    ds_read_b64_tr_b16 v[48:49], v7 offset:10240
    ds_read_b64_tr_b16 v[50:51], v7 offset:11264
    buffer_load_dwordx4 v[192:195], v4, s[28:31], s96 offen offset:0 sc1
    s_waitcnt lgkmcnt(6)
    v_mfma_f32_32x32x16_bf16 v[128:143], v[60:63], v[148:151], v[128:143]
    ds_read_b64_tr_b16 v[52:53], v10 offset:10240
    ds_read_b64_tr_b16 v[54:55], v10 offset:11264
    buffer_load_dwordx4 v[196:199], v4, s[28:31], s96 offen offset:1024 sc1
    s_mov_b32 s96, 351232
    s_waitcnt vmcnt(11)
    s_waitcnt lgkmcnt(6)
    v_mfma_f32_32x32x16_bf16 v[112:127], v[40:43], v[152:155], v[112:127]
    ds_read_b64_tr_b16 v[56:57], v7 offset:16384
    ds_read_b64_tr_b16 v[58:59], v7 offset:17408
    buffer_load_dwordx4 v[200:203], v4, s[28:31], s96 offen offset:0 sc1
    s_lshl_b32 s80, s45, 3
    s_lshr_b32 s80, 134676736, s80
    s_and_b32 s80, s80, 0xff
    s_lshl_b32 s80, s80, 13
    v_bfe_u32 v16, v0, 4, 5
    v_lshl_add_u32 v12, v16, 8, s80
    v_lshrrev_b32 v17, 9, v0
    s_waitcnt lgkmcnt(6)
    v_mfma_f32_32x32x16_bf16 v[128:143], v[44:47], v[152:155], v[128:143]
    ds_read_b64_tr_b16 v[60:61], v10 offset:16384
    ds_read_b64_tr_b16 v[62:63], v10 offset:17408
    buffer_load_dwordx4 v[204:207], v4, s[28:31], s96 offen offset:1024 sc1
    v_xor_b32 v17, v17, v16
    v_and_b32 v17, 7, v17
    s_waitcnt vmcnt(12)
    s_waitcnt lgkmcnt(6)
    v_mfma_f32_32x32x16_bf16 v[112:127], v[48:51], v[156:159], v[112:127]
    ds_read_b64_tr_b16 v[40:41], v7 offset:18432
    ds_read_b64_tr_b16 v[42:43], v7 offset:19456
    v_lshl_or_b32 v12, v17, 4, v12
    v_xor_b32 v13, 32, v12
    s_waitcnt lgkmcnt(6)
    v_mfma_f32_32x32x16_bf16 v[128:143], v[52:55], v[156:159], v[128:143]
    ds_read_b64_tr_b16 v[44:45], v10 offset:18432
    ds_read_b64_tr_b16 v[46:47], v10 offset:19456
    v_xor_b32 v14, 64, v12
    v_xor_b32 v15, 96, v12
    s_waitcnt vmcnt(11)
    s_waitcnt lgkmcnt(6)
    v_mfma_f32_32x32x16_bf16 v[112:127], v[56:59], v[160:163], v[112:127]
    ds_read_b64_tr_b16 v[48:49], v7 offset:24576
    ds_read_b64_tr_b16 v[50:51], v7 offset:25600
    s_waitcnt lgkmcnt(6)
    v_mfma_f32_32x32x16_bf16 v[128:143], v[60:63], v[160:163], v[128:143]
    ds_read_b64_tr_b16 v[52:53], v10 offset:24576
    ds_read_b64_tr_b16 v[54:55], v10 offset:25600
    s_waitcnt vmcnt(10)
    s_waitcnt lgkmcnt(6)
    v_mfma_f32_32x32x16_bf16 v[112:127], v[40:43], v[164:167], v[112:127]
    ds_read_b64_tr_b16 v[56:57], v7 offset:26624
    ds_read_b64_tr_b16 v[58:59], v7 offset:27648
    s_waitcnt lgkmcnt(6)
    v_mfma_f32_32x32x16_bf16 v[128:143], v[44:47], v[164:167], v[128:143]
    ds_read_b64_tr_b16 v[60:61], v10 offset:26624
    ds_read_b64_tr_b16 v[62:63], v10 offset:27648
    s_waitcnt vmcnt(9)
    s_waitcnt lgkmcnt(6)
    v_mfma_f32_32x32x16_bf16 v[112:127], v[48:51], v[168:171], v[112:127]
    ds_read_b64_tr_b16 v[40:41], v5 offset:16384
    ds_read_b64_tr_b16 v[42:43], v5 offset:17408
    s_waitcnt lgkmcnt(6)
    v_mfma_f32_32x32x16_bf16 v[128:143], v[52:55], v[168:171], v[128:143]
    ds_read_b64_tr_b16 v[44:45], v8 offset:16384
    ds_read_b64_tr_b16 v[46:47], v8 offset:17408
    s_waitcnt vmcnt(8)
    s_waitcnt lgkmcnt(6)
    v_mfma_f32_32x32x16_bf16 v[112:127], v[56:59], v[172:175], v[112:127]
    ds_read_b64_tr_b16 v[48:49], v5 offset:18432
    ds_read_b64_tr_b16 v[50:51], v5 offset:19456
    s_waitcnt lgkmcnt(6)
    v_mfma_f32_32x32x16_bf16 v[128:143], v[60:63], v[172:175], v[128:143]
    ds_read_b64_tr_b16 v[52:53], v8 offset:18432
    ds_read_b64_tr_b16 v[54:55], v8 offset:19456
    s_waitcnt vmcnt(7)
    s_waitcnt lgkmcnt(6)
    v_mfma_f32_32x32x16_bf16 v[112:127], v[40:43], v[176:179], v[112:127]
    ds_read_b64_tr_b16 v[56:57], v6 offset:8192
    ds_read_b64_tr_b16 v[58:59], v6 offset:9216
    s_waitcnt lgkmcnt(6)
    v_mfma_f32_32x32x16_bf16 v[128:143], v[44:47], v[176:179], v[128:143]
    ds_read_b64_tr_b16 v[60:61], v9 offset:8192
    ds_read_b64_tr_b16 v[62:63], v9 offset:9216
    s_waitcnt vmcnt(6)
    s_waitcnt lgkmcnt(6)
    v_mfma_f32_32x32x16_bf16 v[112:127], v[48:51], v[180:183], v[112:127]
    ds_read_b64_tr_b16 v[40:41], v6 offset:10240
    ds_read_b64_tr_b16 v[42:43], v6 offset:11264
    s_waitcnt lgkmcnt(6)
    v_mfma_f32_32x32x16_bf16 v[128:143], v[52:55], v[180:183], v[128:143]
    ds_read_b64_tr_b16 v[44:45], v9 offset:10240
    ds_read_b64_tr_b16 v[46:47], v9 offset:11264
    s_waitcnt vmcnt(5)
    s_waitcnt lgkmcnt(6)
    v_mfma_f32_32x32x16_bf16 v[112:127], v[56:59], v[184:187], v[112:127]
    ds_read_b64_tr_b16 v[48:49], v6 offset:16384
    ds_read_b64_tr_b16 v[50:51], v6 offset:17408
    s_waitcnt lgkmcnt(6)
    v_mfma_f32_32x32x16_bf16 v[128:143], v[60:63], v[184:187], v[128:143]
    ds_read_b64_tr_b16 v[52:53], v9 offset:16384
    ds_read_b64_tr_b16 v[54:55], v9 offset:17408
    s_waitcnt vmcnt(4)
    s_waitcnt lgkmcnt(6)
    v_mfma_f32_32x32x16_bf16 v[112:127], v[40:43], v[188:191], v[112:127]
    ds_read_b64_tr_b16 v[56:57], v6 offset:18432
    ds_read_b64_tr_b16 v[58:59], v6 offset:19456
    s_waitcnt lgkmcnt(6)
    v_mfma_f32_32x32x16_bf16 v[128:143], v[44:47], v[188:191], v[128:143]
    ds_read_b64_tr_b16 v[60:61], v9 offset:18432
    ds_read_b64_tr_b16 v[62:63], v9 offset:19456
    s_waitcnt vmcnt(3)
    s_waitcnt lgkmcnt(6)
    v_mfma_f32_32x32x16_bf16 v[112:127], v[48:51], v[192:195], v[112:127]
    ds_read_b64_tr_b16 v[40:41], v6 offset:24576
    ds_read_b64_tr_b16 v[42:43], v6 offset:25600
    s_waitcnt lgkmcnt(6)
    v_mfma_f32_32x32x16_bf16 v[128:143], v[52:55], v[192:195], v[128:143]
    ds_read_b64_tr_b16 v[44:45], v9 offset:24576
    ds_read_b64_tr_b16 v[46:47], v9 offset:25600
    s_waitcnt vmcnt(2)
    s_waitcnt lgkmcnt(6)
    v_mfma_f32_32x32x16_bf16 v[112:127], v[56:59], v[196:199], v[112:127]
    ds_read_b64_tr_b16 v[48:49], v6 offset:26624
    ds_read_b64_tr_b16 v[50:51], v6 offset:27648
    s_waitcnt lgkmcnt(6)
    v_mfma_f32_32x32x16_bf16 v[128:143], v[60:63], v[196:199], v[128:143]
    ds_read_b64_tr_b16 v[52:53], v9 offset:26624
    ds_read_b64_tr_b16 v[54:55], v9 offset:27648
    s_waitcnt vmcnt(1)
    s_waitcnt lgkmcnt(6)
    v_mfma_f32_32x32x16_bf16 v[112:127], v[40:43], v[200:203], v[112:127]
    s_waitcnt lgkmcnt(4)
    v_mfma_f32_32x32x16_bf16 v[128:143], v[44:47], v[200:203], v[128:143]
    s_waitcnt vmcnt(0)
    s_waitcnt lgkmcnt(2)
    v_mfma_f32_32x32x16_bf16 v[112:127], v[48:51], v[204:207], v[112:127]
    s_waitcnt lgkmcnt(0)
    v_mfma_f32_32x32x16_bf16 v[128:143], v[52:55], v[204:207], v[128:143]
    s_nop 9
    ds_write_b128 v12, v[112:115] offset:0
    ds_write_b128 v13, v[116:119] offset:0
    ds_write_b128 v14, v[120:123] offset:0
    ds_write_b128 v15, v[124:127] offset:0
    ds_write_b128 v12, v[128:131] offset:128
    ds_write_b128 v13, v[132:135] offset:128
    ds_write_b128 v14, v[136:139] offset:128
    ds_write_b128 v15, v[140:143] offset:128
    s_waitcnt lgkmcnt(0)
    s_barrier
    s_endpgm
L_QA:
    s_waitcnt vmcnt(2)
    s_barrier
    s_add_u32 m0, s74, 32768
    ds_read_b128 v[144:147], v112 offset:0
    ds_read_b64_tr_b16 v[40:41], v10 offset:16384
    ds_read_b64_tr_b16 v[42:43], v10 offset:16640
    s_mov_b64 exec, s[86:87]
    ds_read_b128 v[40:43], v124 offset:0
    s_mov_b64 exec, -1
    buffer_load_dwordx4 v3, s[4:7], s90 offen lds
    s_add_u32 m0, s74, 33792
    ds_read_b128 v[148:151], v115 offset:0
    ds_read_b64_tr_b16 v[44:45], v10 offset:17408
    ds_read_b64_tr_b16 v[46:47], v10 offset:17664
    s_mov_b64 exec, s[86:87]
    ds_read_b128 v[44:47], v124 offset:32
    s_mov_b64 exec, -1
    buffer_load_dwordx4 v4, s[4:7], s90 offen lds
    s_waitcnt lgkmcnt(4)
    v_mfma_f32_32x32x16_bf16 v[64:79], v[40:43], v[144:147], 0
    ds_read_b128 v[152:155], v118 offset:0
    ds_read_b64_tr_b16 v[48:49], v10 offset:18432
    ds_read_b64_tr_b16 v[50:51], v10 offset:18688
    s_mov_b64 exec, s[86:87]
    ds_read_b128 v[48:51], v124 offset:64
    s_mov_b64 exec, -1
    s_add_u32 s79, s91, 128
    s_cmp_eq_u32 s79, 896
    s_cselect_b32 s92, 0, s79
    s_mul_i32 s99, s92, 1344
    s_add_u32 s79, s92, 128
    s_cmp_eq_u32 s79, 896
    s_cselect_b32 s93, 0, s79
    s_waitcnt lgkmcnt(4)
    v_mfma_f32_32x32x16_bf16 v[64:79], v[44:47], v[148:151], v[64:79]
    ds_read_b128 v[156:159], v121 offset:0
    ds_read_b64_tr_b16 v[52:53], v10 offset:19456
    ds_read_b64_tr_b16 v[54:55], v10 offset:19712
    s_mov_b64 exec, s[86:87]
    ds_read_b128 v[52:55], v124 offset:96
    s_mov_b64 exec, -1
    s_mul_i32 s100, s93, 1344
    s_add_u32 s79, s93, 128
    s_cmp_eq_u32 s79, 896
    s_cselect_b32 s94, 0, s79
    s_mul_i32 s101, s94, 1344
    s_waitcnt lgkmcnt(4)
    v_mfma_f32_32x32x16_bf16 v[64:79], v[48:51], v[152:155], v[64:79]
    s_waitcnt vmcnt(2)
    s_barrier
    s_add_u32 m0, s74, 49152
    ds_read_b128 v[160:163], v112 offset:16384
    ds_read_b64_tr_b16 v[56:57], v10 offset:8192
    ds_read_b64_tr_b16 v[58:59], v10 offset:8448
    s_mov_b64 exec, s[86:87]
    ds_read_b128 v[56:59], v124 offset:128
    s_mov_b64 exec, -1
    buffer_load_dwordx4 v3, s[4:7], s91 offen lds
    s_mov_b32 s64, s40
    s_mov_b32 s65, s41
    s_mov_b32 s66, 25088
    s_mov_b32 s67, 0x20000
    s_mov_b32 s32, s56
    s_waitcnt lgkmcnt(4)
    v_mfma_f32_32x32x16_bf16 v[64:79], v[52:55], v[156:159], v[64:79]
    s_add_u32 m0, s74, 50176
    ds_read_b128 v[164:167], v115 offset:16384
    ds_read_b64_tr_b16 v[60:61], v10 offset:9216
    ds_read_b64_tr_b16 v[62:63], v10 offset:9472
    s_mov_b64 exec, s[86:87]
    ds_read_b128 v[60:63], v124 offset:160
    s_mov_b64 exec, -1
    buffer_load_dwordx4 v4, s[4:7], s91 offen lds
    s_mov_b32 s33, s57
    s_mov_b32 s34, 256
    s_mov_b32 s35, 0x20000
    s_or_b32 s79, s83, s72
    s_cselect_b32 s80, 2147418112, 0
    v_lshl_or_b32 v12, v0, 8, s80
    s_waitcnt lgkmcnt(4)
    v_mfma_f32_32x32x16_bf16 v[64:79], v[56:59], v[160:163], v[64:79]
    ds_read_b128 v[168:171], v118 offset:16384
    ds_read_b64_tr_b16 v[40:41], v10 offset:10240
    ds_read_b64_tr_b16 v[42:43], v10 offset:10496
    s_mov_b64 exec, s[86:87]
    ds_read_b128 v[40:43], v124 offset:192
    s_mov_b64 exec, -1
    s_or_b32 s79, s60, 1
    v_mov_b32 v13, s79
    buffer_store_dword v13, v12, s[32:35], 0 offen sc1
    s_mov_b32 s28, s58
    s_mov_b32 s29, s59
    s_waitcnt lgkmcnt(4)
    v_mfma_f32_32x32x16_bf16 v[64:79], v[60:63], v[164:167], v[64:79]
    ds_read_b128 v[172:175], v121 offset:16384
    ds_read_b64_tr_b16 v[44:45], v10 offset:11264
    ds_read_b64_tr_b16 v[46:47], v10 offset:11520
    s_mov_b64 exec, s[86:87]
    ds_read_b128 v[44:47], v124 offset:224
    s_mov_b64 exec, -1
    s_mov_b32 s30, 26345472
    s_mov_b32 s31, 0x20000
    s_mov_b32 s82, 0x3fb8aa3b
    s_mov_b32 s84, 0
    s_mov_b32 s85, -1
    s_waitcnt lgkmcnt(4)
    v_mfma_f32_32x32x16_bf16 v[64:79], v[40:43], v[168:171], v[64:79]
    s_waitcnt vmcnt(3)
    s_barrier
    s_add_u32 m0, s74, 0
    ds_read_b128 v[176:179], v112 offset:32768
    ds_read_b64_tr_b16 v[48:49], v10 offset:0
    ds_read_b64_tr_b16 v[50:51], v10 offset:256
    s_mov_b64 exec, s[86:87]
    ds_read_b128 v[48:51], v124 offset:256
    s_mov_b64 exec, -1
    buffer_load_dwordx4 v3, s[4:7], s92 offen lds
    v_lshrrev_b32 v12, 8, v0
    v_lshl_add_u32 v13, s72, 2, v12
    v_mul_u32_u24 v1, 2688, v13
    v_lshlrev_b32 v12, 6, v12
    v_sub_u32 v12, v0, v12
    s_waitcnt lgkmcnt(4)
    v_mfma_f32_32x32x16_bf16 v[64:79], v[44:47], v[172:175], v[64:79]
    s_add_u32 m0, s74, 1024
    ds_read_b128 v[180:183], v115 offset:32768
    ds_read_b64_tr_b16 v[52:53], v10 offset:1024
    ds_read_b64_tr_b16 v[54:55], v10 offset:1280
    s_mov_b64 exec, s[86:87]
    ds_read_b128 v[52:55], v124 offset:288
    s_mov_b64 exec, -1
    buffer_load_dwordx4 v4, s[4:7], s92 offen lds
    v_and_b32 v12, 0xf0, v12
    s_mul_i32 s79, s76, 448
    v_add3_u32 v1, v1, v12, s79
    s_mov_b32 s79, 86016
    s_add_u32 s8, s16, s79
    s_addc_u32 s9, s17, 0
    s_sub_u32 s10, 1204224, s79
    s_waitcnt lgkmcnt(4)
    v_mfma_f32_32x32x16_bf16 v[64:79], v[48:51], v[176:179], v[64:79]
    ds_read_b128 v[184:187], v118 offset:32768
    ds_read_b64_tr_b16 v[56:57], v10 offset:2048
    ds_read_b64_tr_b16 v[58:59], v10 offset:2304
    s_mov_b64 exec, s[86:87]
    ds_read_b128 v[56:59], v124 offset:320
    s_mov_b64 exec, -1
    s_mov_b32 s11, 0x20000
    v_min_u32 v12, 6, v20
    v_lshlrev_b32 v12, 3, v12
    v_lshl_add_u32 v12, v19, 6, v12
    v_add_u32 v12, 32, v12
    s_waitcnt lgkmcnt(4)
    v_mfma_f32_32x32x16_bf16 v[64:79], v[52:55], v[180:183], v[64:79]
    ds_read_b128 v[188:191], v121 offset:32768
    ds_read_b64_tr_b16 v[60:61], v10 offset:3072
    ds_read_b64_tr_b16 v[62:63], v10 offset:3328
    s_mov_b64 exec, s[86:87]
    ds_read_b128 v[60:63], v124 offset:352
    s_mov_b64 exec, -1
    v_and_b32 v12, 0xff, v12
    v_lshl_or_b32 v5, v21, 8, v12
    v_add_u32 v6, 0x10000, v5
    v_add_u32 v7, 0x20000, v5
    s_lshl2_add_u32 s79, s78, s45
    s_lshl4_add_u32 s79, s79, s75
    s_mul_i32 s53, s79, 128
    s_waitcnt lgkmcnt(4)
    v_mfma_f32_32x32x16_bf16 v[64:79], v[56:59], v[184:187], v[64:79]
    s_waitcnt vmcnt(3)
    s_barrier
    s_add_u32 m0, s74, 16384
    ds_read_b128 v[192:195], v112 offset:49152
    ds_read_b64_tr_b16 v[40:41], v9 offset:57344
    ds_read_b64_tr_b16 v[42:43], v9 offset:57600
    s_mov_b64 exec, s[86:87]
    ds_read_b128 v[40:43], v124 offset:384
    s_mov_b64 exec, -1
    buffer_load_dwordx4 v3, s[4:7], s93 offen lds
    s_add_u32 s53, s53, 18677760
    s_lshl4_add_u32 s79, s78, s75
    s_and_b32 s80, s72, 1
    s_lshl1_add_u32 s79, s79, s80
    s_mul_i32 s52, s79, 2048
    s_waitcnt lgkmcnt(4)
    v_mfma_f32_32x32x16_bf16 v[64:79], v[60:63], v[188:191], v[64:79]
    s_add_u32 m0, s74, 17408
    ds_read_b128 v[196:199], v115 offset:49152
    ds_read_b64_tr_b16 v[44:45], v9 offset:58368
    ds_read_b64_tr_b16 v[46:47], v9 offset:58624
    s_mov_b64 exec, s[86:87]
    ds_read_b128 v[44:47], v124 offset:416
    s_mov_b64 exec, -1
    buffer_load_dwordx4 v4, s[4:7], s93 offen lds
    s_add_u32 s52, s52, 19922944
    v_lshrrev_b32 v37, 2, v0
    v_mov_b32 v38, 2147418112
    v_cndmask_b32 v33, v37, v38, s[84:85]
    v_bfe_u32 v37, v0, 6, 2
    s_waitcnt lgkmcnt(4)
    v_mfma_f32_32x32x16_bf16 v[64:79], v[40:43], v[192:195], v[64:79]
    ds_read_b128 v[200:203], v118 offset:49152
    ds_read_b64_tr_b16 v[48:49], v9 offset:59392
    ds_read_b64_tr_b16 v[50:51], v9 offset:59648
    s_mov_b64 exec, s[86:87]
    ds_read_b128 v[48:51], v124 offset:448
    s_mov_b64 exec, -1
    v_lshrrev_b32 v38, 9, v0
    v_lshl_add_u32 v37, v38, 2, v37
    v_mul_u32_u24 v39, 56, v37
    v_bfe_u32 v37, v0, 8, 1
    v_bfe_u32 v38, v0, 4, 2
    s_waitcnt lgkmcnt(4)
    v_mfma_f32_32x32x16_bf16 v[64:79], v[44:47], v[196:199], v[64:79]
    ds_read_b128 v[204:207], v121 offset:49152
    ds_read_b64_tr_b16 v[52:53], v9 offset:60416
    ds_read_b64_tr_b16 v[54:55], v9 offset:60672
    s_mov_b64 exec, s[86:87]
    ds_read_b128 v[52:55], v124 offset:480
    s_mov_b64 exec, -1
    s_add_u32 m0, s74, 98304
    s_mul_i32 s79, s76, 12544
    s_add_u32 s79, s79, s74
    buffer_load_dwordx4 v0, s[64:67], s79 offen lds
    buffer_load_dwordx4 v0, s[64:67], s79 offen offset:1024 lds
    v_lshl_or_b32 v37, v37, 2, v38
    v_min_u32 v37, 6, v37
    v_lshl_add_u32 v39, v37, 3, v39
    v_add_u32 v39, 98304, v39
    v_bfe_u32 v37, v0, 4, 5
    s_waitcnt lgkmcnt(4)
    v_mfma_f32_32x32x16_bf16 v[64:79], v[48:51], v[200:203], v[64:79]
    s_waitcnt vmcnt(4)
    s_barrier
    s_add_u32 m0, s74, 32768
    ds_read_b128 v[208:211], v112 offset:0
    ds_read_b64_tr_b16 v[56:57], v10 offset:16384
    ds_read_b64_tr_b16 v[58:59], v10 offset:16640
    s_mov_b64 exec, s[86:87]
    ds_read_b128 v[56:59], v124 offset:512
    s_mov_b64 exec, -1
    buffer_load_dwordx4 v3, s[4:7], s94 offen lds
    v_lshl_add_u32 v132, s45, 5, v37
    v_lshlrev_b32 v35, 7, v132
    v_and_b32 v38, 2, v37
    v_lshl_or_b32 v35, v38, 5, v35
    v_and_b32 v38, 12, v37
    s_waitcnt lgkmcnt(4)
    v_mfma_f32_32x32x16_bf16 v[64:79], v[52:55], v[204:207], v[64:79]
    s_add_u32 m0, s74, 33792
    ds_read_b128 v[212:215], v115 offset:0
    ds_read_b64_tr_b16 v[60:61], v10 offset:17408
    ds_read_b64_tr_b16 v[62:63], v10 offset:17664
    s_mov_b64 exec, s[86:87]
    ds_read_b128 v[60:63], v124 offset:544
    s_mov_b64 exec, -1
    buffer_load_dwordx4 v4, s[4:7], s94 offen lds
    v_lshl_or_b32 v35, v38, 2, v35
    v_lshrrev_b32 v38, 9, v0
    v_xor_b32 v38, v38, v37
    v_and_b32 v38, 1, v38
    v_lshl_or_b32 v35, v38, 3, v35
    s_waitcnt lgkmcnt(4)
    v_mfma_f32_32x32x16_bf16 v[64:79], v[56:59], v[208:211], v[64:79]
    ds_read_b128 v[216:219], v118 offset:0
    ds_read_b64_tr_b16 v[40:41], v10 offset:18432
    ds_read_b64_tr_b16 v[42:43], v10 offset:18688
    s_mov_b64 exec, s[86:87]
    ds_read_b128 v[40:43], v124 offset:576
    s_mov_b64 exec, -1
    v_add_u32 v35, 114688, v35
    v_lshlrev_b32 v132, 6, v132
    v_bfe_u32 v37, v37, 1, 3
    v_lshrrev_b32 v38, 9, v0
    v_xor_b32 v37, v37, v38
    s_waitcnt lgkmcnt(4)
    v_mfma_f32_32x32x16_bf16 v[64:79], v[60:63], v[212:215], v[64:79]
    ds_read_b128 v[220:223], v121 offset:0
    ds_read_b64_tr_b16 v[44:45], v10 offset:19456
    ds_read_b64_tr_b16 v[46:47], v10 offset:19712
    s_mov_b64 exec, s[86:87]
    ds_read_b128 v[44:47], v124 offset:608
    s_mov_b64 exec, -1
    v_lshl_or_b32 v132, v37, 3, v132
    v_add_u32 v132, 131072, v132
    v_bfe_u32 v27, v0, 6, 2
    v_lshrrev_b32 v37, 9, v0
    v_lshl_add_u32 v38, v37, 3, v27
    s_waitcnt lgkmcnt(4)
    v_mfma_f32_32x32x16_bf16 v[64:79], v[40:43], v[216:219], v[64:79]
    s_waitcnt vmcnt(4)
    s_barrier
    ds_read_b128 v[224:227], v112 offset:16384
    ds_read_b64_tr_b16 v[48:49], v10 offset:8192
    ds_read_b64_tr_b16 v[50:51], v10 offset:8448
    s_mov_b64 exec, s[86:87]
    ds_read_b128 v[48:51], v124 offset:640
    s_mov_b64 exec, -1
    v_lshlrev_b32 v128, 7, v38
    v_lshlrev_b32 v130, 6, v38
    v_bfe_u32 v129, v0, 4, 2
    v_bfe_u32 v131, v0, 8, 1
    v_lshl_or_b32 v129, v131, 2, v129
    s_waitcnt lgkmcnt(4)
    v_mfma_f32_32x32x16_bf16 v[64:79], v[44:47], v[220:223], v[64:79]
    ds_read_b128 v[228:231], v115 offset:16384
    ds_read_b64_tr_b16 v[52:53], v10 offset:9216
    ds_read_b64_tr_b16 v[54:55], v10 offset:9472
    s_mov_b64 exec, s[86:87]
    ds_read_b128 v[52:55], v124 offset:672
    s_mov_b64 exec, -1
    v_lshrrev_b32 v38, 1, v38
    v_xor_b32 v38, v38, v129
    v_lshl_or_b32 v130, v38, 3, v130
    v_add_u32 v130, 131072, v130
    v_xor_b32 v131, 16, v130
    s_waitcnt lgkmcnt(4)
    v_mfma_f32_32x32x16_bf16 v[64:79], v[48:51], v[224:227], v[64:79]
    ds_read_b128 v[232:235], v118 offset:16384
    ds_read_b64_tr_b16 v[56:57], v10 offset:10240
    ds_read_b64_tr_b16 v[58:59], v10 offset:10496
    s_mov_b64 exec, s[86:87]
    ds_read_b128 v[56:59], v124 offset:704
    s_mov_b64 exec, -1
    v_and_b32 v38, 1, v27
    v_lshl_or_b32 v38, v37, 2, v38
    v_lshrrev_b32 v27, 1, v27
    v_xor_b32 v27, s72, v27
    v_and_b32 v27, 1, v27
    s_waitcnt lgkmcnt(4)
    v_mfma_f32_32x32x16_bf16 v[64:79], v[52:55], v[228:231], v[64:79]
    ds_read_b128 v[236:239], v121 offset:16384
    ds_read_b64_tr_b16 v[60:61], v10 offset:11264
    ds_read_b64_tr_b16 v[62:63], v10 offset:11520
    s_mov_b64 exec, s[86:87]
    ds_read_b128 v[60:63], v124 offset:736
    s_mov_b64 exec, -1
    v_lshl_or_b32 v38, v27, 3, v38
    v_xor_b32 v38, v38, v129
    v_lshl_or_b32 v128, v38, 3, v128
    v_add_u32 v128, 114688, v128
    v_xor_b32 v129, 16, v128
    s_waitcnt vmcnt(2)
    s_waitcnt lgkmcnt(4)
    v_mfma_f32_32x32x16_bf16 v[64:79], v[56:59], v[232:235], v[64:79]
    s_waitcnt vmcnt(0)
    s_barrier
    ds_read_b128 v[240:243], v112 offset:32768
    ds_read_b64_tr_b16 v[40:41], v10 offset:0
    ds_read_b64_tr_b16 v[42:43], v10 offset:256
    s_mov_b64 exec, s[86:87]
    ds_read_b128 v[40:43], v124 offset:768
    s_mov_b64 exec, -1
    s_waitcnt lgkmcnt(4)
    v_mfma_f32_32x32x16_bf16 v[64:79], v[60:63], v[236:239], v[64:79]
    ds_read_b128 v[244:247], v115 offset:32768
    ds_read_b64_tr_b16 v[44:45], v10 offset:1024
    ds_read_b64_tr_b16 v[46:47], v10 offset:1280
    s_mov_b64 exec, s[86:87]
    ds_read_b128 v[44:47], v124 offset:800
    s_mov_b64 exec, -1
    s_waitcnt lgkmcnt(4)
    v_mfma_f32_32x32x16_bf16 v[64:79], v[40:43], v[240:243], v[64:79]
    ds_read_b128 v[248:251], v118 offset:32768
    ds_read_b64_tr_b16 v[48:49], v10 offset:2048
    ds_read_b64_tr_b16 v[50:51], v10 offset:2304
    s_mov_b64 exec, s[86:87]
    ds_read_b128 v[48:51], v124 offset:832
    s_mov_b64 exec, -1
    s_waitcnt lgkmcnt(4)
    v_mfma_f32_32x32x16_bf16 v[64:79], v[44:47], v[244:247], v[64:79]
    ds_read_b128 v[252:255], v121 offset:32768
    ds_read_b64_tr_b16 v[52:53], v10 offset:3072
    ds_read_b64_tr_b16 v[54:55], v10 offset:3328
    s_mov_b64 exec, s[86:87]
    ds_read_b128 v[52:55], v124 offset:864
    s_mov_b64 exec, -1
    s_waitcnt lgkmcnt(4)
    v_mfma_f32_32x32x16_bf16 v[64:79], v[48:51], v[248:251], v[64:79]
    s_waitcnt lgkmcnt(0)
    v_mfma_f32_32x32x16_bf16 v[64:79], v[52:55], v[252:255], v[64:79]
    s_barrier
    s_nop 10
    v_mul_f32 v37, 0xbfb8aa3b, v76
    v_add_u32 v3, 43008, v1
    v_exp_f32 v37, v37
    s_nop 0
    v_add_f32 v37, 1.0, v37
    v_rcp_f32 v37, v37
    s_nop 0
    v_mov_b32 v32, v37
    s_nop 1
    v_permlane32_swap_b32 v37, v32
    ds_read_b64_tr_b16 v[20:21], v39 offset:10976
    ds_read_b64_tr_b16 v[22:23], v39 offset:11424
    ds_read_b64_tr_b16 v[24:25], v39 offset:11872
    ds_read_b64_tr_b16 v[26:27], v39 offset:12320
    v_cvt_pk_bf16_f32 v18, v76, v77
    v_cvt_pk_bf16_f32 v19, v78, v79
    v_cvt_pk_bf16_f32 v12, v64, v65
    v_cvt_pk_bf16_f32 v13, v66, v67
    v_cvt_pk_bf16_f32 v14, v68, v69
    v_cvt_pk_bf16_f32 v15, v70, v71
    s_add_u32 m0, s73, 16384
    v_cvt_pk_bf16_f32 v16, v72, v73
    buffer_load_dwordx4 v1, s[16:19], s97 offen lds
    v_cvt_pk_bf16_f32 v17, v74, v75
    v_cndmask_b32 v18, v18, 0, s[84:85]
    v_cndmask_b32 v19, v19, 0, s[84:85]
    s_waitcnt lgkmcnt(0)
    v_mfma_f32_32x32x16_bf16 v[64:79], v[20:23], v[12:15], 0
    v_mfma_f32_32x32x16_bf16 v[64:79], v[24:27], v[16:19], v[64:79]
    s_add_u32 m0, s73, 20480
    s_nop 0
    buffer_load_dwordx4 v3, s[16:19], s97 offen lds
    s_nop 8
    v_cndmask_b32 v76, v76, v78, s[84:85]
    v_cndmask_b32 v77, v77, v79, s[84:85]
    v_max3_f32 v28, v64, v65, v66
    v_min3_f32 v29, v64, v65, v66
    v_max3_f32 v30, v67, v68, v69
    s_add_u32 m0, s73, 24576
    v_min3_f32 v31, v67, v68, v69
    buffer_load_dwordx4 v1, s[8:11], s97 offen lds
    v_max3_f32 v28, v28, v70, v71
    v_min3_f32 v29, v29, v70, v71
    v_max3_f32 v30, v30, v72, v73
    v_min3_f32 v31, v31, v72, v73
    v_max3_f32 v28, v28, v74, v75
    v_min3_f32 v29, v29, v74, v75
    v_max3_f32 v30, v30, v76, v77
    v_min3_f32 v31, v31, v76, v77
    v_max_f32 v28, v28, v30
    v_min_f32 v29, v29, v31
    v_mul_f32 v28, s82, v28
    s_add_u32 m0, s73, 28672
    v_mul_f32 v29, 0xbfb8aa3b, v29
    buffer_load_dwordx4 v3, s[8:11], s97 offen lds
    s_nop 0
    v_permlane32_swap_b32 v28, v29
    v_max_f32 v28, v28, v29
    v_mov_b32 v29, v28
    s_nop 1
    v_permlane32_swap_b32 v28, v29
    v_fma_f32 v12, v64, s82, -v28
    v_fma_f32 v13, v65, s82, -v28
    v_fma_f32 v64, -v64, s82, -v29
    v_add_u32 v2, 896, v2
    s_add_u32 m0, s73, 32768
    s_nop 0
    buffer_load_dwordx4 v2, s[16:19], s97 offen lds
    s_add_u32 m0, s73, 40960
    s_nop 0
    buffer_load_dwordx4 v2, s[16:19], s98 offen lds
    s_barrier
    v_fma_f32 v65, -v65, s82, -v29
    v_exp_f32 v12, v12
    s_add_u32 m0, s73, 65536
    v_fma_f32 v14, v66, s82, -v28
    buffer_load_dwordx4 v1, s[16:19], s98 offen lds
    v_exp_f32 v13, v13
    v_fma_f32 v15, v67, s82, -v28
    v_exp_f32 v64, v64
    v_fma_f32 v66, -v66, s82, -v29
    v_exp_f32 v65, v65
    v_fma_f32 v67, -v67, s82, -v29
    v_exp_f32 v14, v14
    s_add_u32 m0, s73, 69632
    v_fma_f32 v16, v68, s82, -v28
    buffer_load_dwordx4 v3, s[16:19], s98 offen lds
    v_exp_f32 v15, v15
    v_fma_f32 v17, v69, s82, -v28
    v_exp_f32 v66, v66
    v_fma_f32 v68, -v68, s82, -v29
    v_exp_f32 v67, v67
    v_fma_f32 v69, -v69, s82, -v29
    v_exp_f32 v16, v16
    v_fma_f32 v18, v70, s82, -v28
    s_add_u32 m0, s73, 73728
    v_fma_f32 v19, v71, s82, -v28
    buffer_load_dwordx4 v1, s[8:11], s98 offen lds
    v_exp_f32 v17, v17
    v_fma_f32 v70, -v70, s82, -v29
    v_fma_f32 v71, -v71, s82, -v29
    v_exp_f32 v68, v68
    v_add_f32 v26, v12, v14
    v_add_f32 v27, v13, v15
    v_exp_f32 v69, v69
    v_add_f32 v30, v64, v66
    s_add_u32 m0, s73, 77824
    v_add_f32 v31, v65, v67
    buffer_load_dwordx4 v3, s[8:11], s98 offen lds
    v_exp_f32 v18, v18
    v_fma_f32 v20, v72, s82, -v28
    v_fma_f32 v21, v73, s82, -v28
    v_exp_f32 v19, v19
    v_fma_f32 v72, -v72, s82, -v29
    v_fma_f32 v73, -v73, s82, -v29
    v_exp_f32 v70, v70
    v_add_f32 v26, v26, v16
    v_add_f32 v27, v27, v17
    s_add_u32 m0, s73, 90112
    v_exp_f32 v71, v71
    buffer_load_dwordx4 v2, s[16:19], s99 offen lds
    v_add_f32 v30, v30, v68
    v_add_f32 v31, v31, v69
    v_exp_f32 v20, v20
    v_fma_f32 v22, v74, s82, -v28
    v_fma_f32 v23, v75, s82, -v28
    v_exp_f32 v21, v21
    v_fma_f32 v74, -v74, s82, -v29
    v_fma_f32 v75, -v75, s82, -v29
    s_add_u32 m0, s73, 139264
    v_exp_f32 v72, v72
    buffer_load_dwordx4 v2, s[16:19], s100 offen lds
    v_add_f32 v26, v26, v18
    v_add_f32 v27, v27, v19
    v_exp_f32 v73, v73
    v_add_f32 v30, v30, v70
    v_add_f32 v31, v31, v71
    v_exp_f32 v22, v22
    s_waitcnt vmcnt(8)
    s_barrier
    v_fma_f32 v24, v76, s82, -v28
    v_fma_f32 v25, v77, s82, -v28
    v_exp_f32 v23, v23
    s_add_u32 m0, s73, 0
    v_fma_f32 v76, -v76, s82, -v29
    buffer_load_dwordx4 v1, s[16:19], s99 offen lds
    v_fma_f32 v77, -v77, s82, -v29
    v_exp_f32 v74, v74
    v_add_f32 v26, v26, v20
    v_add_f32 v27, v27, v21
    v_exp_f32 v75, v75
    v_add_f32 v30, v30, v72
    v_add_f32 v31, v31, v73
    v_exp_f32 v24, v24
    s_add_u32 m0, s73, 4096
    v_add_f32 v26, v26, v22
    buffer_load_dwordx4 v3, s[16:19], s99 offen lds
    v_exp_f32 v25, v25
    v_add_f32 v27, v27, v23
    v_exp_f32 v76, v76
    v_add_f32 v30, v30, v74
    v_exp_f32 v77, v77
    v_add_f32 v31, v31, v75
    v_add_f32 v26, v26, v24
    v_add_f32 v27, v27, v25
    s_add_u32 m0, s73, 81920
    v_add_f32 v30, v30, v76
    buffer_load_dwordx4 v1, s[8:11], s99 offen lds
    v_add_f32 v31, v31, v77
    v_add_f32 v28, v26, v27
    v_add_f32 v29, v30, v31
    s_nop 1
    v_permlane32_swap_b32 v28, v29
    v_add_f32 v28, v28, v29
    v_rcp_f32 v28, v28
    s_nop 0
    v_mov_b32 v29, v28
    s_nop 1
    v_permlane32_swap_b32 v28, v29
    s_add_u32 m0, s73, 86016
    v_mul_f32 v64, v64, v29
    buffer_load_dwordx4 v3, s[8:11], s99 offen lds
    v_mul_f32 v65, v65, v29
    v_mul_f32 v66, v66, v29
    v_mul_f32 v67, v67, v29
    v_mul_f32 v68, v68, v29
    v_mul_f32 v69, v69, v29
    v_cvt_pk_bf16_f32 v64, v64, v65
    v_mul_f32 v70, v70, v29
    v_mul_f32 v71, v71, v29
    v_cvt_pk_bf16_f32 v65, v66, v67
    v_mul_f32 v72, v72, v29
    v_mul_f32 v73, v73, v29
    v_cvt_pk_bf16_f32 v66, v68, v69
    s_add_u32 m0, s73, 147456
    v_mul_f32 v74, v74, v29
    buffer_load_dwordx4 v2, s[16:19], s101 offen lds
    v_mul_f32 v75, v75, v29
    v_cvt_pk_bf16_f32 v67, v70, v71
    v_mul_f32 v76, v76, v29
    v_mul_f32 v77, v77, v29
    v_cvt_pk_bf16_f32 v68, v72, v73
    v_mul_f32 v12, v12, v28
    v_mul_f32 v13, v13, v28
    v_cvt_pk_bf16_f32 v69, v74, v75
    v_mul_f32 v14, v14, v28
    v_mul_f32 v15, v15, v28
    v_cvt_pk_bf16_f32 v70, v76, v77
    v_mul_f32 v16, v16, v28
    v_mul_f32 v17, v17, v28
    v_cvt_pk_bf16_f32 v72, v12, v13
    v_mul_f32 v18, v18, v28
    v_mul_f32 v19, v19, v28
    v_cvt_pk_bf16_f32 v73, v14, v15
    v_mul_f32 v20, v20, v28
    v_mul_f32 v21, v21, v28
    v_cvt_pk_bf16_f32 v74, v16, v17
    v_mul_f32 v22, v22, v28
    s_waitcnt vmcnt(7)
    s_barrier
    v_mul_f32 v23, v23, v28
    s_add_u32 m0, s73, 8192
    s_nop 0
    buffer_load_dwordx4 v1, s[16:19], s100 offen lds
    v_cvt_pk_bf16_f32 v75, v18, v19
    v_mul_f32 v24, v24, v28
    v_mul_f32 v25, v25, v28
    v_cvt_pk_bf16_f32 v76, v20, v21
    v_cvt_pk_bf16_f32 v77, v22, v23
    v_cvt_pk_bf16_f32 v78, v24, v25
    v_mov_b32 v71, 0
    v_mov_b32 v79, 0
    v_xor_b32 v37, 64, v35
    ds_write_b64 v37, v[64:65]
    s_add_u32 m0, s73, 12288
    v_xor_b32 v38, 80, v35
    ds_write_b64 v38, v[66:67]
    buffer_load_dwordx4 v3, s[16:19], s100 offen lds
    v_xor_b32 v37, 96, v35
    ds_write_b64 v37, v[68:69]
    v_xor_b32 v38, 112, v35
    ds_write_b64 v38, v[70:71]
    ds_write_b64 v35, v[72:73]
    v_xor_b32 v38, 16, v35
    ds_write_b64 v38, v[74:75]
    v_xor_b32 v37, 32, v35
    ds_write_b64 v37, v[76:77]
    s_add_u32 m0, s73, 16384
    v_xor_b32 v38, 48, v35
    ds_write_b64 v38, v[78:79]
    buffer_load_dwordx4 v1, s[8:11], s100 offen lds
    v_mov_b32 v34, 2147418112
    v_writelane_b32 v34, 0, 0
    buffer_load_dword v36, v34, s[32:35], 0 offen sc1
    ds_read_b64_tr_b16 v[56:57], v8 offset:49152
    ds_read_b64_tr_b16 v[58:59], v8 offset:49408
    ds_read_b64_tr_b16 v[60:61], v8 offset:50176
    ds_read_b64_tr_b16 v[62:63], v8 offset:50432
    s_add_u32 m0, s73, 20480
    ds_read_b64_tr_b16 v[40:41], v8 offset:51200
    ds_read_b64_tr_b16 v[42:43], v8 offset:51456
    buffer_load_dwordx4 v3, s[8:11], s100 offen lds
    s_waitcnt lgkmcnt(4)
    v_mfma_f32_32x32x16_bf16 v[64:79], v[56:59], v[144:147], 0
    ds_read_b64_tr_b16 v[44:45], v8 offset:52224
    ds_read_b64_tr_b16 v[46:47], v8 offset:52480
    s_waitcnt lgkmcnt(4)
    v_mfma_f32_32x32x16_bf16 v[64:79], v[60:63], v[148:151], v[64:79]
    ds_read_b64_tr_b16 v[48:49], v8 offset:57344
    ds_read_b64_tr_b16 v[50:51], v8 offset:57600
    s_waitcnt lgkmcnt(4)
    v_mfma_f32_32x32x16_bf16 v[64:79], v[40:43], v[152:155], v[64:79]
    ds_read_b64_tr_b16 v[52:53], v8 offset:58368
    ds_read_b64_tr_b16 v[54:55], v8 offset:58624
    s_waitcnt lgkmcnt(4)
    v_mfma_f32_32x32x16_bf16 v[64:79], v[44:47], v[156:159], v[64:79]
    ds_read_b64_tr_b16 v[56:57], v8 offset:59392
    ds_read_b64_tr_b16 v[58:59], v8 offset:59648
    s_waitcnt lgkmcnt(4)
    v_mfma_f32_32x32x16_bf16 v[64:79], v[48:51], v[160:163], v[64:79]
    ds_read_b64_tr_b16 v[60:61], v8 offset:60416
    ds_read_b64_tr_b16 v[62:63], v8 offset:60672
    s_waitcnt lgkmcnt(4)
    v_mfma_f32_32x32x16_bf16 v[64:79], v[52:55], v[164:167], v[64:79]
    ds_read_b64_tr_b16 v[40:41], v8 offset:32768
    ds_read_b64_tr_b16 v[42:43], v8 offset:33024
    s_waitcnt lgkmcnt(4)
    v_mfma_f32_32x32x16_bf16 v[64:79], v[56:59], v[168:171], v[64:79]
    ds_read_b64_tr_b16 v[44:45], v8 offset:33792
    ds_read_b64_tr_b16 v[46:47], v8 offset:34048
    s_waitcnt lgkmcnt(4)
    v_mfma_f32_32x32x16_bf16 v[64:79], v[60:63], v[172:175], v[64:79]
    ds_read_b64_tr_b16 v[48:49], v8 offset:34816
    ds_read_b64_tr_b16 v[50:51], v8 offset:35072
    s_waitcnt lgkmcnt(4)
    v_mfma_f32_32x32x16_bf16 v[64:79], v[40:43], v[176:179], v[64:79]
    ds_read_b64_tr_b16 v[52:53], v8 offset:35840
    ds_read_b64_tr_b16 v[54:55], v8 offset:36096
    s_waitcnt lgkmcnt(4)
    v_mfma_f32_32x32x16_bf16 v[64:79], v[44:47], v[180:183], v[64:79]
    ds_read_b64_tr_b16 v[56:57], v8 offset:40960
    ds_read_b64_tr_b16 v[58:59], v8 offset:41216
    s_waitcnt lgkmcnt(4)
    v_mfma_f32_32x32x16_bf16 v[64:79], v[48:51], v[184:187], v[64:79]
    ds_read_b64_tr_b16 v[60:61], v8 offset:41984
    ds_read_b64_tr_b16 v[62:63], v8 offset:42240
    s_waitcnt lgkmcnt(4)
    v_mfma_f32_32x32x16_bf16 v[64:79], v[52:55], v[188:191], v[64:79]
    ds_read_b64_tr_b16 v[40:41], v8 offset:43008
    ds_read_b64_tr_b16 v[42:43], v8 offset:43264
    s_waitcnt lgkmcnt(4)
    v_mfma_f32_32x32x16_bf16 v[64:79], v[56:59], v[192:195], v[64:79]
    ds_read_b64_tr_b16 v[44:45], v8 offset:44032
    ds_read_b64_tr_b16 v[46:47], v8 offset:44288
    s_waitcnt lgkmcnt(4)
    v_mfma_f32_32x32x16_bf16 v[64:79], v[60:63], v[196:199], v[64:79]
    s_waitcnt vmcnt(5)
    s_barrier
    s_add_u32 m0, s73, 24576
    ds_read_b64_tr_b16 v[48:49], v9 offset:24576
    ds_read_b64_tr_b16 v[50:51], v9 offset:24832
    buffer_load_dwordx4 v1, s[16:19], s101 offen lds
    s_waitcnt lgkmcnt(4)
    v_mfma_f32_32x32x16_bf16 v[64:79], v[40:43], v[200:203], v[64:79]
    ds_read_b64_tr_b16 v[52:53], v9 offset:25600
    ds_read_b64_tr_b16 v[54:55], v9 offset:25856
    s_waitcnt lgkmcnt(4)
    v_mfma_f32_32x32x16_bf16 v[64:79], v[44:47], v[204:207], v[64:79]
    s_add_u32 m0, s73, 28672
    ds_read_b64_tr_b16 v[56:57], v9 offset:26624
    ds_read_b64_tr_b16 v[58:59], v9 offset:26880
    buffer_load_dwordx4 v3, s[16:19], s101 offen lds
    s_waitcnt lgkmcnt(4)
    v_mfma_f32_32x32x16_bf16 v[64:79], v[48:51], v[208:211], v[64:79]
    ds_read_b64_tr_b16 v[60:61], v9 offset:27648
    ds_read_b64_tr_b16 v[62:63], v9 offset:27904
    s_waitcnt lgkmcnt(4)
    v_mfma_f32_32x32x16_bf16 v[64:79], v[52:55], v[212:215], v[64:79]
    s_add_u32 m0, s73, 32768
    ds_read_b64_tr_b16 v[40:41], v10 offset:8192
    ds_read_b64_tr_b16 v[42:43], v10 offset:8448
    buffer_load_dwordx4 v1, s[8:11], s101 offen lds
    s_waitcnt lgkmcnt(4)
    v_mfma_f32_32x32x16_bf16 v[64:79], v[56:59], v[216:219], v[64:79]
    ds_read_b64_tr_b16 v[44:45], v10 offset:9216
    ds_read_b64_tr_b16 v[46:47], v10 offset:9472
    s_waitcnt lgkmcnt(4)
    v_mfma_f32_32x32x16_bf16 v[64:79], v[60:63], v[220:223], v[64:79]
    s_add_u32 m0, s73, 36864
    ds_read_b64_tr_b16 v[48:49], v10 offset:10240
    ds_read_b64_tr_b16 v[50:51], v10 offset:10496
    buffer_load_dwordx4 v3, s[8:11], s101 offen lds
    s_waitcnt lgkmcnt(4)
    v_mfma_f32_32x32x16_bf16 v[64:79], v[40:43], v[224:227], v[64:79]
    ds_read_b64_tr_b16 v[52:53], v10 offset:11264
    ds_read_b64_tr_b16 v[54:55], v10 offset:11520
    s_waitcnt lgkmcnt(4)
    v_mfma_f32_32x32x16_bf16 v[64:79], v[44:47], v[228:231], v[64:79]
    ds_read_b64_tr_b16 v[56:57], v10 offset:16384
    ds_read_b64_tr_b16 v[58:59], v10 offset:16640
    v_add_u32 v1, 192, v1
    v_add_u32 v3, 43008, v1
    s_waitcnt lgkmcnt(4)
    v_mfma_f32_32x32x16_bf16 v[64:79], v[48:51], v[232:235], v[64:79]
    ds_read_b64_tr_b16 v[60:61], v10 offset:17408
    ds_read_b64_tr_b16 v[62:63], v10 offset:17664
    s_waitcnt lgkmcnt(4)
    v_mfma_f32_32x32x16_bf16 v[64:79], v[52:55], v[236:239], v[64:79]
    s_add_u32 m0, s73, 49152
    ds_read_b64_tr_b16 v[40:41], v10 offset:18432
    ds_read_b64_tr_b16 v[42:43], v10 offset:18688
    buffer_load_dwordx4 v1, s[16:19], s95 offen lds
    s_waitcnt lgkmcnt(4)
    v_mfma_f32_32x32x16_bf16 v[64:79], v[56:59], v[240:243], v[64:79]
    ds_read_b64_tr_b16 v[44:45], v10 offset:19456
    ds_read_b64_tr_b16 v[46:47], v10 offset:19712
    s_waitcnt lgkmcnt(4)
    v_mfma_f32_32x32x16_bf16 v[64:79], v[60:63], v[244:247], v[64:79]
    s_add_u32 m0, s73, 53248
    s_nop 0
    buffer_load_dwordx4 v3, s[16:19], s95 offen lds
    s_waitcnt lgkmcnt(2)
    v_mfma_f32_32x32x16_bf16 v[64:79], v[40:43], v[248:251], v[64:79]
    s_waitcnt lgkmcnt(0)
    v_mfma_f32_32x32x16_bf16 v[64:79], v[44:47], v[252:255], v[64:79]
    s_add_u32 m0, s73, 57344
    s_nop 0
    buffer_load_dwordx4 v1, s[8:11], s95 offen lds
    s_nop 8
    v_cvt_pk_bf16_f32 v64, v64, v65
    v_cvt_pk_bf16_f32 v65, v66, v67
    v_cvt_pk_bf16_f32 v66, v68, v69
    v_cvt_pk_bf16_f32 v67, v70, v71
    v_cvt_pk_bf16_f32 v68, v72, v73
    v_cvt_pk_bf16_f32 v69, v74, v75
    v_cvt_pk_bf16_f32 v70, v76, v77
    v_cvt_pk_bf16_f32 v71, v78, v79
    v_mov_b32 v37, 0x3f80
    v_cndmask_b32 v70, v70, v37, s[84:85]
    s_add_u32 m0, s73, 61440
    v_cndmask_b32 v71, v71, 0, s[84:85]
    buffer_load_dwordx4 v3, s[8:11], s95 offen lds
    ds_write_b64 v132, v[64:65]
    v_xor_b32 v38, 16, v132
    ds_write_b64 v38, v[66:67]
    v_xor_b32 v37, 32, v132
    ds_write_b64 v37, v[68:69]
    v_xor_b32 v38, 48, v132
    ds_write_b64 v38, v[70:71]
    s_waitcnt lgkmcnt(0)
    s_waitcnt vmcnt(8)
    s_barrier
    ds_read_b64_tr_b16 v[80:81], v128 offset:0
    ds_read_b64_tr_b16 v[82:83], v129 offset:512
    ds_read_b64_tr_b16 v[84:85], v130 offset:0
    ds_read_b64_tr_b16 v[86:87], v131 offset:256
    ds_read_b64_tr_b16 v[88:89], v128 offset:2048
    ds_read_b64_tr_b16 v[90:91], v129 offset:2560
    ds_read_b64_tr_b16 v[92:93], v130 offset:1024
    ds_read_b64_tr_b16 v[94:95], v131 offset:1280
    ds_read_b64_tr_b16 v[96:97], v128 offset:4096
    ds_read_b64_tr_b16 v[98:99], v129 offset:4608
    ds_read_b64_tr_b16 v[100:101], v130 offset:2048
    ds_read_b64_tr_b16 v[102:103], v131 offset:2304
    s_waitcnt lgkmcnt(8)
    v_mfma_f32_32x32x16_bf16 v[64:79], v[80:83], v[84:87], 0
    ds_read_b64_tr_b16 v[104:105], v128 offset:6144
    ds_read_b64_tr_b16 v[106:107], v129 offset:6656
    ds_read_b64_tr_b16 v[108:109], v130 offset:3072
    ds_read_b64_tr_b16 v[110:111], v131 offset:3328
    s_add_u32 m0, s73, 0
    s_waitcnt lgkmcnt(8)
    v_mfma_f32_32x32x16_bf16 v[64:79], v[88:91], v[92:95], v[64:79]
    ds_read_b64_tr_b16 v[80:81], v128 offset:8192
    ds_read_b64_tr_b16 v[82:83], v129 offset:8704
    ds_read_b64_tr_b16 v[84:85], v130 offset:4096
    ds_read_b64_tr_b16 v[86:87], v131 offset:4352
    buffer_load_dwordx4 v1, s[16:19], s96 offen lds
    s_add_u32 m0, s73, 4096
    s_waitcnt lgkmcnt(8)
    v_mfma_f32_32x32x16_bf16 v[64:79], v[96:99], v[100:103], v[64:79]
    ds_read_b64_tr_b16 v[88:89], v128 offset:10240
    ds_read_b64_tr_b16 v[90:91], v129 offset:10752
    ds_read_b64_tr_b16 v[92:93], v130 offset:5120
    ds_read_b64_tr_b16 v[94:95], v131 offset:5376
    buffer_load_dwordx4 v3, s[16:19], s96 offen lds
    s_waitcnt lgkmcnt(8)
    v_mfma_f32_32x32x16_bf16 v[64:79], v[104:107], v[108:111], v[64:79]
    ds_read_b64_tr_b16 v[96:97], v128 offset:12288
    ds_read_b64_tr_b16 v[98:99], v129 offset:12800
    ds_read_b64_tr_b16 v[100:101], v130 offset:6144
    ds_read_b64_tr_b16 v[102:103], v131 offset:6400
    s_add_u32 m0, s73, 40960
    s_waitcnt lgkmcnt(8)
    v_mfma_f32_32x32x16_bf16 v[64:79], v[80:83], v[84:87], v[64:79]
    ds_read_b64_tr_b16 v[104:105], v128 offset:14336
    ds_read_b64_tr_b16 v[106:107], v129 offset:14848
    ds_read_b64_tr_b16 v[108:109], v130 offset:7168
    ds_read_b64_tr_b16 v[110:111], v131 offset:7424
    buffer_load_dwordx4 v1, s[8:11], s96 offen lds
    s_add_u32 m0, s73, 45056
    s_waitcnt lgkmcnt(8)
    v_mfma_f32_32x32x16_bf16 v[64:79], v[88:91], v[92:95], v[64:79]
    buffer_load_dwordx4 v3, s[8:11], s96 offen lds
    s_waitcnt lgkmcnt(4)
    v_mfma_f32_32x32x16_bf16 v[64:79], v[96:99], v[100:103], v[64:79]
    s_add_u32 m0, s73, 65536
    s_waitcnt lgkmcnt(0)
    v_mfma_f32_32x32x16_bf16 v[64:79], v[104:107], v[108:111], v[64:79]
    buffer_load_dwordx4 v1, s[16:19], s97 offen lds
    s_add_u32 m0, s73, 69632
    s_nop 9
    v_cvt_pk_bf16_f32 v64, v64, v65
    v_cvt_pk_bf16_f32 v65, v66, v67
    v_cvt_pk_bf16_f32 v66, v68, v69
    v_cvt_pk_bf16_f32 v67, v70, v71
    v_cvt_pk_bf16_f32 v68, v72, v73
    v_cvt_pk_bf16_f32 v69, v74, v75
    v_cvt_pk_bf16_f32 v70, v76, v77
    v_cvt_pk_bf16_f32 v71, v78, v79
    s_bitcmp1_b32 s72, 1
    s_cbranch_scc1 L_QA_kvhi1
    buffer_store_dwordx4 v[64:67], v0, s[28:31], s52 offen sc1
    s_branch L_QA_kvend2
L_QA_kvhi1:
    buffer_store_dwordx4 v[68:71], v0, s[28:31], s52 offen offset:1024 sc1
L_QA_kvend2:
    s_mov_b32 s83, 0
L_QA_spin3:
    v_cmp_eq_u32 vcc, 0, v36
    s_nop 0
    s_and_b64 vcc, vcc, 1
    s_cbranch_vccz L_QA_ok4
    buffer_load_dword v36, v34, s[32:35], 0 offen sc1
    s_add_u32 s83, s83, 1
    s_cmp_lt_u32 s83, 1000000
    s_waitcnt vmcnt(0)
    s_cbranch_scc1 L_QA_spin3
L_QA_ok4:
    v_readfirstlane_b32 s81, v36
    s_nop 1
    v_mov_b32 v34, s81
    buffer_load_dwordx4 v3, s[16:19], s97 offen lds
    s_waitcnt vmcnt(11)
    s_barrier
    s_add_u32 m0, s73, 8192
    s_nop 0
    buffer_load_dwordx4 v1, s[8:11], s97 offen lds
    s_add_u32 m0, s73, 12288
    s_nop 0
    buffer_load_dwordx4 v3, s[8:11], s97 offen lds
    s_add_u32 m0, s73, 73728
    s_nop 0
    buffer_load_dwordx4 v1, s[16:19], s98 offen lds
    s_add_u32 m0, s73, 77824
    s_nop 0
    buffer_load_dwordx4 v3, s[16:19], s98 offen lds
    s_add_u32 m0, s73, 81920
    s_nop 0
    buffer_load_dwordx4 v1, s[8:11], s98 offen lds
    s_add_u32 m0, s73, 86016
    s_nop 0
    buffer_load_dwordx4 v3, s[8:11], s98 offen lds
    s_mov_b32 s59, 0
    s_lshr_b32 s40, s75, 1
    s_mul_i32 s40, s40, 368640
    s_mul_i32 s80, s75, 16384
    s_add_u32 s40, s40, s80
    s_mul_i32 s80, s45, 4096
    s_add_u32 s40, s40, s80
    s_mul_i32 s80, s76, 200704
    s_add_u32 s40, s40, s80
    s_add_u32 s40, s40, 13731840
    s_lshl2_add_u32 s79, s75, s45
    s_lshl1_add_u32 s79, s79, s76
    s_mul_i32 s46, s79, 256
    s_add_u32 s46, s46, 18612224
    v_mov_b32 v37, 0xff
    v_add_u32 v38, 56, v5
    v_bfi_b32 v12, v37, v38, v5
    v_bfi_b32 v13, v37, v38, v6
    v_bfi_b32 v14, v37, v38, v7
    v_add_u32 v38, 112, v5
    v_bfi_b32 v15, v37, v38, v5
    v_bfi_b32 v16, v37, v38, v6
    v_bfi_b32 v17, v37, v38, v7
    v_add_u32 v38, 168, v5
    v_bfi_b32 v18, v37, v38, v5
    v_bfi_b32 v19, v37, v38, v6
    v_bfi_b32 v20, v37, v38, v7
    s_waitcnt vmcnt(7)
    buffer_store_dword v34, v33, s[28:31], s53 offen sc1
    s_barrier
    ds_read_b64_tr_b16 v[48:49], v5 offset:49152
    ds_read_b64_tr_b16 v[50:51], v5 offset:50176
    ds_read_b64_tr_b16 v[52:53], v12 offset:49152
    ds_read_b64_tr_b16 v[54:55], v12 offset:50176
    ds_read_b64_tr_b16 v[56:57], v15 offset:49152
    ds_read_b64_tr_b16 v[58:59], v15 offset:50176
    ds_read_b64_tr_b16 v[60:61], v18 offset:49152
    ds_read_b64_tr_b16 v[62:63], v18 offset:50176
    s_waitcnt lgkmcnt(6)
    v_mfma_f32_32x32x16_bf16 v[80:95], v[48:51], v[144:147], 0
    ds_read_b64_tr_b16 v[40:41], v5 offset:53248
    ds_read_b64_tr_b16 v[42:43], v5 offset:54272
    s_waitcnt lgkmcnt(6)
    v_mfma_f32_32x32x16_bf16 v[96:111], v[52:55], v[144:147], 0
    ds_read_b64_tr_b16 v[44:45], v12 offset:53248
    ds_read_b64_tr_b16 v[46:47], v12 offset:54272
    s_waitcnt lgkmcnt(6)
    v_mfma_f32_32x32x16_bf16 v[112:127], v[56:59], v[144:147], 0
    ds_read_b64_tr_b16 v[48:49], v15 offset:53248
    ds_read_b64_tr_b16 v[50:51], v15 offset:54272
    s_waitcnt lgkmcnt(6)
    v_mfma_f32_32x32x16_bf16 v[128:143], v[60:63], v[144:147], 0
    ds_read_b64_tr_b16 v[52:53], v18 offset:53248
    ds_read_b64_tr_b16 v[54:55], v18 offset:54272
    s_waitcnt lgkmcnt(6)
    v_mfma_f32_32x32x16_bf16 v[80:95], v[40:43], v[148:151], v[80:95]
    ds_read_b64_tr_b16 v[56:57], v5 offset:57344
    ds_read_b64_tr_b16 v[58:59], v5 offset:58368
    s_waitcnt lgkmcnt(6)
    v_mfma_f32_32x32x16_bf16 v[96:111], v[44:47], v[148:151], v[96:111]
    ds_read_b64_tr_b16 v[60:61], v12 offset:57344
    ds_read_b64_tr_b16 v[62:63], v12 offset:58368
    s_waitcnt lgkmcnt(6)
    v_mfma_f32_32x32x16_bf16 v[112:127], v[48:51], v[148:151], v[112:127]
    ds_read_b64_tr_b16 v[40:41], v15 offset:57344
    ds_read_b64_tr_b16 v[42:43], v15 offset:58368
    s_waitcnt lgkmcnt(6)
    v_mfma_f32_32x32x16_bf16 v[128:143], v[52:55], v[148:151], v[128:143]
    ds_read_b64_tr_b16 v[44:45], v18 offset:57344
    ds_read_b64_tr_b16 v[46:47], v18 offset:58368
    s_waitcnt lgkmcnt(6)
    v_mfma_f32_32x32x16_bf16 v[80:95], v[56:59], v[152:155], v[80:95]
    ds_read_b64_tr_b16 v[48:49], v5 offset:61440
    ds_read_b64_tr_b16 v[50:51], v5 offset:62464
    s_waitcnt lgkmcnt(6)
    v_mfma_f32_32x32x16_bf16 v[96:111], v[60:63], v[152:155], v[96:111]
    ds_read_b64_tr_b16 v[52:53], v12 offset:61440
    ds_read_b64_tr_b16 v[54:55], v12 offset:62464
    s_waitcnt lgkmcnt(6)
    v_mfma_f32_32x32x16_bf16 v[112:127], v[40:43], v[152:155], v[112:127]
    ds_read_b64_tr_b16 v[56:57], v15 offset:61440
    ds_read_b64_tr_b16 v[58:59], v15 offset:62464
    s_waitcnt lgkmcnt(6)
    v_mfma_f32_32x32x16_bf16 v[128:143], v[44:47], v[152:155], v[128:143]
    ds_read_b64_tr_b16 v[60:61], v18 offset:61440
    ds_read_b64_tr_b16 v[62:63], v18 offset:62464
    s_waitcnt lgkmcnt(6)
    v_mfma_f32_32x32x16_bf16 v[80:95], v[48:51], v[156:159], v[80:95]
    ds_read_b64_tr_b16 v[40:41], v5 offset:0
    ds_read_b64_tr_b16 v[42:43], v5 offset:1024
    s_waitcnt lgkmcnt(6)
    v_mfma_f32_32x32x16_bf16 v[96:111], v[52:55], v[156:159], v[96:111]
    ds_read_b64_tr_b16 v[44:45], v12 offset:0
    ds_read_b64_tr_b16 v[46:47], v12 offset:1024
    s_waitcnt lgkmcnt(6)
    v_mfma_f32_32x32x16_bf16 v[112:127], v[56:59], v[156:159], v[112:127]
    ds_read_b64_tr_b16 v[48:49], v15 offset:0
    ds_read_b64_tr_b16 v[50:51], v15 offset:1024
    s_waitcnt lgkmcnt(6)
    v_mfma_f32_32x32x16_bf16 v[128:143], v[60:63], v[156:159], v[128:143]
    ds_read_b64_tr_b16 v[52:53], v18 offset:0
    ds_read_b64_tr_b16 v[54:55], v18 offset:1024
    s_waitcnt lgkmcnt(6)
    v_mfma_f32_32x32x16_bf16 v[80:95], v[40:43], v[160:163], v[80:95]
    ds_read_b64_tr_b16 v[56:57], v5 offset:4096
    ds_read_b64_tr_b16 v[58:59], v5 offset:5120
    s_waitcnt lgkmcnt(6)
    v_mfma_f32_32x32x16_bf16 v[96:111], v[44:47], v[160:163], v[96:111]
    ds_read_b64_tr_b16 v[60:61], v12 offset:4096
    ds_read_b64_tr_b16 v[62:63], v12 offset:5120
    s_waitcnt lgkmcnt(6)
    v_mfma_f32_32x32x16_bf16 v[112:127], v[48:51], v[160:163], v[112:127]
    ds_read_b64_tr_b16 v[40:41], v15 offset:4096
    ds_read_b64_tr_b16 v[42:43], v15 offset:5120
    s_waitcnt lgkmcnt(6)
    v_mfma_f32_32x32x16_bf16 v[128:143], v[52:55], v[160:163], v[128:143]
    ds_read_b64_tr_b16 v[44:45], v18 offset:4096
    ds_read_b64_tr_b16 v[46:47], v18 offset:5120
    s_waitcnt lgkmcnt(6)
    v_mfma_f32_32x32x16_bf16 v[80:95], v[56:59], v[164:167], v[80:95]
    ds_read_b64_tr_b16 v[48:49], v5 offset:40960
    ds_read_b64_tr_b16 v[50:51], v5 offset:41984
    s_waitcnt lgkmcnt(6)
    v_mfma_f32_32x32x16_bf16 v[96:111], v[60:63], v[164:167], v[96:111]
    ds_read_b64_tr_b16 v[52:53], v12 offset:40960
    ds_read_b64_tr_b16 v[54:55], v12 offset:41984
    s_waitcnt lgkmcnt(6)
    v_mfma_f32_32x32x16_bf16 v[112:127], v[40:43], v[164:167], v[112:127]
    ds_read_b64_tr_b16 v[56:57], v15 offset:40960
    ds_read_b64_tr_b16 v[58:59], v15 offset:41984
    s_waitcnt lgkmcnt(6)
    v_mfma_f32_32x32x16_bf16 v[128:143], v[44:47], v[164:167], v[128:143]
    ds_read_b64_tr_b16 v[60:61], v18 offset:40960
    ds_read_b64_tr_b16 v[62:63], v18 offset:41984
    s_waitcnt lgkmcnt(6)
    v_mfma_f32_32x32x16_bf16 v[80:95], v[48:51], v[168:171], v[80:95]
    ds_read_b64_tr_b16 v[40:41], v5 offset:45056
    ds_read_b64_tr_b16 v[42:43], v5 offset:46080
    s_waitcnt lgkmcnt(6)
    v_mfma_f32_32x32x16_bf16 v[96:111], v[52:55], v[168:171], v[96:111]
    ds_read_b64_tr_b16 v[44:45], v12 offset:45056
    ds_read_b64_tr_b16 v[46:47], v12 offset:46080
    s_waitcnt lgkmcnt(6)
    v_mfma_f32_32x32x16_bf16 v[112:127], v[56:59], v[168:171], v[112:127]
    ds_read_b64_tr_b16 v[48:49], v15 offset:45056
    ds_read_b64_tr_b16 v[50:51], v15 offset:46080
    s_waitcnt lgkmcnt(6)
    v_mfma_f32_32x32x16_bf16 v[128:143], v[60:63], v[168:171], v[128:143]
    ds_read_b64_tr_b16 v[52:53], v18 offset:45056
    ds_read_b64_tr_b16 v[54:55], v18 offset:46080
    s_waitcnt lgkmcnt(6)
    v_mfma_f32_32x32x16_bf16 v[80:95], v[40:43], v[172:175], v[80:95]
    s_waitcnt vmcnt(3)
    s_barrier
    ds_read_b64_tr_b16 v[56:57], v6 offset:0
    ds_read_b64_tr_b16 v[58:59], v6 offset:1024
    s_waitcnt lgkmcnt(6)
    v_mfma_f32_32x32x16_bf16 v[96:111], v[44:47], v[172:175], v[96:111]
    ds_read_b64_tr_b16 v[60:61], v13 offset:0
    ds_read_b64_tr_b16 v[62:63], v13 offset:1024
    s_waitcnt lgkmcnt(6)
    v_mfma_f32_32x32x16_bf16 v[112:127], v[48:51], v[172:175], v[112:127]
    ds_read_b64_tr_b16 v[40:41], v16 offset:0
    ds_read_b64_tr_b16 v[42:43], v16 offset:1024
    s_waitcnt lgkmcnt(6)
    v_mfma_f32_32x32x16_bf16 v[128:143], v[52:55], v[172:175], v[128:143]
    ds_read_b64_tr_b16 v[44:45], v19 offset:0
    ds_read_b64_tr_b16 v[46:47], v19 offset:1024
    s_waitcnt lgkmcnt(6)
    v_mfma_f32_32x32x16_bf16 v[80:95], v[56:59], v[176:179], v[80:95]
    ds_read_b64_tr_b16 v[48:49], v6 offset:4096
    ds_read_b64_tr_b16 v[50:51], v6 offset:5120
    s_waitcnt lgkmcnt(6)
    v_mfma_f32_32x32x16_bf16 v[96:111], v[60:63], v[176:179], v[96:111]
    ds_read_b64_tr_b16 v[52:53], v13 offset:4096
    ds_read_b64_tr_b16 v[54:55], v13 offset:5120
    s_waitcnt lgkmcnt(6)
    v_mfma_f32_32x32x16_bf16 v[112:127], v[40:43], v[176:179], v[112:127]
    ds_read_b64_tr_b16 v[56:57], v16 offset:4096
    ds_read_b64_tr_b16 v[58:59], v16 offset:5120
    s_waitcnt lgkmcnt(6)
    v_mfma_f32_32x32x16_bf16 v[128:143], v[44:47], v[176:179], v[128:143]
    ds_read_b64_tr_b16 v[60:61], v19 offset:4096
    ds_read_b64_tr_b16 v[62:63], v19 offset:5120
    s_waitcnt lgkmcnt(6)
    v_mfma_f32_32x32x16_bf16 v[80:95], v[48:51], v[180:183], v[80:95]
    ds_read_b64_tr_b16 v[40:41], v5 offset:8192
    ds_read_b64_tr_b16 v[42:43], v5 offset:9216
    s_waitcnt lgkmcnt(6)
    v_mfma_f32_32x32x16_bf16 v[96:111], v[52:55], v[180:183], v[96:111]
    ds_read_b64_tr_b16 v[44:45], v12 offset:8192
    ds_read_b64_tr_b16 v[46:47], v12 offset:9216
    s_waitcnt lgkmcnt(6)
    v_mfma_f32_32x32x16_bf16 v[112:127], v[56:59], v[180:183], v[112:127]
    ds_read_b64_tr_b16 v[48:49], v15 offset:8192
    ds_read_b64_tr_b16 v[50:51], v15 offset:9216
    s_waitcnt lgkmcnt(6)
    v_mfma_f32_32x32x16_bf16 v[128:143], v[60:63], v[180:183], v[128:143]
    ds_read_b64_tr_b16 v[52:53], v18 offset:8192
    ds_read_b64_tr_b16 v[54:55], v18 offset:9216
    s_waitcnt lgkmcnt(6)
    v_mfma_f32_32x32x16_bf16 v[80:95], v[40:43], v[184:187], v[80:95]
    ds_read_b64_tr_b16 v[56:57], v5 offset:12288
    ds_read_b64_tr_b16 v[58:59], v5 offset:13312
    s_waitcnt lgkmcnt(6)
    v_mfma_f32_32x32x16_bf16 v[96:111], v[44:47], v[184:187], v[96:111]
    ds_read_b64_tr_b16 v[60:61], v12 offset:12288
    ds_read_b64_tr_b16 v[62:63], v12 offset:13312
    s_waitcnt lgkmcnt(6)
    v_mfma_f32_32x32x16_bf16 v[112:127], v[48:51], v[184:187], v[112:127]
    ds_read_b64_tr_b16 v[40:41], v15 offset:12288
    ds_read_b64_tr_b16 v[42:43], v15 offset:13312
    s_waitcnt lgkmcnt(6)
    v_mfma_f32_32x32x16_bf16 v[128:143], v[52:55], v[184:187], v[128:143]
    ds_read_b64_tr_b16 v[44:45], v18 offset:12288
    ds_read_b64_tr_b16 v[46:47], v18 offset:13312
    s_waitcnt lgkmcnt(6)
    v_mfma_f32_32x32x16_bf16 v[80:95], v[56:59], v[188:191], v[80:95]
    ds_read_b64_tr_b16 v[48:49], v6 offset:8192
    ds_read_b64_tr_b16 v[50:51], v6 offset:9216
    s_waitcnt lgkmcnt(6)
    v_mfma_f32_32x32x16_bf16 v[96:111], v[60:63], v[188:191], v[96:111]
    ds_read_b64_tr_b16 v[52:53], v13 offset:8192
    ds_read_b64_tr_b16 v[54:55], v13 offset:9216
    s_waitcnt lgkmcnt(6)
    v_mfma_f32_32x32x16_bf16 v[112:127], v[40:43], v[188:191], v[112:127]
    ds_read_b64_tr_b16 v[56:57], v16 offset:8192
    ds_read_b64_tr_b16 v[58:59], v16 offset:9216
    s_waitcnt lgkmcnt(6)
    v_mfma_f32_32x32x16_bf16 v[128:143], v[44:47], v[188:191], v[128:143]
    ds_read_b64_tr_b16 v[60:61], v19 offset:8192
    ds_read_b64_tr_b16 v[62:63], v19 offset:9216
    s_waitcnt lgkmcnt(6)
    v_mfma_f32_32x32x16_bf16 v[80:95], v[48:51], v[192:195], v[80:95]
    ds_read_b64_tr_b16 v[40:41], v6 offset:12288
    ds_read_b64_tr_b16 v[42:43], v6 offset:13312
    s_waitcnt lgkmcnt(6)
    v_mfma_f32_32x32x16_bf16 v[96:111], v[52:55], v[192:195], v[96:111]
    ds_read_b64_tr_b16 v[44:45], v13 offset:12288
    ds_read_b64_tr_b16 v[46:47], v13 offset:13312
    s_waitcnt lgkmcnt(6)
    v_mfma_f32_32x32x16_bf16 v[112:127], v[56:59], v[192:195], v[112:127]
    ds_read_b64_tr_b16 v[48:49], v16 offset:12288
    ds_read_b64_tr_b16 v[50:51], v16 offset:13312
    s_waitcnt lgkmcnt(6)
    v_mfma_f32_32x32x16_bf16 v[128:143], v[60:63], v[192:195], v[128:143]
    ds_read_b64_tr_b16 v[52:53], v19 offset:12288
    ds_read_b64_tr_b16 v[54:55], v19 offset:13312
    s_waitcnt lgkmcnt(6)
    v_mfma_f32_32x32x16_bf16 v[80:95], v[40:43], v[196:199], v[80:95]
    s_waitcnt vmcnt(1)
    s_barrier
    ds_read_b64_tr_b16 v[56:57], v6 offset:16384
    ds_read_b64_tr_b16 v[58:59], v6 offset:17408
    s_waitcnt lgkmcnt(6)
    v_mfma_f32_32x32x16_bf16 v[96:111], v[44:47], v[196:199], v[96:111]
    ds_read_b64_tr_b16 v[60:61], v13 offset:16384
    ds_read_b64_tr_b16 v[62:63], v13 offset:17408
    s_waitcnt lgkmcnt(6)
    v_mfma_f32_32x32x16_bf16 v[112:127], v[48:51], v[196:199], v[112:127]
    ds_read_b64_tr_b16 v[40:41], v16 offset:16384
    ds_read_b64_tr_b16 v[42:43], v16 offset:17408
    s_waitcnt lgkmcnt(6)
    v_mfma_f32_32x32x16_bf16 v[128:143], v[52:55], v[196:199], v[128:143]
    ds_read_b64_tr_b16 v[44:45], v19 offset:16384
    ds_read_b64_tr_b16 v[46:47], v19 offset:17408
    s_waitcnt lgkmcnt(6)
    v_mfma_f32_32x32x16_bf16 v[80:95], v[56:59], v[200:203], v[80:95]
    ds_read_b64_tr_b16 v[48:49], v6 offset:20480
    ds_read_b64_tr_b16 v[50:51], v6 offset:21504
    s_waitcnt lgkmcnt(6)
    v_mfma_f32_32x32x16_bf16 v[96:111], v[60:63], v[200:203], v[96:111]
    ds_read_b64_tr_b16 v[52:53], v13 offset:20480
    ds_read_b64_tr_b16 v[54:55], v13 offset:21504
    s_waitcnt lgkmcnt(6)
    v_mfma_f32_32x32x16_bf16 v[112:127], v[40:43], v[200:203], v[112:127]
    ds_read_b64_tr_b16 v[56:57], v16 offset:20480
    ds_read_b64_tr_b16 v[58:59], v16 offset:21504
    s_waitcnt lgkmcnt(6)
    v_mfma_f32_32x32x16_bf16 v[128:143], v[44:47], v[200:203], v[128:143]
    ds_read_b64_tr_b16 v[60:61], v19 offset:20480
    ds_read_b64_tr_b16 v[62:63], v19 offset:21504
    s_waitcnt lgkmcnt(6)
    v_mfma_f32_32x32x16_bf16 v[80:95], v[48:51], v[204:207], v[80:95]
    ds_read_b64_tr_b16 v[40:41], v5 offset:16384
    ds_read_b64_tr_b16 v[42:43], v5 offset:17408
    s_waitcnt lgkmcnt(6)
    v_mfma_f32_32x32x16_bf16 v[96:111], v[52:55], v[204:207], v[96:111]
    ds_read_b64_tr_b16 v[44:45], v12 offset:16384
    ds_read_b64_tr_b16 v[46:47], v12 offset:17408
    s_waitcnt lgkmcnt(6)
    v_mfma_f32_32x32x16_bf16 v[112:127], v[56:59], v[204:207], v[112:127]
    ds_read_b64_tr_b16 v[48:49], v15 offset:16384
    ds_read_b64_tr_b16 v[50:51], v15 offset:17408
    s_waitcnt lgkmcnt(6)
    v_mfma_f32_32x32x16_bf16 v[128:143], v[60:63], v[204:207], v[128:143]
    ds_read_b64_tr_b16 v[52:53], v18 offset:16384
    ds_read_b64_tr_b16 v[54:55], v18 offset:17408
    s_waitcnt lgkmcnt(6)
    v_mfma_f32_32x32x16_bf16 v[80:95], v[40:43], v[208:211], v[80:95]
    ds_read_b64_tr_b16 v[56:57], v5 offset:20480
    ds_read_b64_tr_b16 v[58:59], v5 offset:21504
    s_waitcnt lgkmcnt(6)
    v_mfma_f32_32x32x16_bf16 v[96:111], v[44:47], v[208:211], v[96:111]
    ds_read_b64_tr_b16 v[60:61], v12 offset:20480
    ds_read_b64_tr_b16 v[62:63], v12 offset:21504
    s_waitcnt lgkmcnt(6)
    v_mfma_f32_32x32x16_bf16 v[112:127], v[48:51], v[208:211], v[112:127]
    ds_read_b64_tr_b16 v[40:41], v15 offset:20480
    ds_read_b64_tr_b16 v[42:43], v15 offset:21504
    s_waitcnt lgkmcnt(6)
    v_mfma_f32_32x32x16_bf16 v[128:143], v[52:55], v[208:211], v[128:143]
    ds_read_b64_tr_b16 v[44:45], v18 offset:20480
    ds_read_b64_tr_b16 v[46:47], v18 offset:21504
    s_waitcnt lgkmcnt(6)
    v_mfma_f32_32x32x16_bf16 v[80:95], v[56:59], v[212:215], v[80:95]
    ds_read_b64_tr_b16 v[48:49], v5 offset:24576
    ds_read_b64_tr_b16 v[50:51], v5 offset:25600
    s_waitcnt lgkmcnt(6)
    v_mfma_f32_32x32x16_bf16 v[96:111], v[60:63], v[212:215], v[96:111]
    ds_read_b64_tr_b16 v[52:53], v12 offset:24576
    ds_read_b64_tr_b16 v[54:55], v12 offset:25600
    s_waitcnt lgkmcnt(6)
    v_mfma_f32_32x32x16_bf16 v[112:127], v[40:43], v[212:215], v[112:127]
    ds_read_b64_tr_b16 v[56:57], v15 offset:24576
    ds_read_b64_tr_b16 v[58:59], v15 offset:25600
    s_waitcnt lgkmcnt(6)
    v_mfma_f32_32x32x16_bf16 v[128:143], v[44:47], v[212:215], v[128:143]
    ds_read_b64_tr_b16 v[60:61], v18 offset:24576
    ds_read_b64_tr_b16 v[62:63], v18 offset:25600
    s_waitcnt lgkmcnt(6)
    v_mfma_f32_32x32x16_bf16 v[80:95], v[48:51], v[216:219], v[80:95]
    ds_read_b64_tr_b16 v[40:41], v5 offset:28672
    ds_read_b64_tr_b16 v[42:43], v5 offset:29696
    s_waitcnt lgkmcnt(6)
    v_mfma_f32_32x32x16_bf16 v[96:111], v[52:55], v[216:219], v[96:111]
    ds_read_b64_tr_b16 v[44:45], v12 offset:28672
    ds_read_b64_tr_b16 v[46:47], v12 offset:29696
    s_waitcnt lgkmcnt(6)
    v_mfma_f32_32x32x16_bf16 v[112:127], v[56:59], v[216:219], v[112:127]
    ds_read_b64_tr_b16 v[48:49], v15 offset:28672
    ds_read_b64_tr_b16 v[50:51], v15 offset:29696
    s_waitcnt lgkmcnt(6)
    v_mfma_f32_32x32x16_bf16 v[128:143], v[60:63], v[216:219], v[128:143]
    ds_read_b64_tr_b16 v[52:53], v18 offset:28672
    ds_read_b64_tr_b16 v[54:55], v18 offset:29696
    s_waitcnt lgkmcnt(6)
    v_mfma_f32_32x32x16_bf16 v[80:95], v[40:43], v[220:223], v[80:95]
    ds_read_b64_tr_b16 v[56:57], v6 offset:24576
    ds_read_b64_tr_b16 v[58:59], v6 offset:25600
    s_waitcnt lgkmcnt(6)
    v_mfma_f32_32x32x16_bf16 v[96:111], v[44:47], v[220:223], v[96:111]
    ds_read_b64_tr_b16 v[60:61], v13 offset:24576
    ds_read_b64_tr_b16 v[62:63], v13 offset:25600
    s_waitcnt lgkmcnt(6)
    v_mfma_f32_32x32x16_bf16 v[112:127], v[48:51], v[220:223], v[112:127]
    ds_read_b64_tr_b16 v[40:41], v16 offset:24576
    ds_read_b64_tr_b16 v[42:43], v16 offset:25600
    s_waitcnt lgkmcnt(6)
    v_mfma_f32_32x32x16_bf16 v[128:143], v[52:55], v[220:223], v[128:143]
    ds_read_b64_tr_b16 v[44:45], v19 offset:24576
    ds_read_b64_tr_b16 v[46:47], v19 offset:25600
    s_waitcnt lgkmcnt(6)
    v_mfma_f32_32x32x16_bf16 v[80:95], v[56:59], v[224:227], v[80:95]
    ds_read_b64_tr_b16 v[48:49], v6 offset:28672
    ds_read_b64_tr_b16 v[50:51], v6 offset:29696
    s_waitcnt lgkmcnt(6)
    v_mfma_f32_32x32x16_bf16 v[96:111], v[60:63], v[224:227], v[96:111]
    ds_read_b64_tr_b16 v[52:53], v13 offset:28672
    ds_read_b64_tr_b16 v[54:55], v13 offset:29696
    s_waitcnt lgkmcnt(6)
    v_mfma_f32_32x32x16_bf16 v[112:127], v[40:43], v[224:227], v[112:127]
    ds_read_b64_tr_b16 v[56:57], v16 offset:28672
    ds_read_b64_tr_b16 v[58:59], v16 offset:29696
    s_waitcnt lgkmcnt(6)
    v_mfma_f32_32x32x16_bf16 v[128:143], v[44:47], v[224:227], v[128:143]
    ds_read_b64_tr_b16 v[60:61], v19 offset:28672
    ds_read_b64_tr_b16 v[62:63], v19 offset:29696
    s_waitcnt lgkmcnt(6)
    v_mfma_f32_32x32x16_bf16 v[80:95], v[48:51], v[228:231], v[80:95]
    ds_read_b64_tr_b16 v[40:41], v6 offset:49152
    ds_read_b64_tr_b16 v[42:43], v6 offset:50176
    s_waitcnt lgkmcnt(6)
    v_mfma_f32_32x32x16_bf16 v[96:111], v[52:55], v[228:231], v[96:111]
    ds_read_b64_tr_b16 v[44:45], v13 offset:49152
    ds_read_b64_tr_b16 v[46:47], v13 offset:50176
    s_waitcnt lgkmcnt(6)
    v_mfma_f32_32x32x16_bf16 v[112:127], v[56:59], v[228:231], v[112:127]
    ds_read_b64_tr_b16 v[48:49], v16 offset:49152
    ds_read_b64_tr_b16 v[50:51], v16 offset:50176
    s_waitcnt lgkmcnt(6)
    v_mfma_f32_32x32x16_bf16 v[128:143], v[60:63], v[228:231], v[128:143]
    ds_read_b64_tr_b16 v[52:53], v19 offset:49152
    ds_read_b64_tr_b16 v[54:55], v19 offset:50176
    s_waitcnt lgkmcnt(6)
    v_mfma_f32_32x32x16_bf16 v[80:95], v[40:43], v[232:235], v[80:95]
    ds_read_b64_tr_b16 v[56:57], v6 offset:53248
    ds_read_b64_tr_b16 v[58:59], v6 offset:54272
    s_waitcnt lgkmcnt(6)
    v_mfma_f32_32x32x16_bf16 v[96:111], v[44:47], v[232:235], v[96:111]
    ds_read_b64_tr_b16 v[60:61], v13 offset:53248
    ds_read_b64_tr_b16 v[62:63], v13 offset:54272
    s_waitcnt lgkmcnt(6)
    v_mfma_f32_32x32x16_bf16 v[112:127], v[48:51], v[232:235], v[112:127]
    ds_read_b64_tr_b16 v[40:41], v16 offset:53248
    ds_read_b64_tr_b16 v[42:43], v16 offset:54272
    s_waitcnt lgkmcnt(6)
    v_mfma_f32_32x32x16_bf16 v[128:143], v[52:55], v[232:235], v[128:143]
    ds_read_b64_tr_b16 v[44:45], v19 offset:53248
    ds_read_b64_tr_b16 v[46:47], v19 offset:54272
    s_waitcnt lgkmcnt(6)
    v_mfma_f32_32x32x16_bf16 v[80:95], v[56:59], v[236:239], v[80:95]
    ds_read_b64_tr_b16 v[48:49], v5 offset:0
    ds_read_b64_tr_b16 v[50:51], v5 offset:1024
    s_waitcnt lgkmcnt(6)
    v_mfma_f32_32x32x16_bf16 v[96:111], v[60:63], v[236:239], v[96:111]
    ds_read_b64_tr_b16 v[52:53], v12 offset:0
    ds_read_b64_tr_b16 v[54:55], v12 offset:1024
    s_waitcnt lgkmcnt(6)
    v_mfma_f32_32x32x16_bf16 v[112:127], v[40:43], v[236:239], v[112:127]
    ds_read_b64_tr_b16 v[56:57], v15 offset:0
    ds_read_b64_tr_b16 v[58:59], v15 offset:1024
    s_waitcnt lgkmcnt(6)
    v_mfma_f32_32x32x16_bf16 v[128:143], v[44:47], v[236:239], v[128:143]
    ds_read_b64_tr_b16 v[60:61], v18 offset:0
    ds_read_b64_tr_b16 v[62:63], v18 offset:1024
    s_waitcnt lgkmcnt(6)
    v_mfma_f32_32x32x16_bf16 v[80:95], v[48:51], v[240:243], v[80:95]
    ds_read_b64_tr_b16 v[40:41], v5 offset:4096
    ds_read_b64_tr_b16 v[42:43], v5 offset:5120
    s_waitcnt lgkmcnt(6)
    v_mfma_f32_32x32x16_bf16 v[96:111], v[52:55], v[240:243], v[96:111]
    ds_read_b64_tr_b16 v[44:45], v12 offset:4096
    ds_read_b64_tr_b16 v[46:47], v12 offset:5120
    s_waitcnt lgkmcnt(6)
    v_mfma_f32_32x32x16_bf16 v[112:127], v[56:59], v[240:243], v[112:127]
    ds_read_b64_tr_b16 v[48:49], v15 offset:4096
    ds_read_b64_tr_b16 v[50:51], v15 offset:5120
    s_waitcnt lgkmcnt(6)
    v_mfma_f32_32x32x16_bf16 v[128:143], v[60:63], v[240:243], v[128:143]
    ds_read_b64_tr_b16 v[52:53], v18 offset:4096
    ds_read_b64_tr_b16 v[54:55], v18 offset:5120
    s_waitcnt lgkmcnt(6)
    v_mfma_f32_32x32x16_bf16 v[80:95], v[40:43], v[244:247], v[80:95]
    ds_read_b64_tr_b16 v[56:57], v5 offset:32768
    ds_read_b64_tr_b16 v[58:59], v5 offset:33792
    s_waitcnt lgkmcnt(6)
    v_mfma_f32_32x32x16_bf16 v[96:111], v[44:47], v[244:247], v[96:111]
    ds_read_b64_tr_b16 v[60:61], v12 offset:32768
    ds_read_b64_tr_b16 v[62:63], v12 offset:33792
    s_waitcnt lgkmcnt(6)
    v_mfma_f32_32x32x16_bf16 v[112:127], v[48:51], v[244:247], v[112:127]
    ds_read_b64_tr_b16 v[40:41], v15 offset:32768
    ds_read_b64_tr_b16 v[42:43], v15 offset:33792
    s_waitcnt lgkmcnt(6)
    v_mfma_f32_32x32x16_bf16 v[128:143], v[52:55], v[244:247], v[128:143]
    ds_read_b64_tr_b16 v[44:45], v18 offset:32768
    ds_read_b64_tr_b16 v[46:47], v18 offset:33792
    s_waitcnt lgkmcnt(6)
    v_mfma_f32_32x32x16_bf16 v[80:95], v[56:59], v[248:251], v[80:95]
    ds_read_b64_tr_b16 v[48:49], v5 offset:36864
    ds_read_b64_tr_b16 v[50:51], v5 offset:37888
    s_waitcnt lgkmcnt(6)
    v_mfma_f32_32x32x16_bf16 v[96:111], v[60:63], v[248:251], v[96:111]
    ds_read_b64_tr_b16 v[52:53], v12 offset:36864
    ds_read_b64_tr_b16 v[54:55], v12 offset:37888
    s_waitcnt lgkmcnt(6)
    v_mfma_f32_32x32x16_bf16 v[112:127], v[40:43], v[248:251], v[112:127]
    ds_read_b64_tr_b16 v[56:57], v15 offset:36864
    ds_read_b64_tr_b16 v[58:59], v15 offset:37888
    s_waitcnt lgkmcnt(6)
    v_mfma_f32_32x32x16_bf16 v[128:143], v[44:47], v[248:251], v[128:143]
    ds_read_b64_tr_b16 v[60:61], v18 offset:36864
    ds_read_b64_tr_b16 v[62:63], v18 offset:37888
    s_waitcnt lgkmcnt(6)
    v_mfma_f32_32x32x16_bf16 v[80:95], v[48:51], v[252:255], v[80:95]
    s_waitcnt lgkmcnt(4)
    v_mfma_f32_32x32x16_bf16 v[96:111], v[52:55], v[252:255], v[96:111]
    s_waitcnt lgkmcnt(2)
    v_mfma_f32_32x32x16_bf16 v[112:127], v[56:59], v[252:255], v[112:127]
    s_waitcnt lgkmcnt(0)
    v_mfma_f32_32x32x16_bf16 v[128:143], v[60:63], v[252:255], v[128:143]
    s_setprio 0
    ds_read_b64_tr_b16 v[20:21], v39 offset:6272
    ds_read_b64_tr_b16 v[22:23], v39 offset:6720
    ds_read_b64_tr_b16 v[24:25], v39 offset:7168
    ds_read_b64_tr_b16 v[26:27], v39 offset:7616
    s_nop 0
    v_cvt_pk_bf16_f32 v18, v92, v93
    v_cvt_pk_bf16_f32 v19, v94, v95
    v_cvt_pk_bf16_f32 v12, v80, v81
    v_cvt_pk_bf16_f32 v13, v82, v83
    v_cvt_pk_bf16_f32 v14, v84, v85
    v_cvt_pk_bf16_f32 v15, v86, v87
    v_cvt_pk_bf16_f32 v16, v88, v89
    v_cvt_pk_bf16_f32 v17, v90, v91
    v_cndmask_b32 v18, v18, 0, s[84:85]
    v_cndmask_b32 v19, v19, 0, s[84:85]
    s_waitcnt lgkmcnt(0)
    v_mfma_f32_32x32x16_bf16 v[80:95], v[20:23], v[12:15], 0
    v_mfma_f32_32x32x16_bf16 v[80:95], v[24:27], v[16:19], v[80:95]
    s_nop 11
    v_cndmask_b32 v92, v92, v94, s[84:85]
    v_cndmask_b32 v93, v93, v95, s[84:85]
    v_max3_f32 v28, v80, v81, v82
    v_min3_f32 v29, v80, v81, v82
    v_max3_f32 v30, v83, v84, v85
    v_min3_f32 v31, v83, v84, v85
    v_max3_f32 v28, v28, v86, v87
    v_min3_f32 v29, v29, v86, v87
    v_max3_f32 v30, v30, v88, v89
    v_min3_f32 v31, v31, v88, v89
    v_max3_f32 v28, v28, v90, v91
    v_min3_f32 v29, v29, v90, v91
    v_max3_f32 v30, v30, v92, v93
    v_min3_f32 v31, v31, v92, v93
    v_max_f32 v28, v28, v30
    v_min_f32 v29, v29, v31
    v_mul_f32 v28, s82, v28
    v_mul_f32 v29, 0xbfb8aa3b, v29
    s_nop 1
    v_permlane32_swap_b32 v28, v29
    v_max_f32 v28, v28, v29
    v_mov_b32 v29, v28
    s_nop 1
    v_permlane32_swap_b32 v28, v29
    v_pk_fma_f32 v[12:13], v[80:81], s[82:83], v[28:29] op_sel_hi:[1,0,0] neg_lo:[0,0,1] neg_hi:[0,0,1]
    v_pk_fma_f32 v[80:81], v[80:81], s[82:83], v[28:29] op_sel:[0,0,1] op_sel_hi:[1,0,1] neg_lo:[1,0,1] neg_hi:[1,0,1]
    v_exp_f32 v12, v12
    v_pk_fma_f32 v[14:15], v[82:83], s[82:83], v[28:29] op_sel_hi:[1,0,0] neg_lo:[0,0,1] neg_hi:[0,0,1]
    v_exp_f32 v13, v13
    v_pk_fma_f32 v[82:83], v[82:83], s[82:83], v[28:29] op_sel:[0,0,1] op_sel_hi:[1,0,1] neg_lo:[1,0,1] neg_hi:[1,0,1]
    v_exp_f32 v80, v80
    v_exp_f32 v81, v81
    v_exp_f32 v14, v14
    v_pk_fma_f32 v[16:17], v[84:85], s[82:83], v[28:29] op_sel_hi:[1,0,0] neg_lo:[0,0,1] neg_hi:[0,0,1]
    v_exp_f32 v15, v15
    v_pk_fma_f32 v[84:85], v[84:85], s[82:83], v[28:29] op_sel:[0,0,1] op_sel_hi:[1,0,1] neg_lo:[1,0,1] neg_hi:[1,0,1]
    v_exp_f32 v82, v82
    v_cvt_pk_bf16_f32 v80, v80, v81
    v_exp_f32 v83, v83
    v_exp_f32 v16, v16
    v_pk_fma_f32 v[18:19], v[86:87], s[82:83], v[28:29] op_sel_hi:[1,0,0] neg_lo:[0,0,1] neg_hi:[0,0,1]
    v_exp_f32 v17, v17
    v_pk_fma_f32 v[86:87], v[86:87], s[82:83], v[28:29] op_sel:[0,0,1] op_sel_hi:[1,0,1] neg_lo:[1,0,1] neg_hi:[1,0,1]
    v_exp_f32 v84, v84
    v_cvt_pk_bf16_f32 v81, v82, v83
    v_exp_f32 v85, v85
    v_exp_f32 v18, v18
    v_pk_fma_f32 v[20:21], v[88:89], s[82:83], v[28:29] op_sel_hi:[1,0,0] neg_lo:[0,0,1] neg_hi:[0,0,1]
    v_exp_f32 v19, v19
    v_pk_fma_f32 v[88:89], v[88:89], s[82:83], v[28:29] op_sel:[0,0,1] op_sel_hi:[1,0,1] neg_lo:[1,0,1] neg_hi:[1,0,1]
    v_exp_f32 v86, v86
    v_cvt_pk_bf16_f32 v82, v84, v85
    v_exp_f32 v87, v87
    v_exp_f32 v20, v20
    v_pk_fma_f32 v[22:23], v[90:91], s[82:83], v[28:29] op_sel_hi:[1,0,0] neg_lo:[0,0,1] neg_hi:[0,0,1]
    v_exp_f32 v21, v21
    v_pk_fma_f32 v[90:91], v[90:91], s[82:83], v[28:29] op_sel:[0,0,1] op_sel_hi:[1,0,1] neg_lo:[1,0,1] neg_hi:[1,0,1]
    v_exp_f32 v88, v88
    v_cvt_pk_bf16_f32 v83, v86, v87
    v_exp_f32 v89, v89
    v_exp_f32 v22, v22
    v_pk_fma_f32 v[24:25], v[92:93], s[82:83], v[28:29] op_sel_hi:[1,0,0] neg_lo:[0,0,1] neg_hi:[0,0,1]
    v_exp_f32 v23, v23
    v_pk_fma_f32 v[92:93], v[92:93], s[82:83], v[28:29] op_sel:[0,0,1] op_sel_hi:[1,0,1] neg_lo:[1,0,1] neg_hi:[1,0,1]
    v_exp_f32 v90, v90
    v_cvt_pk_bf16_f32 v84, v88, v89
    v_exp_f32 v91, v91
    v_exp_f32 v24, v24
    v_cvt_pk_bf16_f32 v85, v90, v91
    v_exp_f32 v25, v25
    v_exp_f32 v92, v92
    v_exp_f32 v93, v93
    v_cvt_pk_bf16_f32 v88, v12, v13
    v_cvt_pk_bf16_f32 v89, v14, v15
    v_cvt_pk_bf16_f32 v90, v16, v17
    v_cvt_pk_bf16_f32 v91, v18, v19
    v_cvt_pk_bf16_f32 v86, v92, v93
    v_cvt_pk_bf16_f32 v92, v20, v21
    v_cvt_pk_bf16_f32 v93, v22, v23
    v_cvt_pk_bf16_f32 v94, v24, v25
    v_mov_b32 v87, 0
    v_mov_b32 v95, 0
    ds_read_b64_tr_b16 v[20:21], v39 offset:7840
    ds_read_b64_tr_b16 v[22:23], v39 offset:8288
    ds_read_b64_tr_b16 v[24:25], v39 offset:8736
    ds_read_b64_tr_b16 v[26:27], v39 offset:9184
    v_cvt_pk_bf16_f32 v18, v108, v109
    v_cvt_pk_bf16_f32 v19, v110, v111
    v_cvt_pk_bf16_f32 v12, v96, v97
    v_cvt_pk_bf16_f32 v13, v98, v99
    v_cvt_pk_bf16_f32 v14, v100, v101
    v_cvt_pk_bf16_f32 v15, v102, v103
    v_cvt_pk_bf16_f32 v16, v104, v105
    v_cvt_pk_bf16_f32 v17, v106, v107
    v_cndmask_b32 v18, v18, 0, s[84:85]
    v_cndmask_b32 v19, v19, 0, s[84:85]
    s_waitcnt lgkmcnt(0)
    v_mfma_f32_32x32x16_bf16 v[96:111], v[20:23], v[12:15], 0
    v_mfma_f32_32x32x16_bf16 v[96:111], v[24:27], v[16:19], v[96:111]
    s_nop 11
    v_cndmask_b32 v108, v108, v110, s[84:85]
    v_cndmask_b32 v109, v109, v111, s[84:85]
    v_max3_f32 v28, v96, v97, v98
    v_min3_f32 v29, v96, v97, v98
    v_max3_f32 v30, v99, v100, v101
    v_min3_f32 v31, v99, v100, v101
    v_max3_f32 v28, v28, v102, v103
    v_min3_f32 v29, v29, v102, v103
    v_max3_f32 v30, v30, v104, v105
    v_min3_f32 v31, v31, v104, v105
    v_max3_f32 v28, v28, v106, v107
    v_min3_f32 v29, v29, v106, v107
    v_max3_f32 v30, v30, v108, v109
    v_min3_f32 v31, v31, v108, v109
    v_max_f32 v28, v28, v30
    v_min_f32 v29, v29, v31
    v_mul_f32 v28, s82, v28
    v_mul_f32 v29, 0xbfb8aa3b, v29
    s_nop 1
    v_permlane32_swap_b32 v28, v29
    v_max_f32 v28, v28, v29
    v_mov_b32 v29, v28
    s_nop 1
    v_permlane32_swap_b32 v28, v29
    v_pk_fma_f32 v[12:13], v[96:97], s[82:83], v[28:29] op_sel_hi:[1,0,0] neg_lo:[0,0,1] neg_hi:[0,0,1]
    v_pk_fma_f32 v[96:97], v[96:97], s[82:83], v[28:29] op_sel:[0,0,1] op_sel_hi:[1,0,1] neg_lo:[1,0,1] neg_hi:[1,0,1]
    v_exp_f32 v12, v12
    v_pk_fma_f32 v[14:15], v[98:99], s[82:83], v[28:29] op_sel_hi:[1,0,0] neg_lo:[0,0,1] neg_hi:[0,0,1]
    v_exp_f32 v13, v13
    v_pk_fma_f32 v[98:99], v[98:99], s[82:83], v[28:29] op_sel:[0,0,1] op_sel_hi:[1,0,1] neg_lo:[1,0,1] neg_hi:[1,0,1]
    v_exp_f32 v96, v96
    v_exp_f32 v97, v97
    v_exp_f32 v14, v14
    v_pk_fma_f32 v[16:17], v[100:101], s[82:83], v[28:29] op_sel_hi:[1,0,0] neg_lo:[0,0,1] neg_hi:[0,0,1]
    v_exp_f32 v15, v15
    v_pk_fma_f32 v[100:101], v[100:101], s[82:83], v[28:29] op_sel:[0,0,1] op_sel_hi:[1,0,1] neg_lo:[1,0,1] neg_hi:[1,0,1]
    v_exp_f32 v98, v98
    v_cvt_pk_bf16_f32 v96, v96, v97
    v_exp_f32 v99, v99
    v_exp_f32 v16, v16
    v_pk_fma_f32 v[18:19], v[102:103], s[82:83], v[28:29] op_sel_hi:[1,0,0] neg_lo:[0,0,1] neg_hi:[0,0,1]
    v_exp_f32 v17, v17
    v_pk_fma_f32 v[102:103], v[102:103], s[82:83], v[28:29] op_sel:[0,0,1] op_sel_hi:[1,0,1] neg_lo:[1,0,1] neg_hi:[1,0,1]
    v_exp_f32 v100, v100
    v_cvt_pk_bf16_f32 v97, v98, v99
    v_exp_f32 v101, v101
    v_exp_f32 v18, v18
    v_pk_fma_f32 v[20:21], v[104:105], s[82:83], v[28:29] op_sel_hi:[1,0,0] neg_lo:[0,0,1] neg_hi:[0,0,1]
    v_exp_f32 v19, v19
    v_pk_fma_f32 v[104:105], v[104:105], s[82:83], v[28:29] op_sel:[0,0,1] op_sel_hi:[1,0,1] neg_lo:[1,0,1] neg_hi:[1,0,1]
    v_exp_f32 v102, v102
    v_cvt_pk_bf16_f32 v98, v100, v101
    v_exp_f32 v103, v103
    v_exp_f32 v20, v20
    v_pk_fma_f32 v[22:23], v[106:107], s[82:83], v[28:29] op_sel_hi:[1,0,0] neg_lo:[0,0,1] neg_hi:[0,0,1]
    v_exp_f32 v21, v21
    v_pk_fma_f32 v[106:107], v[106:107], s[82:83], v[28:29] op_sel:[0,0,1] op_sel_hi:[1,0,1] neg_lo:[1,0,1] neg_hi:[1,0,1]
    v_exp_f32 v104, v104
    v_cvt_pk_bf16_f32 v99, v102, v103
    v_exp_f32 v105, v105
    v_exp_f32 v22, v22
    v_pk_fma_f32 v[24:25], v[108:109], s[82:83], v[28:29] op_sel_hi:[1,0,0] neg_lo:[0,0,1] neg_hi:[0,0,1]
    v_exp_f32 v23, v23
    v_pk_fma_f32 v[108:109], v[108:109], s[82:83], v[28:29] op_sel:[0,0,1] op_sel_hi:[1,0,1] neg_lo:[1,0,1] neg_hi:[1,0,1]
    v_exp_f32 v106, v106
    v_cvt_pk_bf16_f32 v100, v104, v105
    v_exp_f32 v107, v107
    v_exp_f32 v24, v24
    v_cvt_pk_bf16_f32 v101, v106, v107
    v_exp_f32 v25, v25
    v_exp_f32 v108, v108
    v_exp_f32 v109, v109
    v_cvt_pk_bf16_f32 v104, v12, v13
    v_cvt_pk_bf16_f32 v105, v14, v15
    v_cvt_pk_bf16_f32 v106, v16, v17
    v_cvt_pk_bf16_f32 v107, v18, v19
    v_cvt_pk_bf16_f32 v102, v108, v109
    v_cvt_pk_bf16_f32 v108, v20, v21
    v_cvt_pk_bf16_f32 v109, v22, v23
    v_cvt_pk_bf16_f32 v110, v24, v25
    v_mov_b32 v103, 0
    v_mov_b32 v111, 0
    ds_read_b64_tr_b16 v[20:21], v39 offset:9408
    ds_read_b64_tr_b16 v[22:23], v39 offset:9856
    ds_read_b64_tr_b16 v[24:25], v39 offset:10304
    ds_read_b64_tr_b16 v[26:27], v39 offset:10752
    v_cvt_pk_bf16_f32 v18, v124, v125
    v_cvt_pk_bf16_f32 v19, v126, v127
    v_cvt_pk_bf16_f32 v12, v112, v113
    v_cvt_pk_bf16_f32 v13, v114, v115
    v_cvt_pk_bf16_f32 v14, v116, v117
    v_cvt_pk_bf16_f32 v15, v118, v119
    v_cvt_pk_bf16_f32 v16, v120, v121
    v_cvt_pk_bf16_f32 v17, v122, v123
    v_cndmask_b32 v18, v18, 0, s[84:85]
    v_cndmask_b32 v19, v19, 0, s[84:85]
    s_waitcnt lgkmcnt(0)
    v_mfma_f32_32x32x16_bf16 v[112:127], v[20:23], v[12:15], 0
    v_mfma_f32_32x32x16_bf16 v[112:127], v[24:27], v[16:19], v[112:127]
    s_nop 11
    v_cndmask_b32 v124, v124, v126, s[84:85]
    v_cndmask_b32 v125, v125, v127, s[84:85]
    v_max3_f32 v28, v112, v113, v114
    v_min3_f32 v29, v112, v113, v114
    v_max3_f32 v30, v115, v116, v117
    v_min3_f32 v31, v115, v116, v117
    v_max3_f32 v28, v28, v118, v119
    v_min3_f32 v29, v29, v118, v119
    v_max3_f32 v30, v30, v120, v121
    v_min3_f32 v31, v31, v120, v121
    v_max3_f32 v28, v28, v122, v123
    v_min3_f32 v29, v29, v122, v123
    v_max3_f32 v30, v30, v124, v125
    v_min3_f32 v31, v31, v124, v125
    v_max_f32 v28, v28, v30
    v_min_f32 v29, v29, v31
    v_mul_f32 v28, s82, v28
    v_mul_f32 v29, 0xbfb8aa3b, v29
    s_nop 1
    v_permlane32_swap_b32 v28, v29
    v_max_f32 v28, v28, v29
    v_mov_b32 v29, v28
    s_nop 1
    v_permlane32_swap_b32 v28, v29
    v_pk_fma_f32 v[12:13], v[112:113], s[82:83], v[28:29] op_sel_hi:[1,0,0] neg_lo:[0,0,1] neg_hi:[0,0,1]
    v_pk_fma_f32 v[112:113], v[112:113], s[82:83], v[28:29] op_sel:[0,0,1] op_sel_hi:[1,0,1] neg_lo:[1,0,1] neg_hi:[1,0,1]
    v_exp_f32 v12, v12
    v_pk_fma_f32 v[14:15], v[114:115], s[82:83], v[28:29] op_sel_hi:[1,0,0] neg_lo:[0,0,1] neg_hi:[0,0,1]
    v_exp_f32 v13, v13
    v_pk_fma_f32 v[114:115], v[114:115], s[82:83], v[28:29] op_sel:[0,0,1] op_sel_hi:[1,0,1] neg_lo:[1,0,1] neg_hi:[1,0,1]
    v_exp_f32 v112, v112
    v_exp_f32 v113, v113
    v_exp_f32 v14, v14
    v_pk_fma_f32 v[16:17], v[116:117], s[82:83], v[28:29] op_sel_hi:[1,0,0] neg_lo:[0,0,1] neg_hi:[0,0,1]
    v_exp_f32 v15, v15
    v_pk_fma_f32 v[116:117], v[116:117], s[82:83], v[28:29] op_sel:[0,0,1] op_sel_hi:[1,0,1] neg_lo:[1,0,1] neg_hi:[1,0,1]
    v_exp_f32 v114, v114
    v_cvt_pk_bf16_f32 v112, v112, v113
    v_exp_f32 v115, v115
    v_exp_f32 v16, v16
    v_pk_fma_f32 v[18:19], v[118:119], s[82:83], v[28:29] op_sel_hi:[1,0,0] neg_lo:[0,0,1] neg_hi:[0,0,1]
    v_exp_f32 v17, v17
    v_pk_fma_f32 v[118:119], v[118:119], s[82:83], v[28:29] op_sel:[0,0,1] op_sel_hi:[1,0,1] neg_lo:[1,0,1] neg_hi:[1,0,1]
    v_exp_f32 v116, v116
    v_cvt_pk_bf16_f32 v113, v114, v115
    v_exp_f32 v117, v117
    v_exp_f32 v18, v18
    v_pk_fma_f32 v[20:21], v[120:121], s[82:83], v[28:29] op_sel_hi:[1,0,0] neg_lo:[0,0,1] neg_hi:[0,0,1]
    v_exp_f32 v19, v19
    v_pk_fma_f32 v[120:121], v[120:121], s[82:83], v[28:29] op_sel:[0,0,1] op_sel_hi:[1,0,1] neg_lo:[1,0,1] neg_hi:[1,0,1]
    v_exp_f32 v118, v118
    v_cvt_pk_bf16_f32 v114, v116, v117
    v_exp_f32 v119, v119
    v_exp_f32 v20, v20
    v_pk_fma_f32 v[22:23], v[122:123], s[82:83], v[28:29] op_sel_hi:[1,0,0] neg_lo:[0,0,1] neg_hi:[0,0,1]
    v_exp_f32 v21, v21
    v_pk_fma_f32 v[122:123], v[122:123], s[82:83], v[28:29] op_sel:[0,0,1] op_sel_hi:[1,0,1] neg_lo:[1,0,1] neg_hi:[1,0,1]
    v_exp_f32 v120, v120
    v_cvt_pk_bf16_f32 v115, v118, v119
    v_exp_f32 v121, v121
    v_exp_f32 v22, v22
    v_pk_fma_f32 v[24:25], v[124:125], s[82:83], v[28:29] op_sel_hi:[1,0,0] neg_lo:[0,0,1] neg_hi:[0,0,1]
    v_exp_f32 v23, v23
    v_pk_fma_f32 v[124:125], v[124:125], s[82:83], v[28:29] op_sel:[0,0,1] op_sel_hi:[1,0,1] neg_lo:[1,0,1] neg_hi:[1,0,1]
    v_exp_f32 v122, v122
    v_cvt_pk_bf16_f32 v116, v120, v121
    v_exp_f32 v123, v123
    v_exp_f32 v24, v24
    v_cvt_pk_bf16_f32 v117, v122, v123
    v_exp_f32 v25, v25
    v_exp_f32 v124, v124
    v_exp_f32 v125, v125
    v_cvt_pk_bf16_f32 v120, v12, v13
    v_cvt_pk_bf16_f32 v121, v14, v15
    v_cvt_pk_bf16_f32 v122, v16, v17
    v_cvt_pk_bf16_f32 v123, v18, v19
    v_cvt_pk_bf16_f32 v118, v124, v125
    v_cvt_pk_bf16_f32 v124, v20, v21
    v_cvt_pk_bf16_f32 v125, v22, v23
    v_cvt_pk_bf16_f32 v126, v24, v25
    v_mov_b32 v119, 0
    v_mov_b32 v127, 0
    ds_read_b64_tr_b16 v[20:21], v39 offset:10976
    ds_read_b64_tr_b16 v[22:23], v39 offset:11424
    ds_read_b64_tr_b16 v[24:25], v39 offset:11872
    ds_read_b64_tr_b16 v[26:27], v39 offset:12320
    v_cvt_pk_bf16_f32 v18, v140, v141
    v_cvt_pk_bf16_f32 v19, v142, v143
    v_cvt_pk_bf16_f32 v12, v128, v129
    v_cvt_pk_bf16_f32 v13, v130, v131
    v_cvt_pk_bf16_f32 v14, v132, v133
    v_cvt_pk_bf16_f32 v15, v134, v135
    v_cvt_pk_bf16_f32 v16, v136, v137
    v_cvt_pk_bf16_f32 v17, v138, v139
    v_cndmask_b32 v18, v18, 0, s[84:85]
    v_cndmask_b32 v19, v19, 0, s[84:85]
    s_waitcnt lgkmcnt(0)
    v_mfma_f32_32x32x16_bf16 v[128:143], v[20:23], v[12:15], 0
    v_mfma_f32_32x32x16_bf16 v[128:143], v[24:27], v[16:19], v[128:143]
    s_nop 11
    v_cndmask_b32 v140, v140, v142, s[84:85]
    v_cndmask_b32 v141, v141, v143, s[84:85]
    v_max3_f32 v28, v128, v129, v130
    v_min3_f32 v29, v128, v129, v130
    v_max3_f32 v30, v131, v132, v133
    v_min3_f32 v31, v131, v132, v133
    v_max3_f32 v28, v28, v134, v135
    v_min3_f32 v29, v29, v134, v135
    v_max3_f32 v30, v30, v136, v137
    v_min3_f32 v31, v31, v136, v137
    v_max3_f32 v28, v28, v138, v139
    v_min3_f32 v29, v29, v138, v139
    v_max3_f32 v30, v30, v140, v141
    v_min3_f32 v31, v31, v140, v141
    v_max_f32 v28, v28, v30
    v_min_f32 v29, v29, v31
    v_mul_f32 v28, s82, v28
    v_mul_f32 v29, 0xbfb8aa3b, v29
    s_nop 1
    v_permlane32_swap_b32 v28, v29
    v_max_f32 v28, v28, v29
    v_mov_b32 v29, v28
    s_nop 1
    v_permlane32_swap_b32 v28, v29
    v_pk_fma_f32 v[12:13], v[128:129], s[82:83], v[28:29] op_sel_hi:[1,0,0] neg_lo:[0,0,1] neg_hi:[0,0,1]
    v_pk_fma_f32 v[128:129], v[128:129], s[82:83], v[28:29] op_sel:[0,0,1] op_sel_hi:[1,0,1] neg_lo:[1,0,1] neg_hi:[1,0,1]
    v_exp_f32 v12, v12
    v_pk_fma_f32 v[14:15], v[130:131], s[82:83], v[28:29] op_sel_hi:[1,0,0] neg_lo:[0,0,1] neg_hi:[0,0,1]
    v_exp_f32 v13, v13
    v_pk_fma_f32 v[130:131], v[130:131], s[82:83], v[28:29] op_sel:[0,0,1] op_sel_hi:[1,0,1] neg_lo:[1,0,1] neg_hi:[1,0,1]
    v_exp_f32 v128, v128
    v_exp_f32 v129, v129
    v_exp_f32 v14, v14
    v_pk_fma_f32 v[16:17], v[132:133], s[82:83], v[28:29] op_sel_hi:[1,0,0] neg_lo:[0,0,1] neg_hi:[0,0,1]
    v_exp_f32 v15, v15
    v_pk_fma_f32 v[132:133], v[132:133], s[82:83], v[28:29] op_sel:[0,0,1] op_sel_hi:[1,0,1] neg_lo:[1,0,1] neg_hi:[1,0,1]
    v_exp_f32 v130, v130
    v_cvt_pk_bf16_f32 v128, v128, v129
    v_exp_f32 v131, v131
    v_exp_f32 v16, v16
    v_pk_fma_f32 v[18:19], v[134:135], s[82:83], v[28:29] op_sel_hi:[1,0,0] neg_lo:[0,0,1] neg_hi:[0,0,1]
    v_exp_f32 v17, v17
    v_pk_fma_f32 v[134:135], v[134:135], s[82:83], v[28:29] op_sel:[0,0,1] op_sel_hi:[1,0,1] neg_lo:[1,0,1] neg_hi:[1,0,1]
    v_exp_f32 v132, v132
    v_cvt_pk_bf16_f32 v129, v130, v131
    v_exp_f32 v133, v133
    v_exp_f32 v18, v18
    v_pk_fma_f32 v[20:21], v[136:137], s[82:83], v[28:29] op_sel_hi:[1,0,0] neg_lo:[0,0,1] neg_hi:[0,0,1]
    v_exp_f32 v19, v19
    v_pk_fma_f32 v[136:137], v[136:137], s[82:83], v[28:29] op_sel:[0,0,1] op_sel_hi:[1,0,1] neg_lo:[1,0,1] neg_hi:[1,0,1]
    v_exp_f32 v134, v134
    v_cvt_pk_bf16_f32 v130, v132, v133
    v_exp_f32 v135, v135
    v_exp_f32 v20, v20
    v_pk_fma_f32 v[22:23], v[138:139], s[82:83], v[28:29] op_sel_hi:[1,0,0] neg_lo:[0,0,1] neg_hi:[0,0,1]
    v_exp_f32 v21, v21
    v_pk_fma_f32 v[138:139], v[138:139], s[82:83], v[28:29] op_sel:[0,0,1] op_sel_hi:[1,0,1] neg_lo:[1,0,1] neg_hi:[1,0,1]
    v_exp_f32 v136, v136
    v_cvt_pk_bf16_f32 v131, v134, v135
    v_exp_f32 v137, v137
    v_exp_f32 v22, v22
    v_pk_fma_f32 v[24:25], v[140:141], s[82:83], v[28:29] op_sel_hi:[1,0,0] neg_lo:[0,0,1] neg_hi:[0,0,1]
    v_exp_f32 v23, v23
    v_pk_fma_f32 v[140:141], v[140:141], s[82:83], v[28:29] op_sel:[0,0,1] op_sel_hi:[1,0,1] neg_lo:[1,0,1] neg_hi:[1,0,1]
    v_exp_f32 v138, v138
    v_cvt_pk_bf16_f32 v132, v136, v137
    v_exp_f32 v139, v139
    v_exp_f32 v24, v24
    v_cvt_pk_bf16_f32 v133, v138, v139
    v_exp_f32 v25, v25
    v_exp_f32 v140, v140
    v_exp_f32 v141, v141
    v_cvt_pk_bf16_f32 v136, v12, v13
    v_cvt_pk_bf16_f32 v137, v14, v15
    v_cvt_pk_bf16_f32 v138, v16, v17
    v_cvt_pk_bf16_f32 v139, v18, v19
    v_cvt_pk_bf16_f32 v134, v140, v141
    v_cvt_pk_bf16_f32 v140, v20, v21
    v_cvt_pk_bf16_f32 v141, v22, v23
    v_cvt_pk_bf16_f32 v142, v24, v25
    v_mov_b32 v135, 0
    v_mov_b32 v143, 0
    s_barrier
    v_add_u32 v5, 49152, v0
    v_add_u32 v6, 57344, v0
    ds_read_b128 v[144:147], v5 offset:0
    ds_read_b128 v[148:151], v5 offset:1024
    ds_read_b128 v[152:155], v5 offset:2048
    ds_read_b128 v[156:159], v5 offset:3072
    ds_read_b128 v[160:163], v5 offset:4096
    ds_read_b128 v[164:167], v5 offset:5120
    ds_read_b128 v[168:171], v5 offset:6144
    ds_read_b128 v[172:175], v5 offset:7168
    ds_read_b128 v[176:179], v6 offset:0
    ds_read_b128 v[180:183], v6 offset:1024
    ds_read_b128 v[184:187], v6 offset:2048
    ds_read_b128 v[188:191], v6 offset:3072
    s_waitcnt lgkmcnt(11)
    v_mfma_f32_32x32x16_bf16 v[64:79], v[144:147], v[88:91], 0
    s_waitcnt lgkmcnt(9)
    v_mfma_f32_32x32x16_bf16 v[208:223], v[152:155], v[80:83], 0
    v_mfma_f32_32x32x16_bf16 v[64:79], v[148:151], v[92:95], v[64:79]
    s_waitcnt lgkmcnt(8)
    v_mfma_f32_32x32x16_bf16 v[208:223], v[156:159], v[84:87], v[208:223]
    ds_read_b128 v[192:195], v6 offset:4096
    ds_read_b128 v[196:199], v6 offset:5120
    ds_read_b128 v[200:203], v6 offset:6144
    ds_read_b128 v[204:207], v6 offset:7168
    s_waitcnt lgkmcnt(11)
    v_mfma_f32_32x32x16_bf16 v[224:239], v[160:163], v[104:107], 0
    s_waitcnt lgkmcnt(9)
    v_mfma_f32_32x32x16_bf16 v[240:255], v[168:171], v[96:99], 0
    v_mfma_f32_32x32x16_bf16 v[224:239], v[164:167], v[108:111], v[224:239]
    s_waitcnt lgkmcnt(8)
    v_mfma_f32_32x32x16_bf16 v[240:255], v[172:175], v[100:103], v[240:255]
    v_rcp_f32 v2, v77
    v_rcp_f32 v3, v221
    s_add_u32 s80, s40, 0
    v_fmaak_f32 v37, v76, v2, 0x358637bd
    v_fmac_f32 v37, v220, v3
    v_rcp_f32 v37, v37
    s_nop 0
    v_mul_f32 v37, v37, v32
    v_mul_f32 v2, v2, v37
    v_mul_f32 v3, v3, v37
    s_nop 1
    v_permlane32_swap_b32 v2, v3
    v_mov_b32 v2, v3
    s_nop 1
    v_permlane32_swap_b32 v2, v3
    v_pk_mul_f32 v[64:65], v[64:65], v[2:3] op_sel_hi:[1,0]
    v_pk_mul_f32 v[66:67], v[66:67], v[2:3] op_sel_hi:[1,0]
    v_pk_fma_f32 v[64:65], v[208:209], v[2:3], v[64:65] op_sel:[0,1,0] op_sel_hi:[1,1,1]
    v_pk_mul_f32 v[68:69], v[68:69], v[2:3] op_sel_hi:[1,0]
    v_pk_fma_f32 v[66:67], v[210:211], v[2:3], v[66:67] op_sel:[0,1,0] op_sel_hi:[1,1,1]
    v_cvt_pk_bf16_f32 v40, v64, v65
    v_pk_mul_f32 v[70:71], v[70:71], v[2:3] op_sel_hi:[1,0]
    v_pk_fma_f32 v[68:69], v[212:213], v[2:3], v[68:69] op_sel:[0,1,0] op_sel_hi:[1,1,1]
    v_cvt_pk_bf16_f32 v41, v66, v67
    v_pk_mul_f32 v[72:73], v[72:73], v[2:3] op_sel_hi:[1,0]
    v_pk_fma_f32 v[70:71], v[214:215], v[2:3], v[70:71] op_sel:[0,1,0] op_sel_hi:[1,1,1]
    v_cvt_pk_bf16_f32 v42, v68, v69
    v_pk_mul_f32 v[74:75], v[74:75], v[2:3] op_sel_hi:[1,0]
    v_pk_fma_f32 v[72:73], v[216:217], v[2:3], v[72:73] op_sel:[0,1,0] op_sel_hi:[1,1,1]
    v_cvt_pk_bf16_f32 v43, v70, v71
    buffer_store_dwordx4 v[40:43], v0, s[28:31], s80 offen sc1
    v_pk_mul_f32 v[76:77], v[76:77], v[2:3] op_sel_hi:[1,0]
    v_pk_fma_f32 v[74:75], v[218:219], v[2:3], v[74:75] op_sel:[0,1,0] op_sel_hi:[1,1,1]
    v_cvt_pk_bf16_f32 v44, v72, v73
    v_pk_mul_f32 v[78:79], v[78:79], v[2:3] op_sel_hi:[1,0]
    v_pk_fma_f32 v[76:77], v[220:221], v[2:3], v[76:77] op_sel:[0,1,0] op_sel_hi:[1,1,1]
    v_cvt_pk_bf16_f32 v45, v74, v75
    v_pk_fma_f32 v[78:79], v[222:223], v[2:3], v[78:79] op_sel:[0,1,0] op_sel_hi:[1,1,1]
    v_cvt_pk_bf16_f32 v46, v76, v77
    v_cvt_pk_bf16_f32 v47, v78, v79
    buffer_store_dwordx4 v[44:47], v0, s[28:31], s80 offen offset:1024 sc1
    s_waitcnt lgkmcnt(7)
    v_mfma_f32_32x32x16_bf16 v[64:79], v[176:179], v[120:123], 0
    s_waitcnt lgkmcnt(5)
    v_mfma_f32_32x32x16_bf16 v[208:223], v[184:187], v[112:115], 0
    v_mfma_f32_32x32x16_bf16 v[64:79], v[180:183], v[124:127], v[64:79]
    s_waitcnt lgkmcnt(4)
    v_mfma_f32_32x32x16_bf16 v[208:223], v[188:191], v[116:119], v[208:223]
    v_rcp_f32 v2, v237
    v_rcp_f32 v3, v253
    s_add_u32 s80, s40, 2048
    v_fmaak_f32 v37, v236, v2, 0x358637bd
    v_fmac_f32 v37, v252, v3
    v_rcp_f32 v37, v37
    s_nop 0
    v_mul_f32 v37, v37, v32
    v_mul_f32 v2, v2, v37
    v_mul_f32 v3, v3, v37
    s_nop 1
    v_permlane32_swap_b32 v2, v3
    v_mov_b32 v2, v3
    s_nop 1
    v_permlane32_swap_b32 v2, v3
    v_pk_mul_f32 v[224:225], v[224:225], v[2:3] op_sel_hi:[1,0]
    v_pk_mul_f32 v[226:227], v[226:227], v[2:3] op_sel_hi:[1,0]
    v_pk_fma_f32 v[224:225], v[240:241], v[2:3], v[224:225] op_sel:[0,1,0] op_sel_hi:[1,1,1]
    v_pk_mul_f32 v[228:229], v[228:229], v[2:3] op_sel_hi:[1,0]
    v_pk_fma_f32 v[226:227], v[242:243], v[2:3], v[226:227] op_sel:[0,1,0] op_sel_hi:[1,1,1]
    v_cvt_pk_bf16_f32 v48, v224, v225
    v_pk_mul_f32 v[230:231], v[230:231], v[2:3] op_sel_hi:[1,0]
    v_pk_fma_f32 v[228:229], v[244:245], v[2:3], v[228:229] op_sel:[0,1,0] op_sel_hi:[1,1,1]
    v_cvt_pk_bf16_f32 v49, v226, v227
    v_pk_mul_f32 v[232:233], v[232:233], v[2:3] op_sel_hi:[1,0]
    v_pk_fma_f32 v[230:231], v[246:247], v[2:3], v[230:231] op_sel:[0,1,0] op_sel_hi:[1,1,1]
    v_cvt_pk_bf16_f32 v50, v228, v229
    v_pk_mul_f32 v[234:235], v[234:235], v[2:3] op_sel_hi:[1,0]
    v_pk_fma_f32 v[232:233], v[248:249], v[2:3], v[232:233] op_sel:[0,1,0] op_sel_hi:[1,1,1]
    v_cvt_pk_bf16_f32 v51, v230, v231
    buffer_store_dwordx4 v[48:51], v0, s[28:31], s80 offen sc1
    v_pk_mul_f32 v[236:237], v[236:237], v[2:3] op_sel_hi:[1,0]
    v_pk_fma_f32 v[234:235], v[250:251], v[2:3], v[234:235] op_sel:[0,1,0] op_sel_hi:[1,1,1]
    v_cvt_pk_bf16_f32 v52, v232, v233
    v_pk_mul_f32 v[238:239], v[238:239], v[2:3] op_sel_hi:[1,0]
    v_pk_fma_f32 v[236:237], v[252:253], v[2:3], v[236:237] op_sel:[0,1,0] op_sel_hi:[1,1,1]
    v_cvt_pk_bf16_f32 v53, v234, v235
    v_pk_fma_f32 v[238:239], v[254:255], v[2:3], v[238:239] op_sel:[0,1,0] op_sel_hi:[1,1,1]
    v_cvt_pk_bf16_f32 v54, v236, v237
    v_cvt_pk_bf16_f32 v55, v238, v239
    buffer_store_dwordx4 v[52:55], v0, s[28:31], s80 offen offset:1024 sc1
    s_waitcnt lgkmcnt(3)
    v_mfma_f32_32x32x16_bf16 v[224:239], v[192:195], v[136:139], 0
    s_waitcnt lgkmcnt(1)
    v_mfma_f32_32x32x16_bf16 v[240:255], v[200:203], v[128:131], 0
    v_mfma_f32_32x32x16_bf16 v[224:239], v[196:199], v[140:143], v[224:239]
    s_waitcnt lgkmcnt(0)
    v_mfma_f32_32x32x16_bf16 v[240:255], v[204:207], v[132:135], v[240:255]
    v_rcp_f32 v2, v77
    v_rcp_f32 v3, v221
    s_add_u32 s80, s40, 50176
    v_fmaak_f32 v37, v76, v2, 0x358637bd
    v_fmac_f32 v37, v220, v3
    v_rcp_f32 v37, v37
    s_nop 0
    v_mul_f32 v37, v37, v32
    v_mul_f32 v2, v2, v37
    v_mul_f32 v3, v3, v37
    s_nop 1
    v_permlane32_swap_b32 v2, v3
    v_mov_b32 v2, v3
    s_nop 1
    v_permlane32_swap_b32 v2, v3
    v_pk_mul_f32 v[64:65], v[64:65], v[2:3] op_sel_hi:[1,0]
    v_pk_mul_f32 v[66:67], v[66:67], v[2:3] op_sel_hi:[1,0]
    v_pk_fma_f32 v[64:65], v[208:209], v[2:3], v[64:65] op_sel:[0,1,0] op_sel_hi:[1,1,1]
    v_pk_mul_f32 v[68:69], v[68:69], v[2:3] op_sel_hi:[1,0]
    v_pk_fma_f32 v[66:67], v[210:211], v[2:3], v[66:67] op_sel:[0,1,0] op_sel_hi:[1,1,1]
    v_cvt_pk_bf16_f32 v56, v64, v65
    v_pk_mul_f32 v[70:71], v[70:71], v[2:3] op_sel_hi:[1,0]
    v_pk_fma_f32 v[68:69], v[212:213], v[2:3], v[68:69] op_sel:[0,1,0] op_sel_hi:[1,1,1]
    v_cvt_pk_bf16_f32 v57, v66, v67
    v_pk_mul_f32 v[72:73], v[72:73], v[2:3] op_sel_hi:[1,0]
    v_pk_fma_f32 v[70:71], v[214:215], v[2:3], v[70:71] op_sel:[0,1,0] op_sel_hi:[1,1,1]
    v_cvt_pk_bf16_f32 v58, v68, v69
    v_pk_mul_f32 v[74:75], v[74:75], v[2:3] op_sel_hi:[1,0]
    v_pk_fma_f32 v[72:73], v[216:217], v[2:3], v[72:73] op_sel:[0,1,0] op_sel_hi:[1,1,1]
    v_cvt_pk_bf16_f32 v59, v70, v71
    buffer_store_dwordx4 v[56:59], v0, s[28:31], s80 offen sc1
    v_pk_mul_f32 v[76:77], v[76:77], v[2:3] op_sel_hi:[1,0]
    v_pk_fma_f32 v[74:75], v[218:219], v[2:3], v[74:75] op_sel:[0,1,0] op_sel_hi:[1,1,1]
    v_cvt_pk_bf16_f32 v60, v72, v73
    v_pk_mul_f32 v[78:79], v[78:79], v[2:3] op_sel_hi:[1,0]
    v_pk_fma_f32 v[76:77], v[220:221], v[2:3], v[76:77] op_sel:[0,1,0] op_sel_hi:[1,1,1]
    v_cvt_pk_bf16_f32 v61, v74, v75
    v_pk_fma_f32 v[78:79], v[222:223], v[2:3], v[78:79] op_sel:[0,1,0] op_sel_hi:[1,1,1]
    v_cvt_pk_bf16_f32 v62, v76, v77
    v_cvt_pk_bf16_f32 v63, v78, v79
    buffer_store_dwordx4 v[60:63], v0, s[28:31], s80 offen offset:1024 sc1
    v_rcp_f32 v2, v237
    v_rcp_f32 v3, v253
    s_add_u32 s80, s40, 52224
    v_fmaak_f32 v37, v236, v2, 0x358637bd
    v_fmac_f32 v37, v252, v3
    v_rcp_f32 v37, v37
    s_nop 0
    v_mul_f32 v37, v37, v32
    v_mul_f32 v2, v2, v37
    v_mul_f32 v3, v3, v37
    s_nop 1
    v_permlane32_swap_b32 v2, v3
    v_mov_b32 v2, v3
    s_nop 1
    v_permlane32_swap_b32 v2, v3
    v_pk_mul_f32 v[224:225], v[224:225], v[2:3] op_sel_hi:[1,0]
    v_pk_mul_f32 v[226:227], v[226:227], v[2:3] op_sel_hi:[1,0]
    v_pk_fma_f32 v[224:225], v[240:241], v[2:3], v[224:225] op_sel:[0,1,0] op_sel_hi:[1,1,1]
    v_pk_mul_f32 v[228:229], v[228:229], v[2:3] op_sel_hi:[1,0]
    v_pk_fma_f32 v[226:227], v[242:243], v[2:3], v[226:227] op_sel:[0,1,0] op_sel_hi:[1,1,1]
    v_cvt_pk_bf16_f32 v40, v224, v225
    v_pk_mul_f32 v[230:231], v[230:231], v[2:3] op_sel_hi:[1,0]
    v_pk_fma_f32 v[228:229], v[244:245], v[2:3], v[228:229] op_sel:[0,1,0] op_sel_hi:[1,1,1]
    v_cvt_pk_bf16_f32 v41, v226, v227
    v_pk_mul_f32 v[232:233], v[232:233], v[2:3] op_sel_hi:[1,0]
    v_pk_fma_f32 v[230:231], v[246:247], v[2:3], v[230:231] op_sel:[0,1,0] op_sel_hi:[1,1,1]
    v_cvt_pk_bf16_f32 v42, v228, v229
    v_pk_mul_f32 v[234:235], v[234:235], v[2:3] op_sel_hi:[1,0]
    v_pk_fma_f32 v[232:233], v[248:249], v[2:3], v[232:233] op_sel:[0,1,0] op_sel_hi:[1,1,1]
    v_cvt_pk_bf16_f32 v43, v230, v231
    buffer_store_dwordx4 v[40:43], v0, s[28:31], s80 offen sc1
    v_pk_mul_f32 v[236:237], v[236:237], v[2:3] op_sel_hi:[1,0]
    v_pk_fma_f32 v[234:235], v[250:251], v[2:3], v[234:235] op_sel:[0,1,0] op_sel_hi:[1,1,1]
    v_cvt_pk_bf16_f32 v44, v232, v233
    v_pk_mul_f32 v[238:239], v[238:239], v[2:3] op_sel_hi:[1,0]
    v_pk_fma_f32 v[236:237], v[252:253], v[2:3], v[236:237] op_sel:[0,1,0] op_sel_hi:[1,1,1]
    v_cvt_pk_bf16_f32 v45, v234, v235
    v_pk_fma_f32 v[238:239], v[254:255], v[2:3], v[238:239] op_sel:[0,1,0] op_sel_hi:[1,1,1]
    v_cvt_pk_bf16_f32 v46, v236, v237
    v_cvt_pk_bf16_f32 v47, v238, v239
    buffer_store_dwordx4 v[44:47], v0, s[28:31], s80 offen offset:1024 sc1
    s_waitcnt vmcnt(0)
    buffer_store_dword v34, v33, s[28:31], s46 offen sc1
    s_endpgm
L_QB:
    s_waitcnt vmcnt(3)
    s_barrier
    s_add_u32 m0, s74, 32768
    ds_read_b128 v[144:147], v112 offset:0
    buffer_load_dwordx4 v3, s[4:7], s90 offen lds
    s_add_u32 m0, s74, 33792
    ds_read_b128 v[148:151], v115 offset:0
    buffer_load_dwordx4 v4, s[4:7], s90 offen lds
    s_waitcnt lgkmcnt(1)
    s_add_u32 m0, s73, 126976
    ds_read_b128 v[152:155], v118 offset:0
    buffer_load_dwordx4 v2, s[16:19], s97 offen lds
    s_add_u32 s79, s91, 128
    s_cmp_eq_u32 s79, 896
    s_cselect_b32 s92, 0, s79
    s_mul_i32 s99, s92, 1344
    s_add_u32 s79, s92, 128
    s_cmp_eq_u32 s79, 896
    s_cselect_b32 s93, 0, s79
    s_waitcnt lgkmcnt(1)
    ds_read_b128 v[156:159], v121 offset:0
    s_mul_i32 s100, s93, 1344
    s_add_u32 s79, s93, 128
    s_cmp_eq_u32 s79, 896
    s_cselect_b32 s94, 0, s79
    s_mul_i32 s101, s94, 1344
    s_mov_b32 s64, s40
    s_waitcnt lgkmcnt(1)
    s_waitcnt vmcnt(3)
    s_barrier
    s_add_u32 m0, s74, 49152
    ds_read_b128 v[160:163], v112 offset:16384
    buffer_load_dwordx4 v3, s[4:7], s91 offen lds
    s_mov_b32 s65, s41
    s_mov_b32 s66, 25088
    s_mov_b32 s67, 0x20000
    s_mov_b32 s32, s56
    s_mov_b32 s33, s57
    s_mov_b32 s34, 256
    s_waitcnt lgkmcnt(1)
    s_add_u32 m0, s74, 50176
    ds_read_b128 v[164:167], v115 offset:16384
    buffer_load_dwordx4 v4, s[4:7], s91 offen lds
    s_mov_b32 s35, 0x20000
    s_mov_b32 s86, 0x10000000
    s_mov_b32 s87, 0x10000000
    v_lshlrev_b32 v12, 4, v17
    v_add_u32 v124, 155648, v12
    v_bfe_u32 v19, v0, 6, 2
    s_waitcnt lgkmcnt(1)
    s_add_u32 m0, s73, 118784
    ds_read_b128 v[168:171], v118 offset:16384
    buffer_load_dwordx4 v2, s[16:19], s98 offen lds
    v_lshl_add_u32 v21, v17, 3, v19
    v_bfe_u32 v12, v0, 8, 1
    v_bfe_u32 v13, v0, 4, 2
    v_lshl_or_b32 v20, v12, 2, v13
    v_add_u32 v13, s78, v20
    s_and_b32 s79, s78, 14
    v_subrev_u32 v13, s79, v13
    s_waitcnt lgkmcnt(1)
    ds_read_b128 v[172:175], v121 offset:16384
    v_and_b32 v13, 7, v13
    v_lshlrev_b32 v13, 3, v13
    v_lshl_or_b32 v8, v21, 6, v13
    v_add_u32 v9, 0x10000, v8
    v_add_u32 v10, 0x20000, v8
    s_mov_b32 s28, s58
    s_waitcnt lgkmcnt(1)
    s_waitcnt vmcnt(3)
    s_barrier
    s_add_u32 m0, s74, 0
    ds_read_b128 v[176:179], v112 offset:32768
    buffer_load_dwordx4 v3, s[4:7], s92 offen lds
    s_mov_b32 s29, s59
    s_mov_b32 s30, 26345472
    s_mov_b32 s31, 0x20000
    s_mov_b32 s82, 0x3fb8aa3b
    s_mov_b32 s84, 0
    s_mov_b32 s85, -1
    s_waitcnt lgkmcnt(1)
    s_add_u32 m0, s74, 1024
    ds_read_b128 v[180:183], v115 offset:32768
    buffer_load_dwordx4 v4, s[4:7], s92 offen lds
    v_lshrrev_b32 v12, 8, v0
    v_lshl_add_u32 v13, s72, 2, v12
    v_mul_u32_u24 v1, 2688, v13
    v_lshlrev_b32 v12, 6, v12
    v_sub_u32 v12, v0, v12
    v_and_b32 v12, 0xf0, v12
    s_waitcnt lgkmcnt(1)
    s_add_u32 m0, s73, 143360
    ds_read_b128 v[184:187], v118 offset:32768
    buffer_load_dwordx4 v2, s[16:19], s99 offen lds
    s_mul_i32 s79, s76, 448
    v_add3_u32 v1, v1, v12, s79
    s_mov_b32 s79, 86016
    s_add_u32 s8, s16, s79
    s_addc_u32 s9, s17, 0
    s_sub_u32 s10, 1204224, s79
    s_waitcnt lgkmcnt(1)
    ds_read_b128 v[188:191], v121 offset:32768
    s_mov_b32 s11, 0x20000
    v_min_u32 v12, 6, v20
    v_lshlrev_b32 v12, 3, v12
    v_lshl_add_u32 v12, v19, 6, v12
    v_lshl_or_b32 v5, v21, 8, v12
    v_add_u32 v6, 0x10000, v5
    s_waitcnt lgkmcnt(1)
    s_waitcnt vmcnt(3)
    s_barrier
    s_add_u32 m0, s74, 16384
    ds_read_b128 v[192:195], v112 offset:49152
    buffer_load_dwordx4 v3, s[4:7], s93 offen lds
    v_add_u32 v7, 0x20000, v5
    v_lshrrev_b32 v37, 2, v0
    v_mov_b32 v38, 2147418112
    v_cndmask_b32 v33, v37, v38, s[84:85]
    v_bfe_u32 v37, v0, 6, 2
    v_lshrrev_b32 v38, 9, v0
    s_waitcnt lgkmcnt(1)
    s_add_u32 m0, s74, 17408
    ds_read_b128 v[196:199], v115 offset:49152
    buffer_load_dwordx4 v4, s[4:7], s93 offen lds
    v_lshl_add_u32 v37, v38, 2, v37
    v_mul_u32_u24 v39, 56, v37
    v_bfe_u32 v37, v0, 8, 1
    v_bfe_u32 v38, v0, 4, 2
    v_lshl_or_b32 v37, v37, 2, v38
    v_min_u32 v37, 6, v37
    s_waitcnt lgkmcnt(1)
    s_add_u32 m0, s73, 135168
    ds_read_b128 v[200:203], v118 offset:49152
    buffer_load_dwordx4 v2, s[16:19], s100 offen lds
    v_lshl_add_u32 v39, v37, 3, v39
    v_add_u32 v39, 98304, v39
    s_mov_b32 s59, 0
    s_lshr_b32 s40, s75, 1
    s_mul_i32 s40, s40, 368640
    s_mul_i32 s80, s75, 16384
    s_add_u32 s40, s40, s80
    s_waitcnt lgkmcnt(1)
    ds_read_b128 v[204:207], v121 offset:49152
    s_add_u32 m0, s74, 98304
    s_mul_i32 s79, s76, 12544
    s_add_u32 s79, s79, s74
    buffer_load_dwordx4 v0, s[64:67], s79 offen lds
    buffer_load_dwordx4 v0, s[64:67], s79 offen offset:1024 lds
    s_mul_i32 s80, s45, 4096
    s_add_u32 s40, s40, s80
    s_mul_i32 s80, s76, 200704
    s_add_u32 s40, s40, s80
    s_add_u32 s40, s40, 13631488
    s_lshl2_add_u32 s79, s75, s45
    s_lshl1_add_u32 s79, s79, s76
    s_mul_i32 s46, s79, 256
    s_waitcnt lgkmcnt(1)
    s_waitcnt vmcnt(5)
    s_barrier
    s_add_u32 m0, s74, 32768
    ds_read_b128 v[208:211], v112 offset:0
    buffer_load_dwordx4 v3, s[4:7], s94 offen lds
    s_add_u32 s46, s46, 18612352
    s_lshl2_add_u32 s44, s76, s45
    s_lshr_b32 s50, s75, 3
    s_bfe_u32 s41, s75, 0x10002
    s_mul_i32 s47, s44, 16384
    s_mul_i32 s80, s50, 2048
    s_add_u32 s47, s47, s80
    s_waitcnt lgkmcnt(1)
    s_add_u32 m0, s74, 33792
    ds_read_b128 v[212:215], v115 offset:0
    buffer_load_dwordx4 v4, s[4:7], s94 offen lds
    s_mul_i32 s80, s41, 4096
    s_add_u32 s47, s47, s80
    s_add_u32 s47, s47, 18677760
    s_mul_i32 s48, s44, 2048
    s_add_u32 s48, s48, 18808832
    s_mul_i32 s49, s75, 128
    s_waitcnt lgkmcnt(1)
    s_add_u32 m0, s73, 126976
    ds_read_b128 v[216:219], v118 offset:0
    buffer_load_dwordx4 v2, s[16:19], s101 offen lds
    s_mul_i32 s80, s48, 1
    s_add_u32 s49, s49, s80
    s_mul_i32 s41, s44, 131072
    s_mul_i32 s80, s75, 256
    s_add_u32 s41, s41, s80
    s_add_u32 s41, s41, 19922944
    s_waitcnt lgkmcnt(1)
    ds_read_b128 v[220:223], v121 offset:0
    s_mul_i32 s50, s44, 8192
    s_mul_i32 s80, s75, 256
    s_add_u32 s50, s50, s80
    s_add_u32 s50, s50, 17825792
    s_waitcnt lgkmcnt(1)
    s_waitcnt vmcnt(5)
    s_barrier
    ds_read_b128 v[224:227], v112 offset:16384
    v_subrev_u32 v8, 43008, v1
    s_waitcnt lgkmcnt(1)
    s_add_u32 m0, s73, 90112
    ds_read_b128 v[228:231], v115 offset:16384
    buffer_load_dwordx4 v1, s[16:19], s95 offen lds
    s_waitcnt lgkmcnt(1)
    s_add_u32 m0, s73, 86016
    ds_read_b128 v[232:235], v118 offset:16384
    buffer_load_dwordx4 v8, s[16:19], s95 offen lds
    s_waitcnt lgkmcnt(1)
    s_add_u32 m0, s73, 81920
    ds_read_b128 v[236:239], v121 offset:16384
    buffer_load_dwordx4 v1, s[8:11], s95 offen lds
    s_waitcnt vmcnt(6)
    s_waitcnt lgkmcnt(1)
    s_add_u32 m0, s73, 77824
    s_nop 0
    buffer_load_dwordx4 v8, s[8:11], s95 offen lds
    s_waitcnt vmcnt(4)
    s_barrier
    s_add_u32 m0, s73, 0
    ds_read_b128 v[240:243], v112 offset:32768
    buffer_load_dwordx4 v1, s[16:19], s96 offen lds
    s_waitcnt lgkmcnt(1)
    s_sub_u32 m0, s73, 4096
    ds_read_b128 v[244:247], v115 offset:32768
    buffer_load_dwordx4 v8, s[16:19], s96 offen lds
    s_waitcnt lgkmcnt(1)
    s_add_u32 m0, s73, 8192
    ds_read_b128 v[248:251], v118 offset:32768
    buffer_load_dwordx4 v1, s[8:11], s96 offen lds
    s_waitcnt lgkmcnt(1)
    s_add_u32 m0, s73, 4096
    ds_read_b128 v[252:255], v121 offset:32768
    buffer_load_dwordx4 v8, s[8:11], s96 offen lds
    s_waitcnt lgkmcnt(1)
    v_add_u32 v2, 896, v2
    s_waitcnt lgkmcnt(0)
    s_add_u32 m0, s73, 45056
    s_nop 0
    buffer_load_dwordx4 v2, s[16:19], s95 offen lds
    v_mov_b32 v37, 0xff
    v_mov_b32 v21, v124
    v_add_u32 v38, 56, v5
    v_bfi_b32 v12, v37, v38, v5
    v_bfi_b32 v13, v37, v38, v6
    v_bfi_b32 v14, v37, v38, v7
    v_add_u32 v38, 112, v5
    v_bfi_b32 v15, v37, v38, v5
    v_bfi_b32 v16, v37, v38, v6
    v_bfi_b32 v17, v37, v38, v7
    v_add_u32 v38, 168, v5
    v_bfi_b32 v18, v37, v38, v5
    v_bfi_b32 v19, v37, v38, v6
    v_bfi_b32 v20, v37, v38, v7
    s_add_u32 m0, s73, 53248
    s_nop 0
    buffer_load_dwordx4 v2, s[16:19], s96 offen lds
    v_mov_b32 v34, 2147418112
    v_writelane_b32 v34, 0, 0
    buffer_load_dword v36, v34, s[32:35], 0 offen sc1
    s_waitcnt vmcnt(7)
    s_barrier
    ds_read_b64_tr_b16 v[56:57], v6 offset:24576
    ds_read_b64_tr_b16 v[58:59], v6 offset:25600
    s_mov_b64 exec, s[86:87]
    ds_read_b128 v[56:59], v21 offset:0
    s_mov_b64 exec, -1
    ds_read_b64_tr_b16 v[60:61], v13 offset:24576
    ds_read_b64_tr_b16 v[62:63], v13 offset:25600
    ds_read_b64_tr_b16 v[40:41], v16 offset:24576
    ds_read_b64_tr_b16 v[42:43], v16 offset:25600
    ds_read_b64_tr_b16 v[44:45], v19 offset:24576
    ds_read_b64_tr_b16 v[46:47], v19 offset:25600
    s_waitcnt lgkmcnt(6)
    v_mfma_f32_32x32x16_bf16 v[80:95], v[56:59], v[144:147], 0
    ds_read_b64_tr_b16 v[48:49], v6 offset:28672
    ds_read_b64_tr_b16 v[50:51], v6 offset:29696
    s_mov_b64 exec, s[86:87]
    ds_read_b128 v[48:51], v21 offset:32
    s_mov_b64 exec, -1
    s_waitcnt lgkmcnt(7)
    v_mfma_f32_32x32x16_bf16 v[96:111], v[60:63], v[144:147], 0
    ds_read_b64_tr_b16 v[52:53], v13 offset:28672
    ds_read_b64_tr_b16 v[54:55], v13 offset:29696
    s_waitcnt lgkmcnt(7)
    v_mfma_f32_32x32x16_bf16 v[112:127], v[40:43], v[144:147], 0
    ds_read_b64_tr_b16 v[56:57], v16 offset:28672
    ds_read_b64_tr_b16 v[58:59], v16 offset:29696
    s_waitcnt lgkmcnt(7)
    v_mfma_f32_32x32x16_bf16 v[128:143], v[44:47], v[144:147], 0
    ds_read_b64_tr_b16 v[60:61], v19 offset:28672
    ds_read_b64_tr_b16 v[62:63], v19 offset:29696
    s_waitcnt lgkmcnt(6)
    v_mfma_f32_32x32x16_bf16 v[80:95], v[48:51], v[148:151], v[80:95]
    ds_read_b64_tr_b16 v[40:41], v6 offset:16384
    ds_read_b64_tr_b16 v[42:43], v6 offset:17408
    s_mov_b64 exec, s[86:87]
    ds_read_b128 v[40:43], v21 offset:64
    s_mov_b64 exec, -1
    s_waitcnt lgkmcnt(7)
    v_mfma_f32_32x32x16_bf16 v[96:111], v[52:55], v[148:151], v[96:111]
    ds_read_b64_tr_b16 v[44:45], v13 offset:16384
    ds_read_b64_tr_b16 v[46:47], v13 offset:17408
    s_waitcnt lgkmcnt(7)
    v_mfma_f32_32x32x16_bf16 v[112:127], v[56:59], v[148:151], v[112:127]
    ds_read_b64_tr_b16 v[48:49], v16 offset:16384
    ds_read_b64_tr_b16 v[50:51], v16 offset:17408
    s_waitcnt lgkmcnt(7)
    v_mfma_f32_32x32x16_bf16 v[128:143], v[60:63], v[148:151], v[128:143]
    ds_read_b64_tr_b16 v[52:53], v19 offset:16384
    ds_read_b64_tr_b16 v[54:55], v19 offset:17408
    s_waitcnt lgkmcnt(6)
    v_mfma_f32_32x32x16_bf16 v[80:95], v[40:43], v[152:155], v[80:95]
    ds_read_b64_tr_b16 v[56:57], v6 offset:20480
    ds_read_b64_tr_b16 v[58:59], v6 offset:21504
    s_mov_b64 exec, s[86:87]
    ds_read_b128 v[56:59], v21 offset:96
    s_mov_b64 exec, -1
    s_waitcnt lgkmcnt(7)
    v_mfma_f32_32x32x16_bf16 v[96:111], v[44:47], v[152:155], v[96:111]
    ds_read_b64_tr_b16 v[60:61], v13 offset:20480
    ds_read_b64_tr_b16 v[62:63], v13 offset:21504
    s_waitcnt lgkmcnt(7)
    v_mfma_f32_32x32x16_bf16 v[112:127], v[48:51], v[152:155], v[112:127]
    ds_read_b64_tr_b16 v[40:41], v16 offset:20480
    ds_read_b64_tr_b16 v[42:43], v16 offset:21504
    s_waitcnt lgkmcnt(7)
    v_mfma_f32_32x32x16_bf16 v[128:143], v[52:55], v[152:155], v[128:143]
    ds_read_b64_tr_b16 v[44:45], v19 offset:20480
    ds_read_b64_tr_b16 v[46:47], v19 offset:21504
    s_waitcnt lgkmcnt(6)
    v_mfma_f32_32x32x16_bf16 v[80:95], v[56:59], v[156:159], v[80:95]
    s_waitcnt vmcnt(3)
    s_barrier
    ds_read_b64_tr_b16 v[48:49], v5 offset:0
    ds_read_b64_tr_b16 v[50:51], v5 offset:1024
    s_mov_b64 exec, s[86:87]
    ds_read_b128 v[48:51], v21 offset:128
    s_mov_b64 exec, -1
    s_waitcnt lgkmcnt(7)
    v_mfma_f32_32x32x16_bf16 v[96:111], v[60:63], v[156:159], v[96:111]
    ds_read_b64_tr_b16 v[52:53], v12 offset:0
    ds_read_b64_tr_b16 v[54:55], v12 offset:1024
    s_waitcnt lgkmcnt(7)
    v_mfma_f32_32x32x16_bf16 v[112:127], v[40:43], v[156:159], v[112:127]
    ds_read_b64_tr_b16 v[56:57], v15 offset:0
    ds_read_b64_tr_b16 v[58:59], v15 offset:1024
    s_waitcnt lgkmcnt(7)
    v_mfma_f32_32x32x16_bf16 v[128:143], v[44:47], v[156:159], v[128:143]
    ds_read_b64_tr_b16 v[60:61], v18 offset:0
    ds_read_b64_tr_b16 v[62:63], v18 offset:1024
    s_waitcnt lgkmcnt(6)
    v_mfma_f32_32x32x16_bf16 v[80:95], v[48:51], v[160:163], v[80:95]
    ds_read_b64_tr_b16 v[40:41], v5 offset:4096
    ds_read_b64_tr_b16 v[42:43], v5 offset:5120
    s_mov_b64 exec, s[86:87]
    ds_read_b128 v[40:43], v21 offset:160
    s_mov_b64 exec, -1
    s_waitcnt lgkmcnt(7)
    v_mfma_f32_32x32x16_bf16 v[96:111], v[52:55], v[160:163], v[96:111]
    ds_read_b64_tr_b16 v[44:45], v12 offset:4096
    ds_read_b64_tr_b16 v[46:47], v12 offset:5120
    s_waitcnt lgkmcnt(7)
    v_mfma_f32_32x32x16_bf16 v[112:127], v[56:59], v[160:163], v[112:127]
    ds_read_b64_tr_b16 v[48:49], v15 offset:4096
    ds_read_b64_tr_b16 v[50:51], v15 offset:5120
    s_waitcnt lgkmcnt(7)
    v_mfma_f32_32x32x16_bf16 v[128:143], v[60:63], v[160:163], v[128:143]
    ds_read_b64_tr_b16 v[52:53], v18 offset:4096
    ds_read_b64_tr_b16 v[54:55], v18 offset:5120
    s_waitcnt lgkmcnt(6)
    v_mfma_f32_32x32x16_bf16 v[80:95], v[40:43], v[164:167], v[80:95]
    ds_read_b64_tr_b16 v[56:57], v5 offset:8192
    ds_read_b64_tr_b16 v[58:59], v5 offset:9216
    s_mov_b64 exec, s[86:87]
    ds_read_b128 v[56:59], v21 offset:192
    s_mov_b64 exec, -1
    s_waitcnt lgkmcnt(7)
    v_mfma_f32_32x32x16_bf16 v[96:111], v[44:47], v[164:167], v[96:111]
    ds_read_b64_tr_b16 v[60:61], v12 offset:8192
    ds_read_b64_tr_b16 v[62:63], v12 offset:9216
    s_waitcnt lgkmcnt(7)
    v_mfma_f32_32x32x16_bf16 v[112:127], v[48:51], v[164:167], v[112:127]
    ds_read_b64_tr_b16 v[40:41], v15 offset:8192
    ds_read_b64_tr_b16 v[42:43], v15 offset:9216
    s_waitcnt lgkmcnt(7)
    v_mfma_f32_32x32x16_bf16 v[128:143], v[52:55], v[164:167], v[128:143]
    ds_read_b64_tr_b16 v[44:45], v18 offset:8192
    ds_read_b64_tr_b16 v[46:47], v18 offset:9216
    s_waitcnt lgkmcnt(6)
    v_mfma_f32_32x32x16_bf16 v[80:95], v[56:59], v[168:171], v[80:95]
    ds_read_b64_tr_b16 v[48:49], v5 offset:12288
    ds_read_b64_tr_b16 v[50:51], v5 offset:13312
    s_mov_b64 exec, s[86:87]
    ds_read_b128 v[48:51], v21 offset:224
    s_mov_b64 exec, -1
    s_waitcnt lgkmcnt(7)
    v_mfma_f32_32x32x16_bf16 v[96:111], v[60:63], v[168:171], v[96:111]
    ds_read_b64_tr_b16 v[52:53], v12 offset:12288
    ds_read_b64_tr_b16 v[54:55], v12 offset:13312
    s_waitcnt lgkmcnt(7)
    v_mfma_f32_32x32x16_bf16 v[112:127], v[40:43], v[168:171], v[112:127]
    ds_read_b64_tr_b16 v[56:57], v15 offset:12288
    ds_read_b64_tr_b16 v[58:59], v15 offset:13312
    s_waitcnt lgkmcnt(7)
    v_mfma_f32_32x32x16_bf16 v[128:143], v[44:47], v[168:171], v[128:143]
    ds_read_b64_tr_b16 v[60:61], v18 offset:12288
    ds_read_b64_tr_b16 v[62:63], v18 offset:13312
    s_waitcnt lgkmcnt(6)
    v_mfma_f32_32x32x16_bf16 v[80:95], v[48:51], v[172:175], v[80:95]
    s_barrier
    ds_read_b64_tr_b16 v[40:41], v5 offset:16384
    ds_read_b64_tr_b16 v[42:43], v5 offset:17408
    s_mov_b64 exec, s[86:87]
    ds_read_b128 v[40:43], v21 offset:256
    s_mov_b64 exec, -1
    s_waitcnt lgkmcnt(7)
    v_mfma_f32_32x32x16_bf16 v[96:111], v[52:55], v[172:175], v[96:111]
    ds_read_b64_tr_b16 v[44:45], v12 offset:16384
    ds_read_b64_tr_b16 v[46:47], v12 offset:17408
    s_waitcnt lgkmcnt(7)
    v_mfma_f32_32x32x16_bf16 v[112:127], v[56:59], v[172:175], v[112:127]
    ds_read_b64_tr_b16 v[48:49], v15 offset:16384
    ds_read_b64_tr_b16 v[50:51], v15 offset:17408
    s_waitcnt lgkmcnt(7)
    v_mfma_f32_32x32x16_bf16 v[128:143], v[60:63], v[172:175], v[128:143]
    ds_read_b64_tr_b16 v[52:53], v18 offset:16384
    ds_read_b64_tr_b16 v[54:55], v18 offset:17408
    s_waitcnt lgkmcnt(6)
    v_mfma_f32_32x32x16_bf16 v[80:95], v[40:43], v[176:179], v[80:95]
    ds_read_b64_tr_b16 v[56:57], v5 offset:20480
    ds_read_b64_tr_b16 v[58:59], v5 offset:21504
    s_mov_b64 exec, s[86:87]
    ds_read_b128 v[56:59], v21 offset:288
    s_mov_b64 exec, -1
    s_waitcnt lgkmcnt(7)
    v_mfma_f32_32x32x16_bf16 v[96:111], v[44:47], v[176:179], v[96:111]
    ds_read_b64_tr_b16 v[60:61], v12 offset:20480
    ds_read_b64_tr_b16 v[62:63], v12 offset:21504
    s_waitcnt lgkmcnt(7)
    v_mfma_f32_32x32x16_bf16 v[112:127], v[48:51], v[176:179], v[112:127]
    ds_read_b64_tr_b16 v[40:41], v15 offset:20480
    ds_read_b64_tr_b16 v[42:43], v15 offset:21504
    s_waitcnt lgkmcnt(7)
    v_mfma_f32_32x32x16_bf16 v[128:143], v[52:55], v[176:179], v[128:143]
    ds_read_b64_tr_b16 v[44:45], v18 offset:20480
    ds_read_b64_tr_b16 v[46:47], v18 offset:21504
    s_waitcnt lgkmcnt(6)
    v_mfma_f32_32x32x16_bf16 v[80:95], v[56:59], v[180:183], v[80:95]
    ds_read_b64_tr_b16 v[48:49], v5 offset:24576
    ds_read_b64_tr_b16 v[50:51], v5 offset:25600
    s_mov_b64 exec, s[86:87]
    ds_read_b128 v[48:51], v21 offset:320
    s_mov_b64 exec, -1
    s_waitcnt lgkmcnt(7)
    v_mfma_f32_32x32x16_bf16 v[96:111], v[60:63], v[180:183], v[96:111]
    ds_read_b64_tr_b16 v[52:53], v12 offset:24576
    ds_read_b64_tr_b16 v[54:55], v12 offset:25600
    s_waitcnt lgkmcnt(7)
    v_mfma_f32_32x32x16_bf16 v[112:127], v[40:43], v[180:183], v[112:127]
    ds_read_b64_tr_b16 v[56:57], v15 offset:24576
    ds_read_b64_tr_b16 v[58:59], v15 offset:25600
    s_waitcnt lgkmcnt(7)
    v_mfma_f32_32x32x16_bf16 v[128:143], v[44:47], v[180:183], v[128:143]
    ds_read_b64_tr_b16 v[60:61], v18 offset:24576
    ds_read_b64_tr_b16 v[62:63], v18 offset:25600
    s_waitcnt lgkmcnt(6)
    v_mfma_f32_32x32x16_bf16 v[80:95], v[48:51], v[184:187], v[80:95]
    ds_read_b64_tr_b16 v[40:41], v5 offset:28672
    ds_read_b64_tr_b16 v[42:43], v5 offset:29696
    s_mov_b64 exec, s[86:87]
    ds_read_b128 v[40:43], v21 offset:352
    s_mov_b64 exec, -1
    s_waitcnt lgkmcnt(7)
    v_mfma_f32_32x32x16_bf16 v[96:111], v[52:55], v[184:187], v[96:111]
    ds_read_b64_tr_b16 v[44:45], v12 offset:28672
    ds_read_b64_tr_b16 v[46:47], v12 offset:29696
    s_waitcnt lgkmcnt(7)
    v_mfma_f32_32x32x16_bf16 v[112:127], v[56:59], v[184:187], v[112:127]
    ds_read_b64_tr_b16 v[48:49], v15 offset:28672
    ds_read_b64_tr_b16 v[50:51], v15 offset:29696
    s_waitcnt lgkmcnt(7)
    v_mfma_f32_32x32x16_bf16 v[128:143], v[60:63], v[184:187], v[128:143]
    ds_read_b64_tr_b16 v[52:53], v18 offset:28672
    ds_read_b64_tr_b16 v[54:55], v18 offset:29696
    s_waitcnt lgkmcnt(6)
    v_mfma_f32_32x32x16_bf16 v[80:95], v[40:43], v[188:191], v[80:95]
    s_waitcnt vmcnt(1)
    s_barrier
    ds_read_b64_tr_b16 v[56:57], v6 offset:0
    ds_read_b64_tr_b16 v[58:59], v6 offset:1024
    s_mov_b64 exec, s[86:87]
    ds_read_b128 v[56:59], v21 offset:384
    s_mov_b64 exec, -1
    s_waitcnt lgkmcnt(7)
    v_mfma_f32_32x32x16_bf16 v[96:111], v[44:47], v[188:191], v[96:111]
    ds_read_b64_tr_b16 v[60:61], v13 offset:0
    ds_read_b64_tr_b16 v[62:63], v13 offset:1024
    s_waitcnt lgkmcnt(7)
    v_mfma_f32_32x32x16_bf16 v[112:127], v[48:51], v[188:191], v[112:127]
    ds_read_b64_tr_b16 v[40:41], v16 offset:0
    ds_read_b64_tr_b16 v[42:43], v16 offset:1024
    s_waitcnt lgkmcnt(7)
    v_mfma_f32_32x32x16_bf16 v[128:143], v[52:55], v[188:191], v[128:143]
    ds_read_b64_tr_b16 v[44:45], v19 offset:0
    ds_read_b64_tr_b16 v[46:47], v19 offset:1024
    s_waitcnt lgkmcnt(6)
    v_mfma_f32_32x32x16_bf16 v[80:95], v[56:59], v[192:195], v[80:95]
    ds_read_b64_tr_b16 v[48:49], v6 offset:4096
    ds_read_b64_tr_b16 v[50:51], v6 offset:5120
    s_mov_b64 exec, s[86:87]
    ds_read_b128 v[48:51], v21 offset:416
    s_mov_b64 exec, -1
    s_waitcnt lgkmcnt(7)
    v_mfma_f32_32x32x16_bf16 v[96:111], v[60:63], v[192:195], v[96:111]
    ds_read_b64_tr_b16 v[52:53], v13 offset:4096
    ds_read_b64_tr_b16 v[54:55], v13 offset:5120
    s_waitcnt lgkmcnt(7)
    v_mfma_f32_32x32x16_bf16 v[112:127], v[40:43], v[192:195], v[112:127]
    ds_read_b64_tr_b16 v[56:57], v16 offset:4096
    ds_read_b64_tr_b16 v[58:59], v16 offset:5120
    s_waitcnt lgkmcnt(7)
    v_mfma_f32_32x32x16_bf16 v[128:143], v[44:47], v[192:195], v[128:143]
    ds_read_b64_tr_b16 v[60:61], v19 offset:4096
    ds_read_b64_tr_b16 v[62:63], v19 offset:5120
    s_waitcnt lgkmcnt(6)
    v_mfma_f32_32x32x16_bf16 v[80:95], v[48:51], v[196:199], v[80:95]
    ds_read_b64_tr_b16 v[40:41], v6 offset:8192
    ds_read_b64_tr_b16 v[42:43], v6 offset:9216
    s_mov_b64 exec, s[86:87]
    ds_read_b128 v[40:43], v21 offset:448
    s_mov_b64 exec, -1
    s_waitcnt lgkmcnt(7)
    v_mfma_f32_32x32x16_bf16 v[96:111], v[52:55], v[196:199], v[96:111]
    ds_read_b64_tr_b16 v[44:45], v13 offset:8192
    ds_read_b64_tr_b16 v[46:47], v13 offset:9216
    s_waitcnt lgkmcnt(7)
    v_mfma_f32_32x32x16_bf16 v[112:127], v[56:59], v[196:199], v[112:127]
    ds_read_b64_tr_b16 v[48:49], v16 offset:8192
    ds_read_b64_tr_b16 v[50:51], v16 offset:9216
    s_waitcnt lgkmcnt(7)
    v_mfma_f32_32x32x16_bf16 v[128:143], v[60:63], v[196:199], v[128:143]
    ds_read_b64_tr_b16 v[52:53], v19 offset:8192
    ds_read_b64_tr_b16 v[54:55], v19 offset:9216
    s_waitcnt lgkmcnt(6)
    v_mfma_f32_32x32x16_bf16 v[80:95], v[40:43], v[200:203], v[80:95]
    ds_read_b64_tr_b16 v[56:57], v6 offset:12288
    ds_read_b64_tr_b16 v[58:59], v6 offset:13312
    s_mov_b64 exec, s[86:87]
    ds_read_b128 v[56:59], v21 offset:480
    s_mov_b64 exec, -1
    s_waitcnt lgkmcnt(7)
    v_mfma_f32_32x32x16_bf16 v[96:111], v[44:47], v[200:203], v[96:111]
    ds_read_b64_tr_b16 v[60:61], v13 offset:12288
    ds_read_b64_tr_b16 v[62:63], v13 offset:13312
    s_waitcnt lgkmcnt(7)
    v_mfma_f32_32x32x16_bf16 v[112:127], v[48:51], v[200:203], v[112:127]
    ds_read_b64_tr_b16 v[40:41], v16 offset:12288
    ds_read_b64_tr_b16 v[42:43], v16 offset:13312
    s_waitcnt lgkmcnt(7)
    v_mfma_f32_32x32x16_bf16 v[128:143], v[52:55], v[200:203], v[128:143]
    ds_read_b64_tr_b16 v[44:45], v19 offset:12288
    ds_read_b64_tr_b16 v[46:47], v19 offset:13312
    s_waitcnt lgkmcnt(6)
    v_mfma_f32_32x32x16_bf16 v[80:95], v[56:59], v[204:207], v[80:95]
    s_barrier
    ds_read_b64_tr_b16 v[48:49], v5 offset:0
    ds_read_b64_tr_b16 v[50:51], v5 offset:1024
    s_mov_b64 exec, s[86:87]
    ds_read_b128 v[48:51], v21 offset:512
    s_mov_b64 exec, -1
    s_waitcnt lgkmcnt(7)
    v_mfma_f32_32x32x16_bf16 v[96:111], v[60:63], v[204:207], v[96:111]
    ds_read_b64_tr_b16 v[52:53], v12 offset:0
    ds_read_b64_tr_b16 v[54:55], v12 offset:1024
    s_waitcnt lgkmcnt(7)
    v_mfma_f32_32x32x16_bf16 v[112:127], v[40:43], v[204:207], v[112:127]
    ds_read_b64_tr_b16 v[56:57], v15 offset:0
    ds_read_b64_tr_b16 v[58:59], v15 offset:1024
    s_waitcnt lgkmcnt(7)
    v_mfma_f32_32x32x16_bf16 v[128:143], v[44:47], v[204:207], v[128:143]
    ds_read_b64_tr_b16 v[60:61], v18 offset:0
    ds_read_b64_tr_b16 v[62:63], v18 offset:1024
    s_waitcnt lgkmcnt(6)
    v_mfma_f32_32x32x16_bf16 v[80:95], v[48:51], v[208:211], v[80:95]
    ds_read_b64_tr_b16 v[40:41], v5 offset:4096
    ds_read_b64_tr_b16 v[42:43], v5 offset:5120
    s_mov_b64 exec, s[86:87]
    ds_read_b128 v[40:43], v21 offset:544
    s_mov_b64 exec, -1
    s_waitcnt lgkmcnt(7)
    v_mfma_f32_32x32x16_bf16 v[96:111], v[52:55], v[208:211], v[96:111]
    ds_read_b64_tr_b16 v[44:45], v12 offset:4096
    ds_read_b64_tr_b16 v[46:47], v12 offset:5120
    s_waitcnt lgkmcnt(7)
    v_mfma_f32_32x32x16_bf16 v[112:127], v[56:59], v[208:211], v[112:127]
    ds_read_b64_tr_b16 v[48:49], v15 offset:4096
    ds_read_b64_tr_b16 v[50:51], v15 offset:5120
    s_waitcnt lgkmcnt(7)
    v_mfma_f32_32x32x16_bf16 v[128:143], v[60:63], v[208:211], v[128:143]
    ds_read_b64_tr_b16 v[52:53], v18 offset:4096
    ds_read_b64_tr_b16 v[54:55], v18 offset:5120
    s_waitcnt lgkmcnt(6)
    v_mfma_f32_32x32x16_bf16 v[80:95], v[40:43], v[212:215], v[80:95]
    ds_read_b64_tr_b16 v[56:57], v6 offset:16384
    ds_read_b64_tr_b16 v[58:59], v6 offset:17408
    s_mov_b64 exec, s[86:87]
    ds_read_b128 v[56:59], v21 offset:576
    s_mov_b64 exec, -1
    s_waitcnt lgkmcnt(7)
    v_mfma_f32_32x32x16_bf16 v[96:111], v[44:47], v[212:215], v[96:111]
    ds_read_b64_tr_b16 v[60:61], v13 offset:16384
    ds_read_b64_tr_b16 v[62:63], v13 offset:17408
    s_waitcnt lgkmcnt(7)
    v_mfma_f32_32x32x16_bf16 v[112:127], v[48:51], v[212:215], v[112:127]
    ds_read_b64_tr_b16 v[40:41], v16 offset:16384
    ds_read_b64_tr_b16 v[42:43], v16 offset:17408
    s_waitcnt lgkmcnt(7)
    v_mfma_f32_32x32x16_bf16 v[128:143], v[52:55], v[212:215], v[128:143]
    ds_read_b64_tr_b16 v[44:45], v19 offset:16384
    ds_read_b64_tr_b16 v[46:47], v19 offset:17408
    s_waitcnt lgkmcnt(6)
    v_mfma_f32_32x32x16_bf16 v[80:95], v[56:59], v[216:219], v[80:95]
    ds_read_b64_tr_b16 v[48:49], v6 offset:20480
    ds_read_b64_tr_b16 v[50:51], v6 offset:21504
    s_mov_b64 exec, s[86:87]
    ds_read_b128 v[48:51], v21 offset:608
    s_mov_b64 exec, -1
    s_waitcnt lgkmcnt(7)
    v_mfma_f32_32x32x16_bf16 v[96:111], v[60:63], v[216:219], v[96:111]
    ds_read_b64_tr_b16 v[52:53], v13 offset:20480
    ds_read_b64_tr_b16 v[54:55], v13 offset:21504
    s_waitcnt lgkmcnt(7)
    v_mfma_f32_32x32x16_bf16 v[112:127], v[40:43], v[216:219], v[112:127]
    ds_read_b64_tr_b16 v[56:57], v16 offset:20480
    ds_read_b64_tr_b16 v[58:59], v16 offset:21504
    s_waitcnt lgkmcnt(7)
    v_mfma_f32_32x32x16_bf16 v[128:143], v[44:47], v[216:219], v[128:143]
    ds_read_b64_tr_b16 v[60:61], v19 offset:20480
    ds_read_b64_tr_b16 v[62:63], v19 offset:21504
    s_waitcnt lgkmcnt(6)
    v_mfma_f32_32x32x16_bf16 v[80:95], v[48:51], v[220:223], v[80:95]
    s_barrier
    ds_read_b64_tr_b16 v[40:41], v5 offset:8192
    ds_read_b64_tr_b16 v[42:43], v5 offset:9216
    s_mov_b64 exec, s[86:87]
    ds_read_b128 v[40:43], v21 offset:640
    s_mov_b64 exec, -1
    s_waitcnt lgkmcnt(7)
    v_mfma_f32_32x32x16_bf16 v[96:111], v[52:55], v[220:223], v[96:111]
    ds_read_b64_tr_b16 v[44:45], v12 offset:8192
    ds_read_b64_tr_b16 v[46:47], v12 offset:9216
    s_waitcnt lgkmcnt(7)
    v_mfma_f32_32x32x16_bf16 v[112:127], v[56:59], v[220:223], v[112:127]
    ds_read_b64_tr_b16 v[48:49], v15 offset:8192
    ds_read_b64_tr_b16 v[50:51], v15 offset:9216
    s_waitcnt lgkmcnt(7)
    v_mfma_f32_32x32x16_bf16 v[128:143], v[60:63], v[220:223], v[128:143]
    ds_read_b64_tr_b16 v[52:53], v18 offset:8192
    ds_read_b64_tr_b16 v[54:55], v18 offset:9216
    s_waitcnt lgkmcnt(6)
    v_mfma_f32_32x32x16_bf16 v[80:95], v[40:43], v[224:227], v[80:95]
    ds_read_b64_tr_b16 v[56:57], v5 offset:12288
    ds_read_b64_tr_b16 v[58:59], v5 offset:13312
    s_mov_b64 exec, s[86:87]
    ds_read_b128 v[56:59], v21 offset:672
    s_mov_b64 exec, -1
    s_waitcnt lgkmcnt(7)
    v_mfma_f32_32x32x16_bf16 v[96:111], v[44:47], v[224:227], v[96:111]
    ds_read_b64_tr_b16 v[60:61], v12 offset:12288
    ds_read_b64_tr_b16 v[62:63], v12 offset:13312
    s_waitcnt lgkmcnt(7)
    v_mfma_f32_32x32x16_bf16 v[112:127], v[48:51], v[224:227], v[112:127]
    ds_read_b64_tr_b16 v[40:41], v15 offset:12288
    ds_read_b64_tr_b16 v[42:43], v15 offset:13312
    s_waitcnt lgkmcnt(7)
    v_mfma_f32_32x32x16_bf16 v[128:143], v[52:55], v[224:227], v[128:143]
    ds_read_b64_tr_b16 v[44:45], v18 offset:12288
    ds_read_b64_tr_b16 v[46:47], v18 offset:13312
    s_waitcnt lgkmcnt(6)
    v_mfma_f32_32x32x16_bf16 v[80:95], v[56:59], v[228:231], v[80:95]
    ds_read_b64_tr_b16 v[48:49], v5 offset:16384
    ds_read_b64_tr_b16 v[50:51], v5 offset:17408
    s_mov_b64 exec, s[86:87]
    ds_read_b128 v[48:51], v21 offset:704
    s_mov_b64 exec, -1
    s_waitcnt lgkmcnt(7)
    v_mfma_f32_32x32x16_bf16 v[96:111], v[60:63], v[228:231], v[96:111]
    ds_read_b64_tr_b16 v[52:53], v12 offset:16384
    ds_read_b64_tr_b16 v[54:55], v12 offset:17408
    s_waitcnt lgkmcnt(7)
    v_mfma_f32_32x32x16_bf16 v[112:127], v[40:43], v[228:231], v[112:127]
    ds_read_b64_tr_b16 v[56:57], v15 offset:16384
    ds_read_b64_tr_b16 v[58:59], v15 offset:17408
    s_waitcnt lgkmcnt(7)
    v_mfma_f32_32x32x16_bf16 v[128:143], v[44:47], v[228:231], v[128:143]
    ds_read_b64_tr_b16 v[60:61], v18 offset:16384
    ds_read_b64_tr_b16 v[62:63], v18 offset:17408
    s_waitcnt lgkmcnt(6)
    v_mfma_f32_32x32x16_bf16 v[80:95], v[48:51], v[232:235], v[80:95]
    ds_read_b64_tr_b16 v[40:41], v5 offset:20480
    ds_read_b64_tr_b16 v[42:43], v5 offset:21504
    s_mov_b64 exec, s[86:87]
    ds_read_b128 v[40:43], v21 offset:736
    s_mov_b64 exec, -1
    s_waitcnt lgkmcnt(7)
    v_mfma_f32_32x32x16_bf16 v[96:111], v[52:55], v[232:235], v[96:111]
    ds_read_b64_tr_b16 v[44:45], v12 offset:20480
    ds_read_b64_tr_b16 v[46:47], v12 offset:21504
    s_waitcnt lgkmcnt(7)
    v_mfma_f32_32x32x16_bf16 v[112:127], v[56:59], v[232:235], v[112:127]
    ds_read_b64_tr_b16 v[48:49], v15 offset:20480
    ds_read_b64_tr_b16 v[50:51], v15 offset:21504
    s_waitcnt lgkmcnt(7)
    v_mfma_f32_32x32x16_bf16 v[128:143], v[60:63], v[232:235], v[128:143]
    ds_read_b64_tr_b16 v[52:53], v18 offset:20480
    ds_read_b64_tr_b16 v[54:55], v18 offset:21504
    s_waitcnt lgkmcnt(6)
    v_mfma_f32_32x32x16_bf16 v[80:95], v[40:43], v[236:239], v[80:95]
    s_barrier
    ds_read_b64_tr_b16 v[56:57], v5 offset:24576
    ds_read_b64_tr_b16 v[58:59], v5 offset:25600
    s_mov_b64 exec, s[86:87]
    ds_read_b128 v[56:59], v21 offset:768
    s_mov_b64 exec, -1
    s_waitcnt lgkmcnt(7)
    v_mfma_f32_32x32x16_bf16 v[96:111], v[44:47], v[236:239], v[96:111]
    ds_read_b64_tr_b16 v[60:61], v12 offset:24576
    ds_read_b64_tr_b16 v[62:63], v12 offset:25600
    s_waitcnt lgkmcnt(7)
    v_mfma_f32_32x32x16_bf16 v[112:127], v[48:51], v[236:239], v[112:127]
    ds_read_b64_tr_b16 v[40:41], v15 offset:24576
    ds_read_b64_tr_b16 v[42:43], v15 offset:25600
    s_waitcnt lgkmcnt(7)
    v_mfma_f32_32x32x16_bf16 v[128:143], v[52:55], v[236:239], v[128:143]
    ds_read_b64_tr_b16 v[44:45], v18 offset:24576
    ds_read_b64_tr_b16 v[46:47], v18 offset:25600
    s_waitcnt lgkmcnt(6)
    v_mfma_f32_32x32x16_bf16 v[80:95], v[56:59], v[240:243], v[80:95]
    ds_read_b64_tr_b16 v[48:49], v5 offset:28672
    ds_read_b64_tr_b16 v[50:51], v5 offset:29696
    s_mov_b64 exec, s[86:87]
    ds_read_b128 v[48:51], v21 offset:800
    s_mov_b64 exec, -1
    s_waitcnt lgkmcnt(7)
    v_mfma_f32_32x32x16_bf16 v[96:111], v[60:63], v[240:243], v[96:111]
    ds_read_b64_tr_b16 v[52:53], v12 offset:28672
    ds_read_b64_tr_b16 v[54:55], v12 offset:29696
    s_waitcnt lgkmcnt(7)
    v_mfma_f32_32x32x16_bf16 v[112:127], v[40:43], v[240:243], v[112:127]
    ds_read_b64_tr_b16 v[56:57], v15 offset:28672
    ds_read_b64_tr_b16 v[58:59], v15 offset:29696
    s_waitcnt lgkmcnt(7)
    v_mfma_f32_32x32x16_bf16 v[128:143], v[44:47], v[240:243], v[128:143]
    ds_read_b64_tr_b16 v[60:61], v18 offset:28672
    ds_read_b64_tr_b16 v[62:63], v18 offset:29696
    s_waitcnt lgkmcnt(6)
    v_mfma_f32_32x32x16_bf16 v[80:95], v[48:51], v[244:247], v[80:95]
    ds_read_b64_tr_b16 v[40:41], v5 offset:32768
    ds_read_b64_tr_b16 v[42:43], v5 offset:33792
    s_mov_b64 exec, s[86:87]
    ds_read_b128 v[40:43], v21 offset:832
    s_mov_b64 exec, -1
    s_waitcnt lgkmcnt(7)
    v_mfma_f32_32x32x16_bf16 v[96:111], v[52:55], v[244:247], v[96:111]
    ds_read_b64_tr_b16 v[44:45], v12 offset:32768
    ds_read_b64_tr_b16 v[46:47], v12 offset:33792
    s_waitcnt lgkmcnt(7)
    v_mfma_f32_32x32x16_bf16 v[112:127], v[56:59], v[244:247], v[112:127]
    ds_read_b64_tr_b16 v[48:49], v15 offset:32768
    ds_read_b64_tr_b16 v[50:51], v15 offset:33792
    s_waitcnt lgkmcnt(7)
    v_mfma_f32_32x32x16_bf16 v[128:143], v[60:63], v[244:247], v[128:143]
    ds_read_b64_tr_b16 v[52:53], v18 offset:32768
    ds_read_b64_tr_b16 v[54:55], v18 offset:33792
    s_waitcnt lgkmcnt(6)
    v_mfma_f32_32x32x16_bf16 v[80:95], v[40:43], v[248:251], v[80:95]
    ds_read_b64_tr_b16 v[56:57], v5 offset:36864
    ds_read_b64_tr_b16 v[58:59], v5 offset:37888
    s_mov_b64 exec, s[86:87]
    ds_read_b128 v[56:59], v21 offset:864
    s_mov_b64 exec, -1
    s_waitcnt lgkmcnt(7)
    v_mfma_f32_32x32x16_bf16 v[96:111], v[44:47], v[248:251], v[96:111]
    ds_read_b64_tr_b16 v[60:61], v12 offset:36864
    ds_read_b64_tr_b16 v[62:63], v12 offset:37888
    s_waitcnt lgkmcnt(7)
    v_mfma_f32_32x32x16_bf16 v[112:127], v[48:51], v[248:251], v[112:127]
    ds_read_b64_tr_b16 v[40:41], v15 offset:36864
    ds_read_b64_tr_b16 v[42:43], v15 offset:37888
    s_waitcnt lgkmcnt(7)
    v_mfma_f32_32x32x16_bf16 v[128:143], v[52:55], v[248:251], v[128:143]
    ds_read_b64_tr_b16 v[44:45], v18 offset:36864
    ds_read_b64_tr_b16 v[46:47], v18 offset:37888
    s_waitcnt lgkmcnt(6)
    v_mfma_f32_32x32x16_bf16 v[80:95], v[56:59], v[252:255], v[80:95]
    s_barrier
    s_waitcnt lgkmcnt(4)
    v_mfma_f32_32x32x16_bf16 v[96:111], v[60:63], v[252:255], v[96:111]
    s_waitcnt lgkmcnt(2)
    v_mfma_f32_32x32x16_bf16 v[112:127], v[40:43], v[252:255], v[112:127]
    s_waitcnt lgkmcnt(0)
    v_mfma_f32_32x32x16_bf16 v[128:143], v[44:47], v[252:255], v[128:143]
    s_setprio 1
    s_waitcnt vmcnt(0)
    s_mov_b32 s83, 0
L_QB_spin1:
    v_cmp_eq_u32 vcc, 0, v36
    s_nop 0
    s_and_b64 vcc, vcc, 1
    s_cbranch_vccz L_QB_ok2
    buffer_load_dword v36, v34, s[32:35], 0 offen sc1
    s_add_u32 s83, s83, 1
    s_cmp_lt_u32 s83, 1000000
    s_waitcnt vmcnt(0)
    s_cbranch_scc1 L_QB_spin1
L_QB_ok2:
    v_readfirstlane_b32 s81, v36
    s_nop 1
    v_mov_b32 v34, s81
    v_mul_f32 v37, 0xbfb8aa3b, v92
    v_add_u32 v1, 192, v1
    v_subrev_u32 v8, 43008, v1
    v_exp_f32 v37, v37
    s_nop 0
    v_add_f32 v37, 1.0, v37
    v_rcp_f32 v37, v37
    s_nop 0
    v_mov_b32 v32, v37
    s_nop 1
    v_permlane32_swap_b32 v37, v32
    ds_read_b64_tr_b16 v[20:21], v39 offset:0
    ds_read_b64_tr_b16 v[22:23], v39 offset:448
    ds_read_b64_tr_b16 v[24:25], v39 offset:896
    ds_read_b64_tr_b16 v[26:27], v39 offset:1344
    v_cvt_pk_bf16_f32 v18, v92, v93
    v_cvt_pk_bf16_f32 v19, v94, v95
    v_cvt_pk_bf16_f32 v12, v80, v81
    v_cvt_pk_bf16_f32 v13, v82, v83
    v_cvt_pk_bf16_f32 v14, v84, v85
    v_cvt_pk_bf16_f32 v15, v86, v87
    s_add_u32 m0, s73, 16384
    v_cvt_pk_bf16_f32 v16, v88, v89
    buffer_load_dwordx4 v1, s[16:19], s99 offen lds
    v_cvt_pk_bf16_f32 v17, v90, v91
    v_cndmask_b32 v18, v18, 0, s[84:85]
    v_cndmask_b32 v19, v19, 0, s[84:85]
    s_waitcnt lgkmcnt(0)
    v_mfma_f32_32x32x16_bf16 v[80:95], v[20:23], v[12:15], 0
    v_mfma_f32_32x32x16_bf16 v[80:95], v[24:27], v[16:19], v[80:95]
    s_add_u32 m0, s73, 12288
    s_nop 0
    buffer_load_dwordx4 v8, s[16:19], s99 offen lds
    s_nop 8
    v_cndmask_b32 v92, v92, v94, s[84:85]
    v_cndmask_b32 v93, v93, v95, s[84:85]
    v_max3_f32 v28, v80, v81, v82
    v_min3_f32 v29, v80, v81, v82
    v_max3_f32 v30, v83, v84, v85
    s_add_u32 m0, s73, 24576
    v_min3_f32 v31, v83, v84, v85
    buffer_load_dwordx4 v1, s[8:11], s99 offen lds
    v_max3_f32 v28, v28, v86, v87
    v_min3_f32 v29, v29, v86, v87
    v_max3_f32 v30, v30, v88, v89
    v_min3_f32 v31, v31, v88, v89
    v_max3_f32 v28, v28, v90, v91
    v_min3_f32 v29, v29, v90, v91
    v_max3_f32 v30, v30, v92, v93
    v_min3_f32 v31, v31, v92, v93
    v_max_f32 v28, v28, v30
    v_min_f32 v29, v29, v31
    v_mul_f32 v28, s82, v28
    s_add_u32 m0, s73, 20480
    v_mul_f32 v29, 0xbfb8aa3b, v29
    buffer_load_dwordx4 v8, s[8:11], s99 offen lds
    s_nop 0
    v_permlane32_swap_b32 v28, v29
    v_max_f32 v28, v28, v29
    v_mov_b32 v29, v28
    s_nop 1
    v_permlane32_swap_b32 v28, v29
    v_fma_f32 v12, v80, s82, -v28
    v_fma_f32 v13, v81, s82, -v28
    v_fma_f32 v80, -v80, s82, -v29
    v_fma_f32 v81, -v81, s82, -v29
    v_exp_f32 v12, v12
    s_add_u32 m0, s73, 90112
    v_fma_f32 v14, v82, s82, -v28
    buffer_load_dwordx4 v1, s[16:19], s100 offen lds
    v_exp_f32 v13, v13
    v_fma_f32 v15, v83, s82, -v28
    v_exp_f32 v80, v80
    v_fma_f32 v82, -v82, s82, -v29
    v_exp_f32 v81, v81
    v_fma_f32 v83, -v83, s82, -v29
    v_exp_f32 v14, v14
    s_add_u32 m0, s73, 86016
    v_fma_f32 v16, v84, s82, -v28
    buffer_load_dwordx4 v8, s[16:19], s100 offen lds
    v_fma_f32 v17, v85, s82, -v28
    v_exp_f32 v15, v15
    v_fma_f32 v84, -v84, s82, -v29
    v_fma_f32 v85, -v85, s82, -v29
    v_exp_f32 v82, v82
    v_cvt_pk_bf16_f32 v80, v80, v81
    v_exp_f32 v83, v83
    v_exp_f32 v16, v16
    s_add_u32 m0, s73, 114688
    v_fma_f32 v18, v86, s82, -v28
    buffer_load_dwordx4 v1, s[8:11], s100 offen lds
    v_fma_f32 v19, v87, s82, -v28
    v_exp_f32 v17, v17
    v_fma_f32 v86, -v86, s82, -v29
    v_fma_f32 v87, -v87, s82, -v29
    v_exp_f32 v84, v84
    v_cvt_pk_bf16_f32 v81, v82, v83
    v_exp_f32 v85, v85
    v_exp_f32 v18, v18
    s_add_u32 m0, s73, 110592
    v_fma_f32 v20, v88, s82, -v28
    buffer_load_dwordx4 v8, s[8:11], s100 offen lds
    v_fma_f32 v21, v89, s82, -v28
    v_exp_f32 v19, v19
    v_fma_f32 v88, -v88, s82, -v29
    v_fma_f32 v89, -v89, s82, -v29
    v_exp_f32 v86, v86
    v_cvt_pk_bf16_f32 v82, v84, v85
    s_barrier
    s_mov_b32 s58, -1
    v_and_b32 v35, 0xf0, v0
    v_bfe_u32 v36, v0, 8, 1
    v_lshl_add_u32 v35, v35, 3, s47
    v_lshl_add_u32 v35, v36, 13, v35
    v_mov_b32 v36, 2147418112
    v_cndmask_b32 v35, v36, v35, s[58:59]
    buffer_load_dword v36, v35, s[28:31], 0 offen sc1
    v_exp_f32 v87, v87
    v_exp_f32 v20, v20
    s_add_u32 m0, s73, 0
    v_fma_f32 v22, v90, s82, -v28
    buffer_load_dwordx4 v1, s[16:19], s101 offen lds
    v_fma_f32 v23, v91, s82, -v28
    v_exp_f32 v21, v21
    v_fma_f32 v90, -v90, s82, -v29
    v_fma_f32 v91, -v91, s82, -v29
    v_exp_f32 v88, v88
    v_cvt_pk_bf16_f32 v83, v86, v87
    v_exp_f32 v89, v89
    s_sub_u32 m0, s73, 4096
    v_exp_f32 v22, v22
    buffer_load_dwordx4 v8, s[16:19], s101 offen lds
    v_fma_f32 v24, v92, s82, -v28
    v_fma_f32 v25, v93, s82, -v28
    v_exp_f32 v23, v23
    v_fma_f32 v92, -v92, s82, -v29
    v_fma_f32 v93, -v93, s82, -v29
    v_exp_f32 v90, v90
    v_cvt_pk_bf16_f32 v84, v88, v89
    v_exp_f32 v91, v91
    s_add_u32 m0, s73, 32768
    v_exp_f32 v24, v24
    buffer_load_dwordx4 v1, s[8:11], s101 offen lds
    v_cvt_pk_bf16_f32 v85, v90, v91
    v_exp_f32 v25, v25
    v_exp_f32 v92, v92
    v_exp_f32 v93, v93
    v_cvt_pk_bf16_f32 v88, v12, v13
    v_cvt_pk_bf16_f32 v89, v14, v15
    v_cvt_pk_bf16_f32 v90, v16, v17
    s_add_u32 m0, s73, 28672
    v_cvt_pk_bf16_f32 v91, v18, v19
    buffer_load_dwordx4 v8, s[8:11], s101 offen lds
    v_cvt_pk_bf16_f32 v86, v92, v93
    v_cvt_pk_bf16_f32 v92, v20, v21
    v_cvt_pk_bf16_f32 v93, v22, v23
    v_cvt_pk_bf16_f32 v94, v24, v25
    v_mov_b32 v87, 0
    v_mov_b32 v95, 0
    ds_read_b64_tr_b16 v[20:21], v39 offset:1568
    ds_read_b64_tr_b16 v[22:23], v39 offset:2016
    ds_read_b64_tr_b16 v[24:25], v39 offset:2464
    ds_read_b64_tr_b16 v[26:27], v39 offset:2912
    v_cvt_pk_bf16_f32 v18, v108, v109
    v_cvt_pk_bf16_f32 v19, v110, v111
    v_cvt_pk_bf16_f32 v12, v96, v97
    v_cvt_pk_bf16_f32 v13, v98, v99
    v_cvt_pk_bf16_f32 v14, v100, v101
    v_cvt_pk_bf16_f32 v15, v102, v103
    v_cvt_pk_bf16_f32 v16, v104, v105
    v_cvt_pk_bf16_f32 v17, v106, v107
    v_cndmask_b32 v18, v18, 0, s[84:85]
    v_cndmask_b32 v19, v19, 0, s[84:85]
    s_waitcnt lgkmcnt(0)
    v_mfma_f32_32x32x16_bf16 v[96:111], v[20:23], v[12:15], 0
    v_mfma_f32_32x32x16_bf16 v[96:111], v[24:27], v[16:19], v[96:111]
    s_nop 11
    v_cndmask_b32 v108, v108, v110, s[84:85]
    v_cndmask_b32 v109, v109, v111, s[84:85]
    v_max3_f32 v28, v96, v97, v98
    v_min3_f32 v29, v96, v97, v98
    v_max3_f32 v30, v99, v100, v101
    v_min3_f32 v31, v99, v100, v101
    v_max3_f32 v28, v28, v102, v103
    v_min3_f32 v29, v29, v102, v103
    v_max3_f32 v30, v30, v104, v105
    v_min3_f32 v31, v31, v104, v105
    v_max3_f32 v28, v28, v106, v107
    v_min3_f32 v29, v29, v106, v107
    v_max3_f32 v30, v30, v108, v109
    v_min3_f32 v31, v31, v108, v109
    v_max_f32 v28, v28, v30
    v_min_f32 v29, v29, v31
    v_mul_f32 v28, s82, v28
    v_mul_f32 v29, 0xbfb8aa3b, v29
    s_nop 1
    v_permlane32_swap_b32 v28, v29
    v_max_f32 v28, v28, v29
    v_mov_b32 v29, v28
    s_nop 1
    v_permlane32_swap_b32 v28, v29
    v_fma_f32 v12, v96, s82, -v28
    v_fma_f32 v13, v97, s82, -v28
    s_waitcnt vmcnt(0)
    s_barrier
    s_mov_b32 s83, 0
L_QB_spin3:
    v_cmp_ne_u32 vcc, v34, v36
    s_nop 0
    s_and_b64 vcc, vcc, s[58:59]
    s_cbranch_vccz L_QB_ok4
    buffer_load_dword v36, v35, s[28:31], 0 offen sc1
    s_add_u32 s83, s83, 1
    s_cmp_lt_u32 s83, 1000000
    s_waitcnt vmcnt(0)
    s_cbranch_scc1 L_QB_spin3
L_QB_ok4:
    v_and_b32 v37, 0xf0, v0
    v_lshrrev_b32 v38, 8, v0
    v_lshl_add_u32 v37, v38, 12, v37
    v_fma_f32 v96, -v96, s82, -v29
    buffer_load_dwordx4 v[144:147], v37, s[28:31], s41 offen sc1
    s_add_u32 s41, s41, 16384
    v_fma_f32 v97, -v97, s82, -v29
    buffer_load_dwordx4 v[148:151], v37, s[28:31], s41 offen sc1
    s_add_u32 s41, s41, 16384
    v_exp_f32 v12, v12
    buffer_load_dwordx4 v[152:155], v37, s[28:31], s41 offen sc1
    s_add_u32 s41, s41, 16384
    v_fma_f32 v14, v98, s82, -v28
    buffer_load_dwordx4 v[156:159], v37, s[28:31], s41 offen sc1
    s_add_u32 s41, s41, 16384
    v_exp_f32 v13, v13
    buffer_load_dwordx4 v[160:163], v37, s[28:31], s41 offen sc1
    s_add_u32 s41, s41, 16384
    v_fma_f32 v15, v99, s82, -v28
    buffer_load_dwordx4 v[164:167], v37, s[28:31], s41 offen sc1
    s_add_u32 s41, s41, 16384
    v_exp_f32 v96, v96
    buffer_load_dwordx4 v[168:171], v37, s[28:31], s41 offen sc1
    s_add_u32 s41, s41, 16384
    v_fma_f32 v98, -v98, s82, -v29
    buffer_load_dwordx4 v[172:175], v37, s[28:31], s41 offen sc1
    s_add_u32 s41, s41, 16384
    v_exp_f32 v97, v97
    v_fma_f32 v99, -v99, s82, -v29
    v_exp_f32 v14, v14
    v_fma_f32 v16, v100, s82, -v28
    v_fma_f32 v17, v101, s82, -v28
    v_exp_f32 v15, v15
    v_fma_f32 v100, -v100, s82, -v29
    v_fma_f32 v101, -v101, s82, -v29
    v_exp_f32 v98, v98
    v_cvt_pk_bf16_f32 v96, v96, v97
    v_exp_f32 v99, v99
    v_exp_f32 v16, v16
    v_fma_f32 v18, v102, s82, -v28
    v_fma_f32 v19, v103, s82, -v28
    v_exp_f32 v17, v17
    v_fma_f32 v102, -v102, s82, -v29
    v_fma_f32 v103, -v103, s82, -v29
    v_exp_f32 v100, v100
    v_cvt_pk_bf16_f32 v97, v98, v99
    v_exp_f32 v101, v101
    v_exp_f32 v18, v18
    v_fma_f32 v20, v104, s82, -v28
    v_fma_f32 v21, v105, s82, -v28
    v_exp_f32 v19, v19
    v_fma_f32 v104, -v104, s82, -v29
    v_fma_f32 v105, -v105, s82, -v29
    v_exp_f32 v102, v102
    v_cvt_pk_bf16_f32 v98, v100, v101
    v_exp_f32 v103, v103
    v_exp_f32 v20, v20
    v_fma_f32 v22, v106, s82, -v28
    v_fma_f32 v23, v107, s82, -v28
    v_exp_f32 v21, v21
    v_fma_f32 v106, -v106, s82, -v29
    v_fma_f32 v107, -v107, s82, -v29
    v_exp_f32 v104, v104
    v_cvt_pk_bf16_f32 v99, v102, v103
    v_exp_f32 v105, v105
    v_exp_f32 v22, v22
    v_fma_f32 v24, v108, s82, -v28
    v_fma_f32 v25, v109, s82, -v28
    v_exp_f32 v23, v23
    v_fma_f32 v108, -v108, s82, -v29
    v_fma_f32 v109, -v109, s82, -v29
    v_exp_f32 v106, v106
    v_cvt_pk_bf16_f32 v100, v104, v105
    v_exp_f32 v107, v107
    v_exp_f32 v24, v24
    v_cvt_pk_bf16_f32 v101, v106, v107
    v_exp_f32 v25, v25
    v_exp_f32 v108, v108
    v_exp_f32 v109, v109
    v_cvt_pk_bf16_f32 v104, v12, v13
    v_cvt_pk_bf16_f32 v105, v14, v15
    v_and_b32 v37, 0xf0, v0
    v_lshl_add_u32 v37, v38, 2, v37
    v_mov_b32 v208, 0x3f803f80
    s_bitcmp1_b32 s75, 0
    s_cselect_b32 s86, 0x20002000, 0
    s_mov_b32 s87, s86
    v_mov_b32 v210, 0x3f80
    v_mov_b32 v211, 0
    v_and_b32 v38, 48, v0
    v_lshlrev_b64 v[210:211], v38, v[210:211]
    s_waitcnt vmcnt(3)
    s_nop 0
    v_mfma_f32_4x4x4_16b_bf16 v[176:179], v[210:211], v[144:145], 0
    v_mfma_f32_4x4x4_16b_bf16 v[180:183], v[210:211], v[146:147], 0
    v_mfma_f32_4x4x4_16b_bf16 v[184:187], v[210:211], v[160:161], 0
    v_mfma_f32_4x4x4_16b_bf16 v[188:191], v[210:211], v[162:163], 0
    s_waitcnt vmcnt(2)
    v_mfma_f32_4x4x4_16b_bf16 v[176:179], v[210:211], v[148:149], v[176:179]
    v_mfma_f32_4x4x4_16b_bf16 v[180:183], v[210:211], v[150:151], v[180:183]
    v_mfma_f32_4x4x4_16b_bf16 v[184:187], v[210:211], v[164:165], v[184:187]
    v_mfma_f32_4x4x4_16b_bf16 v[188:191], v[210:211], v[166:167], v[188:191]
    s_waitcnt vmcnt(1)
    v_mfma_f32_4x4x4_16b_bf16 v[176:179], v[210:211], v[152:153], v[176:179]
    v_mfma_f32_4x4x4_16b_bf16 v[180:183], v[210:211], v[154:155], v[180:183]
    v_mfma_f32_4x4x4_16b_bf16 v[184:187], v[210:211], v[168:169], v[184:187]
    v_mfma_f32_4x4x4_16b_bf16 v[188:191], v[210:211], v[170:171], v[188:191]
    s_waitcnt vmcnt(0)
    v_mfma_f32_4x4x4_16b_bf16 v[176:179], v[210:211], v[156:157], v[176:179]
    v_mfma_f32_4x4x4_16b_bf16 v[180:183], v[210:211], v[158:159], v[180:183]
    v_mfma_f32_4x4x4_16b_bf16 v[184:187], v[210:211], v[172:173], v[184:187]
    v_mfma_f32_4x4x4_16b_bf16 v[188:191], v[210:211], v[174:175], v[188:191]
    s_nop 5
    v_permlane32_swap_b32 v176, v180
    v_permlane32_swap_b32 v177, v181
    v_permlane32_swap_b32 v178, v182
    v_permlane32_swap_b32 v179, v183
    v_add_f32 v176, v176, v180
    v_add_f32 v177, v177, v181
    v_add_f32 v178, v178, v182
    v_add_f32 v179, v179, v183
    s_nop 0
    v_permlane16_swap_b32 v176, v178
    v_permlane16_swap_b32 v177, v179
    v_add_f32 v176, v176, v178
    v_add_f32 v177, v177, v179
    v_cvt_pk_bf16_f32 v176, v176, v177
    v_cndmask_b32 v176, v176, v208, s[86:87]
    buffer_store_dword v176, v37, s[28:31], s50 offen sc1
    v_permlane32_swap_b32 v184, v188
    v_permlane32_swap_b32 v185, v189
    v_permlane32_swap_b32 v186, v190
    v_permlane32_swap_b32 v187, v191
    v_add_f32 v184, v184, v188
    v_add_f32 v185, v185, v189
    v_add_f32 v186, v186, v190
    v_add_f32 v187, v187, v191
    s_nop 0
    v_permlane16_swap_b32 v184, v186
    v_permlane16_swap_b32 v185, v187
    v_add_f32 v184, v184, v186
    v_add_f32 v185, v185, v187
    v_cvt_pk_bf16_f32 v184, v184, v185
    v_cndmask_b32 v184, v184, v208, s[86:87]
    s_add_u32 s50, s50, 4096
    buffer_store_dword v184, v37, s[28:31], s50 offen sc1
    v_cvt_pk_bf16_f32 v106, v16, v17
    v_cvt_pk_bf16_f32 v107, v18, v19
    v_cvt_pk_bf16_f32 v102, v108, v109
    v_cvt_pk_bf16_f32 v108, v20, v21
    v_cvt_pk_bf16_f32 v109, v22, v23
    v_cvt_pk_bf16_f32 v110, v24, v25
    v_mov_b32 v103, 0
    v_mov_b32 v111, 0
    ds_read_b64_tr_b16 v[20:21], v39 offset:3136
    ds_read_b64_tr_b16 v[22:23], v39 offset:3584
    ds_read_b64_tr_b16 v[24:25], v39 offset:4032
    ds_read_b64_tr_b16 v[26:27], v39 offset:4480
    v_cvt_pk_bf16_f32 v18, v124, v125
    v_cvt_pk_bf16_f32 v19, v126, v127
    v_cvt_pk_bf16_f32 v12, v112, v113
    v_cvt_pk_bf16_f32 v13, v114, v115
    v_cvt_pk_bf16_f32 v14, v116, v117
    v_cvt_pk_bf16_f32 v15, v118, v119
    v_cvt_pk_bf16_f32 v16, v120, v121
    v_cvt_pk_bf16_f32 v17, v122, v123
    v_cndmask_b32 v18, v18, 0, s[84:85]
    v_cndmask_b32 v19, v19, 0, s[84:85]
    s_waitcnt lgkmcnt(0)
    v_mfma_f32_32x32x16_bf16 v[112:127], v[20:23], v[12:15], 0
    v_mfma_f32_32x32x16_bf16 v[112:127], v[24:27], v[16:19], v[112:127]
    s_nop 11
    v_cndmask_b32 v124, v124, v126, s[84:85]
    v_cndmask_b32 v125, v125, v127, s[84:85]
    v_max3_f32 v28, v112, v113, v114
    v_min3_f32 v29, v112, v113, v114
    v_max3_f32 v30, v115, v116, v117
    v_min3_f32 v31, v115, v116, v117
    v_max3_f32 v28, v28, v118, v119
    v_min3_f32 v29, v29, v118, v119
    v_max3_f32 v30, v30, v120, v121
    v_min3_f32 v31, v31, v120, v121
    v_max3_f32 v28, v28, v122, v123
    v_min3_f32 v29, v29, v122, v123
    v_max3_f32 v30, v30, v124, v125
    v_min3_f32 v31, v31, v124, v125
    v_max_f32 v28, v28, v30
    v_min_f32 v29, v29, v31
    v_mul_f32 v28, s82, v28
    v_mul_f32 v29, 0xbfb8aa3b, v29
    s_nop 1
    v_permlane32_swap_b32 v28, v29
    v_max_f32 v28, v28, v29
    v_mov_b32 v29, v28
    s_nop 1
    v_permlane32_swap_b32 v28, v29
    v_fma_f32 v12, v112, s82, -v28
    v_fma_f32 v13, v113, s82, -v28
    v_fma_f32 v112, -v112, s82, -v29
    v_fma_f32 v113, -v113, s82, -v29
    v_exp_f32 v12, v12
    v_fma_f32 v14, v114, s82, -v28
    v_exp_f32 v13, v13
    v_fma_f32 v15, v115, s82, -v28
    v_exp_f32 v112, v112
    v_fma_f32 v114, -v114, s82, -v29
    v_exp_f32 v113, v113
    v_fma_f32 v115, -v115, s82, -v29
    v_exp_f32 v14, v14
    v_fma_f32 v16, v116, s82, -v28
    v_fma_f32 v17, v117, s82, -v28
    v_exp_f32 v15, v15
    v_fma_f32 v116, -v116, s82, -v29
    v_fma_f32 v117, -v117, s82, -v29
    v_exp_f32 v114, v114
    v_cvt_pk_bf16_f32 v112, v112, v113
    v_exp_f32 v115, v115
    v_exp_f32 v16, v16
    s_waitcnt vmcnt(0)
    buffer_store_dword v34, v33, s[28:31], s49 offen sc1
    v_fma_f32 v18, v118, s82, -v28
    v_fma_f32 v19, v119, s82, -v28
    v_exp_f32 v17, v17
    v_fma_f32 v118, -v118, s82, -v29
    v_fma_f32 v119, -v119, s82, -v29
    v_exp_f32 v116, v116
    v_cvt_pk_bf16_f32 v113, v114, v115
    v_exp_f32 v117, v117
    v_exp_f32 v18, v18
    v_fma_f32 v20, v120, s82, -v28
    v_fma_f32 v21, v121, s82, -v28
    v_exp_f32 v19, v19
    v_fma_f32 v120, -v120, s82, -v29
    v_fma_f32 v121, -v121, s82, -v29
    v_exp_f32 v118, v118
    v_cvt_pk_bf16_f32 v114, v116, v117
    v_exp_f32 v119, v119
    v_exp_f32 v20, v20
    v_fma_f32 v22, v122, s82, -v28
    v_fma_f32 v23, v123, s82, -v28
    v_exp_f32 v21, v21
    v_fma_f32 v122, -v122, s82, -v29
    v_fma_f32 v123, -v123, s82, -v29
    v_exp_f32 v120, v120
    v_cvt_pk_bf16_f32 v115, v118, v119
    v_exp_f32 v121, v121
    v_exp_f32 v22, v22
    v_fma_f32 v24, v124, s82, -v28
    v_fma_f32 v25, v125, s82, -v28
    v_exp_f32 v23, v23
    v_fma_f32 v124, -v124, s82, -v29
    v_fma_f32 v125, -v125, s82, -v29
    v_exp_f32 v122, v122
    v_cvt_pk_bf16_f32 v116, v120, v121
    v_exp_f32 v123, v123
    v_exp_f32 v24, v24
    v_cvt_pk_bf16_f32 v117, v122, v123
    v_exp_f32 v25, v25
    v_exp_f32 v124, v124
    v_exp_f32 v125, v125
    v_cvt_pk_bf16_f32 v120, v12, v13
    v_cvt_pk_bf16_f32 v121, v14, v15
    v_cvt_pk_bf16_f32 v122, v16, v17
    v_cvt_pk_bf16_f32 v123, v18, v19
    v_cvt_pk_bf16_f32 v118, v124, v125
    v_cvt_pk_bf16_f32 v124, v20, v21
    v_cvt_pk_bf16_f32 v125, v22, v23
    v_cvt_pk_bf16_f32 v126, v24, v25
    v_mov_b32 v119, 0
    v_mov_b32 v127, 0
    ds_read_b64_tr_b16 v[20:21], v39 offset:4704
    ds_read_b64_tr_b16 v[22:23], v39 offset:5152
    ds_read_b64_tr_b16 v[24:25], v39 offset:5600
    ds_read_b64_tr_b16 v[26:27], v39 offset:6048
    v_cvt_pk_bf16_f32 v18, v140, v141
    v_cvt_pk_bf16_f32 v19, v142, v143
    v_cvt_pk_bf16_f32 v12, v128, v129
    v_cvt_pk_bf16_f32 v13, v130, v131
    v_cvt_pk_bf16_f32 v14, v132, v133
    v_cvt_pk_bf16_f32 v15, v134, v135
    v_cvt_pk_bf16_f32 v16, v136, v137
    v_cvt_pk_bf16_f32 v17, v138, v139
    v_cndmask_b32 v18, v18, 0, s[84:85]
    v_cndmask_b32 v19, v19, 0, s[84:85]
    s_waitcnt lgkmcnt(0)
    v_mfma_f32_32x32x16_bf16 v[128:143], v[20:23], v[12:15], 0
    v_mfma_f32_32x32x16_bf16 v[128:143], v[24:27], v[16:19], v[128:143]
    s_nop 11
    v_cndmask_b32 v140, v140, v142, s[84:85]
    v_cndmask_b32 v141, v141, v143, s[84:85]
    v_max3_f32 v28, v128, v129, v130
    v_min3_f32 v29, v128, v129, v130
    v_max3_f32 v30, v131, v132, v133
    v_min3_f32 v31, v131, v132, v133
    v_max3_f32 v28, v28, v134, v135
    v_min3_f32 v29, v29, v134, v135
    v_max3_f32 v30, v30, v136, v137
    v_min3_f32 v31, v31, v136, v137
    v_max3_f32 v28, v28, v138, v139
    v_min3_f32 v29, v29, v138, v139
    v_max3_f32 v30, v30, v140, v141
    v_min3_f32 v31, v31, v140, v141
    v_max_f32 v28, v28, v30
    v_min_f32 v29, v29, v31
    v_mul_f32 v28, s82, v28
    v_mul_f32 v29, 0xbfb8aa3b, v29
    s_nop 1
    v_permlane32_swap_b32 v28, v29
    v_max_f32 v28, v28, v29
    v_mov_b32 v29, v28
    s_nop 1
    v_permlane32_swap_b32 v28, v29
    v_fma_f32 v12, v128, s82, -v28
    v_fma_f32 v13, v129, s82, -v28
    v_fma_f32 v128, -v128, s82, -v29
    v_fma_f32 v129, -v129, s82, -v29
    v_exp_f32 v12, v12
    v_fma_f32 v14, v130, s82, -v28
    v_exp_f32 v13, v13
    v_fma_f32 v15, v131, s82, -v28
    v_exp_f32 v128, v128
    v_fma_f32 v130, -v130, s82, -v29
    v_exp_f32 v129, v129
    v_fma_f32 v131, -v131, s82, -v29
    v_exp_f32 v14, v14
    v_fma_f32 v16, v132, s82, -v28
    v_fma_f32 v17, v133, s82, -v28
    v_exp_f32 v15, v15
    v_fma_f32 v132, -v132, s82, -v29
    v_fma_f32 v133, -v133, s82, -v29
    v_exp_f32 v130, v130
    v_cvt_pk_bf16_f32 v128, v128, v129
    v_exp_f32 v131, v131
    v_exp_f32 v16, v16
    s_mov_b32 s58, 65535
    v_lshl_add_u32 v35, v0, 3, s48
    v_mov_b32 v36, 2147418112
    v_cndmask_b32 v35, v36, v35, s[58:59]
    buffer_load_dword v36, v35, s[28:31], 0 offen sc1
    v_fma_f32 v18, v134, s82, -v28
    v_fma_f32 v19, v135, s82, -v28
    v_exp_f32 v17, v17
    v_fma_f32 v134, -v134, s82, -v29
    v_fma_f32 v135, -v135, s82, -v29
    v_exp_f32 v132, v132
    v_cvt_pk_bf16_f32 v129, v130, v131
    v_exp_f32 v133, v133
    v_exp_f32 v18, v18
    v_fma_f32 v20, v136, s82, -v28
    v_fma_f32 v21, v137, s82, -v28
    v_exp_f32 v19, v19
    v_fma_f32 v136, -v136, s82, -v29
    v_fma_f32 v137, -v137, s82, -v29
    v_exp_f32 v134, v134
    v_cvt_pk_bf16_f32 v130, v132, v133
    v_exp_f32 v135, v135
    v_exp_f32 v20, v20
    v_fma_f32 v22, v138, s82, -v28
    v_fma_f32 v23, v139, s82, -v28
    v_exp_f32 v21, v21
    v_fma_f32 v138, -v138, s82, -v29
    v_fma_f32 v139, -v139, s82, -v29
    v_exp_f32 v136, v136
    v_cvt_pk_bf16_f32 v131, v134, v135
    v_exp_f32 v137, v137
    v_exp_f32 v22, v22
    v_fma_f32 v24, v140, s82, -v28
    v_fma_f32 v25, v141, s82, -v28
    v_exp_f32 v23, v23
    v_fma_f32 v140, -v140, s82, -v29
    v_fma_f32 v141, -v141, s82, -v29
    v_exp_f32 v138, v138
    v_cvt_pk_bf16_f32 v132, v136, v137
    v_exp_f32 v139, v139
    v_exp_f32 v24, v24
    v_cvt_pk_bf16_f32 v133, v138, v139
    v_exp_f32 v25, v25
    v_exp_f32 v140, v140
    v_exp_f32 v141, v141
    v_cvt_pk_bf16_f32 v136, v12, v13
    v_cvt_pk_bf16_f32 v137, v14, v15
    v_cvt_pk_bf16_f32 v138, v16, v17
    v_cvt_pk_bf16_f32 v139, v18, v19
    v_cvt_pk_bf16_f32 v134, v140, v141
    v_cvt_pk_bf16_f32 v140, v20, v21
    v_cvt_pk_bf16_f32 v141, v22, v23
    v_cvt_pk_bf16_f32 v142, v24, v25
    v_mov_b32 v135, 0
    v_mov_b32 v143, 0
    s_waitcnt vmcnt(0)
    s_mov_b32 s83, 0
L_QB_spin5:
    v_cmp_ne_u32 vcc, v34, v36
    s_nop 0
    s_and_b64 vcc, vcc, s[58:59]
    s_cbranch_vccz L_QB_ok6
    buffer_load_dword v36, v35, s[28:31], 0 offen sc1
    s_add_u32 s83, s83, 1
    s_cmp_lt_u32 s83, 1000000
    s_waitcnt vmcnt(0)
    s_cbranch_scc1 L_QB_spin5
L_QB_ok6:
    s_mul_i32 s3, s76, 32768
    s_mul_i32 s80, s45, 8192
    s_add_u32 s3, s3, s80
    s_add_u32 s3, s3, 17825792
    buffer_load_dwordx4 v[144:147], v0, s[28:31], s3 offen offset:0 sc1
    buffer_load_dwordx4 v[148:151], v0, s[28:31], s3 offen offset:1024 sc1
    buffer_load_dwordx4 v[152:155], v0, s[28:31], s3 offen offset:2048 sc1
    buffer_load_dwordx4 v[156:159], v0, s[28:31], s3 offen offset:3072 sc1
    s_add_u32 s3, s3, 4096
    buffer_load_dwordx4 v[160:163], v0, s[28:31], s3 offen offset:0 sc1
    buffer_load_dwordx4 v[164:167], v0, s[28:31], s3 offen offset:1024 sc1
    buffer_load_dwordx4 v[168:171], v0, s[28:31], s3 offen offset:2048 sc1
    buffer_load_dwordx4 v[172:175], v0, s[28:31], s3 offen offset:3072 sc1
    s_lshl_b32 s80, s45, 3
    s_lshr_b32 s80, 117835009, s80
    s_and_b32 s80, s80, 0xff
    v_lshl_add_u32 v37, s80, 13, v0
    s_waitcnt vmcnt(7)
    ds_write_b128 v37, v[144:147] offset:0
    s_waitcnt vmcnt(6)
    ds_write_b128 v37, v[148:151] offset:1024
    s_waitcnt vmcnt(5)
    ds_write_b128 v37, v[152:155] offset:2048
    s_waitcnt vmcnt(4)
    ds_write_b128 v37, v[156:159] offset:3072
    s_waitcnt vmcnt(3)
    ds_write_b128 v37, v[160:163] offset:4096
    s_waitcnt vmcnt(2)
    ds_write_b128 v37, v[164:167] offset:5120
    s_waitcnt vmcnt(1)
    ds_write_b128 v37, v[168:171] offset:6144
    s_waitcnt vmcnt(0)
    ds_write_b128 v37, v[172:175] offset:7168
    s_waitcnt lgkmcnt(0)
    s_setprio 1
    s_barrier
    v_add_u32 v5, 8192, v0
    v_add_u32 v6, 40960, v0
    ds_read_b128 v[144:147], v5 offset:0
    ds_read_b128 v[148:151], v5 offset:1024
    ds_read_b128 v[152:155], v5 offset:2048
    ds_read_b128 v[156:159], v5 offset:3072
    ds_read_b128 v[160:163], v5 offset:4096
    ds_read_b128 v[164:167], v5 offset:5120
    ds_read_b128 v[168:171], v5 offset:6144
    ds_read_b128 v[172:175], v5 offset:7168
    ds_read_b128 v[176:179], v6 offset:0
    ds_read_b128 v[180:183], v6 offset:1024
    ds_read_b128 v[184:187], v6 offset:2048
    ds_read_b128 v[188:191], v6 offset:3072
    s_waitcnt lgkmcnt(11)
    v_mfma_f32_32x32x16_bf16 v[64:79], v[144:147], v[88:91], 0
    s_waitcnt lgkmcnt(9)
    v_mfma_f32_32x32x16_bf16 v[208:223], v[152:155], v[80:83], 0
    v_mfma_f32_32x32x16_bf16 v[64:79], v[148:151], v[92:95], v[64:79]
    s_waitcnt lgkmcnt(8)
    v_mfma_f32_32x32x16_bf16 v[208:223], v[156:159], v[84:87], v[208:223]
    ds_read_b128 v[192:195], v6 offset:4096
    ds_read_b128 v[196:199], v6 offset:5120
    ds_read_b128 v[200:203], v6 offset:6144
    ds_read_b128 v[204:207], v6 offset:7168
    s_waitcnt lgkmcnt(11)
    v_mfma_f32_32x32x16_bf16 v[224:239], v[160:163], v[104:107], 0
    s_waitcnt lgkmcnt(9)
    v_mfma_f32_32x32x16_bf16 v[240:255], v[168:171], v[96:99], 0
    v_mfma_f32_32x32x16_bf16 v[224:239], v[164:167], v[108:111], v[224:239]
    s_waitcnt lgkmcnt(8)
    v_mfma_f32_32x32x16_bf16 v[240:255], v[172:175], v[100:103], v[240:255]
    v_rcp_f32 v2, v77
    v_rcp_f32 v3, v221
    s_add_u32 s80, s40, 0
    v_fmaak_f32 v37, v76, v2, 0x358637bd
    v_fmac_f32 v37, v220, v3
    v_rcp_f32 v37, v37
    s_nop 0
    v_mul_f32 v37, v37, v32
    v_mul_f32 v2, v2, v37
    v_mul_f32 v3, v3, v37
    s_nop 1
    v_permlane32_swap_b32 v2, v3
    v_mov_b32 v2, v3
    s_nop 1
    v_permlane32_swap_b32 v2, v3
    v_pk_mul_f32 v[64:65], v[64:65], v[2:3] op_sel_hi:[1,0]
    v_pk_mul_f32 v[66:67], v[66:67], v[2:3] op_sel_hi:[1,0]
    v_pk_fma_f32 v[64:65], v[208:209], v[2:3], v[64:65] op_sel:[0,1,0] op_sel_hi:[1,1,1]
    v_pk_mul_f32 v[68:69], v[68:69], v[2:3] op_sel_hi:[1,0]
    v_pk_fma_f32 v[66:67], v[210:211], v[2:3], v[66:67] op_sel:[0,1,0] op_sel_hi:[1,1,1]
    v_cvt_pk_bf16_f32 v40, v64, v65
    v_pk_mul_f32 v[70:71], v[70:71], v[2:3] op_sel_hi:[1,0]
    v_pk_fma_f32 v[68:69], v[212:213], v[2:3], v[68:69] op_sel:[0,1,0] op_sel_hi:[1,1,1]
    v_cvt_pk_bf16_f32 v41, v66, v67
    v_pk_mul_f32 v[72:73], v[72:73], v[2:3] op_sel_hi:[1,0]
    v_pk_fma_f32 v[70:71], v[214:215], v[2:3], v[70:71] op_sel:[0,1,0] op_sel_hi:[1,1,1]
    v_cvt_pk_bf16_f32 v42, v68, v69
    v_pk_mul_f32 v[74:75], v[74:75], v[2:3] op_sel_hi:[1,0]
    v_pk_fma_f32 v[72:73], v[216:217], v[2:3], v[72:73] op_sel:[0,1,0] op_sel_hi:[1,1,1]
    v_cvt_pk_bf16_f32 v43, v70, v71
    buffer_store_dwordx4 v[40:43], v0, s[28:31], s80 offen sc1
    v_pk_mul_f32 v[76:77], v[76:77], v[2:3] op_sel_hi:[1,0]
    v_pk_fma_f32 v[74:75], v[218:219], v[2:3], v[74:75] op_sel:[0,1,0] op_sel_hi:[1,1,1]
    v_cvt_pk_bf16_f32 v44, v72, v73
    v_pk_mul_f32 v[78:79], v[78:79], v[2:3] op_sel_hi:[1,0]
    v_pk_fma_f32 v[76:77], v[220:221], v[2:3], v[76:77] op_sel:[0,1,0] op_sel_hi:[1,1,1]
    v_cvt_pk_bf16_f32 v45, v74, v75
    v_pk_fma_f32 v[78:79], v[222:223], v[2:3], v[78:79] op_sel:[0,1,0] op_sel_hi:[1,1,1]
    v_cvt_pk_bf16_f32 v46, v76, v77
    v_cvt_pk_bf16_f32 v47, v78, v79
    buffer_store_dwordx4 v[44:47], v0, s[28:31], s80 offen offset:1024 sc1
    s_waitcnt lgkmcnt(7)
    v_mfma_f32_32x32x16_bf16 v[64:79], v[176:179], v[120:123], 0
    s_waitcnt lgkmcnt(5)
    v_mfma_f32_32x32x16_bf16 v[208:223], v[184:187], v[112:115], 0
    v_mfma_f32_32x32x16_bf16 v[64:79], v[180:183], v[124:127], v[64:79]
    s_waitcnt lgkmcnt(4)
    v_mfma_f32_32x32x16_bf16 v[208:223], v[188:191], v[116:119], v[208:223]
    v_rcp_f32 v2, v237
    v_rcp_f32 v3, v253
    s_add_u32 s80, s40, 2048
    v_fmaak_f32 v37, v236, v2, 0x358637bd
    v_fmac_f32 v37, v252, v3
    v_rcp_f32 v37, v37
    s_nop 0
    v_mul_f32 v37, v37, v32
    v_mul_f32 v2, v2, v37
    v_mul_f32 v3, v3, v37
    s_nop 1
    v_permlane32_swap_b32 v2, v3
    v_mov_b32 v2, v3
    s_nop 1
    v_permlane32_swap_b32 v2, v3
    v_pk_mul_f32 v[224:225], v[224:225], v[2:3] op_sel_hi:[1,0]
    v_pk_mul_f32 v[226:227], v[226:227], v[2:3] op_sel_hi:[1,0]
    v_pk_fma_f32 v[224:225], v[240:241], v[2:3], v[224:225] op_sel:[0,1,0] op_sel_hi:[1,1,1]
    v_pk_mul_f32 v[228:229], v[228:229], v[2:3] op_sel_hi:[1,0]
    v_pk_fma_f32 v[226:227], v[242:243], v[2:3], v[226:227] op_sel:[0,1,0] op_sel_hi:[1,1,1]
    v_cvt_pk_bf16_f32 v48, v224, v225
    v_pk_mul_f32 v[230:231], v[230:231], v[2:3] op_sel_hi:[1,0]
    v_pk_fma_f32 v[228:229], v[244:245], v[2:3], v[228:229] op_sel:[0,1,0] op_sel_hi:[1,1,1]
    v_cvt_pk_bf16_f32 v49, v226, v227
    v_pk_mul_f32 v[232:233], v[232:233], v[2:3] op_sel_hi:[1,0]
    v_pk_fma_f32 v[230:231], v[246:247], v[2:3], v[230:231] op_sel:[0,1,0] op_sel_hi:[1,1,1]
    v_cvt_pk_bf16_f32 v50, v228, v229
    v_pk_mul_f32 v[234:235], v[234:235], v[2:3] op_sel_hi:[1,0]
    v_pk_fma_f32 v[232:233], v[248:249], v[2:3], v[232:233] op_sel:[0,1,0] op_sel_hi:[1,1,1]
    v_cvt_pk_bf16_f32 v51, v230, v231
    buffer_store_dwordx4 v[48:51], v0, s[28:31], s80 offen sc1
    v_pk_mul_f32 v[236:237], v[236:237], v[2:3] op_sel_hi:[1,0]
    v_pk_fma_f32 v[234:235], v[250:251], v[2:3], v[234:235] op_sel:[0,1,0] op_sel_hi:[1,1,1]
    v_cvt_pk_bf16_f32 v52, v232, v233
    v_pk_mul_f32 v[238:239], v[238:239], v[2:3] op_sel_hi:[1,0]
    v_pk_fma_f32 v[236:237], v[252:253], v[2:3], v[236:237] op_sel:[0,1,0] op_sel_hi:[1,1,1]
    v_cvt_pk_bf16_f32 v53, v234, v235
    v_pk_fma_f32 v[238:239], v[254:255], v[2:3], v[238:239] op_sel:[0,1,0] op_sel_hi:[1,1,1]
    v_cvt_pk_bf16_f32 v54, v236, v237
    v_cvt_pk_bf16_f32 v55, v238, v239
    buffer_store_dwordx4 v[52:55], v0, s[28:31], s80 offen offset:1024 sc1
    s_waitcnt lgkmcnt(3)
    v_mfma_f32_32x32x16_bf16 v[224:239], v[192:195], v[136:139], 0
    s_waitcnt lgkmcnt(1)
    v_mfma_f32_32x32x16_bf16 v[240:255], v[200:203], v[128:131], 0
    v_mfma_f32_32x32x16_bf16 v[224:239], v[196:199], v[140:143], v[224:239]
    s_waitcnt lgkmcnt(0)
    v_mfma_f32_32x32x16_bf16 v[240:255], v[204:207], v[132:135], v[240:255]
    v_rcp_f32 v2, v77
    v_rcp_f32 v3, v221
    s_add_u32 s80, s40, 50176
    v_fmaak_f32 v37, v76, v2, 0x358637bd
    v_fmac_f32 v37, v220, v3
    v_rcp_f32 v37, v37
    s_nop 0
    v_mul_f32 v37, v37, v32
    v_mul_f32 v2, v2, v37
    v_mul_f32 v3, v3, v37
    s_nop 1
    v_permlane32_swap_b32 v2, v3
    v_mov_b32 v2, v3
    s_nop 1
    v_permlane32_swap_b32 v2, v3
    v_pk_mul_f32 v[64:65], v[64:65], v[2:3] op_sel_hi:[1,0]
    v_pk_mul_f32 v[66:67], v[66:67], v[2:3] op_sel_hi:[1,0]
    v_pk_fma_f32 v[64:65], v[208:209], v[2:3], v[64:65] op_sel:[0,1,0] op_sel_hi:[1,1,1]
    v_pk_mul_f32 v[68:69], v[68:69], v[2:3] op_sel_hi:[1,0]
    v_pk_fma_f32 v[66:67], v[210:211], v[2:3], v[66:67] op_sel:[0,1,0] op_sel_hi:[1,1,1]
    v_cvt_pk_bf16_f32 v56, v64, v65
    v_pk_mul_f32 v[70:71], v[70:71], v[2:3] op_sel_hi:[1,0]
    v_pk_fma_f32 v[68:69], v[212:213], v[2:3], v[68:69] op_sel:[0,1,0] op_sel_hi:[1,1,1]
    v_cvt_pk_bf16_f32 v57, v66, v67
    v_pk_mul_f32 v[72:73], v[72:73], v[2:3] op_sel_hi:[1,0]
    v_pk_fma_f32 v[70:71], v[214:215], v[2:3], v[70:71] op_sel:[0,1,0] op_sel_hi:[1,1,1]
    v_cvt_pk_bf16_f32 v58, v68, v69
    v_pk_mul_f32 v[74:75], v[74:75], v[2:3] op_sel_hi:[1,0]
    v_pk_fma_f32 v[72:73], v[216:217], v[2:3], v[72:73] op_sel:[0,1,0] op_sel_hi:[1,1,1]
    v_cvt_pk_bf16_f32 v59, v70, v71
    buffer_store_dwordx4 v[56:59], v0, s[28:31], s80 offen sc1
    v_pk_mul_f32 v[76:77], v[76:77], v[2:3] op_sel_hi:[1,0]
    v_pk_fma_f32 v[74:75], v[218:219], v[2:3], v[74:75] op_sel:[0,1,0] op_sel_hi:[1,1,1]
    v_cvt_pk_bf16_f32 v60, v72, v73
    v_pk_mul_f32 v[78:79], v[78:79], v[2:3] op_sel_hi:[1,0]
    v_pk_fma_f32 v[76:77], v[220:221], v[2:3], v[76:77] op_sel:[0,1,0] op_sel_hi:[1,1,1]
    v_cvt_pk_bf16_f32 v61, v74, v75
    v_pk_fma_f32 v[78:79], v[222:223], v[2:3], v[78:79] op_sel:[0,1,0] op_sel_hi:[1,1,1]
    v_cvt_pk_bf16_f32 v62, v76, v77
    v_cvt_pk_bf16_f32 v63, v78, v79
    buffer_store_dwordx4 v[60:63], v0, s[28:31], s80 offen offset:1024 sc1
    v_rcp_f32 v2, v237
    v_rcp_f32 v3, v253
    s_add_u32 s80, s40, 52224
    v_fmaak_f32 v37, v236, v2, 0x358637bd
    v_fmac_f32 v37, v252, v3
    v_rcp_f32 v37, v37
    s_nop 0
    v_mul_f32 v37, v37, v32
    v_mul_f32 v2, v2, v37
    v_mul_f32 v3, v3, v37
    s_nop 1
    v_permlane32_swap_b32 v2, v3
    v_mov_b32 v2, v3
    s_nop 1
    v_permlane32_swap_b32 v2, v3
    v_pk_mul_f32 v[224:225], v[224:225], v[2:3] op_sel_hi:[1,0]
    v_pk_mul_f32 v[226:227], v[226:227], v[2:3] op_sel_hi:[1,0]
    v_pk_fma_f32 v[224:225], v[240:241], v[2:3], v[224:225] op_sel:[0,1,0] op_sel_hi:[1,1,1]
    v_pk_mul_f32 v[228:229], v[228:229], v[2:3] op_sel_hi:[1,0]
    v_pk_fma_f32 v[226:227], v[242:243], v[2:3], v[226:227] op_sel:[0,1,0] op_sel_hi:[1,1,1]
    v_cvt_pk_bf16_f32 v40, v224, v225
    v_pk_mul_f32 v[230:231], v[230:231], v[2:3] op_sel_hi:[1,0]
    v_pk_fma_f32 v[228:229], v[244:245], v[2:3], v[228:229] op_sel:[0,1,0] op_sel_hi:[1,1,1]
    v_cvt_pk_bf16_f32 v41, v226, v227
    v_pk_mul_f32 v[232:233], v[232:233], v[2:3] op_sel_hi:[1,0]
    v_pk_fma_f32 v[230:231], v[246:247], v[2:3], v[230:231] op_sel:[0,1,0] op_sel_hi:[1,1,1]
    v_cvt_pk_bf16_f32 v42, v228, v229
    v_pk_mul_f32 v[234:235], v[234:235], v[2:3] op_sel_hi:[1,0]
    v_pk_fma_f32 v[232:233], v[248:249], v[2:3], v[232:233] op_sel:[0,1,0] op_sel_hi:[1,1,1]
    v_cvt_pk_bf16_f32 v43, v230, v231
    buffer_store_dwordx4 v[40:43], v0, s[28:31], s80 offen sc1
    v_pk_mul_f32 v[236:237], v[236:237], v[2:3] op_sel_hi:[1,0]
    v_pk_fma_f32 v[234:235], v[250:251], v[2:3], v[234:235] op_sel:[0,1,0] op_sel_hi:[1,1,1]
    v_cvt_pk_bf16_f32 v44, v232, v233
    v_pk_mul_f32 v[238:239], v[238:239], v[2:3] op_sel_hi:[1,0]
    v_pk_fma_f32 v[236:237], v[252:253], v[2:3], v[236:237] op_sel:[0,1,0] op_sel_hi:[1,1,1]
    v_cvt_pk_bf16_f32 v45, v234, v235
    v_pk_fma_f32 v[238:239], v[254:255], v[2:3], v[238:239] op_sel:[0,1,0] op_sel_hi:[1,1,1]
    v_cvt_pk_bf16_f32 v46, v236, v237
    v_cvt_pk_bf16_f32 v47, v238, v239
    buffer_store_dwordx4 v[44:47], v0, s[28:31], s80 offen offset:1024 sc1
    s_waitcnt vmcnt(0)
    buffer_store_dword v34, v33, s[28:31], s46 offen sc1
    s_endpgm
L_exit:
    s_endpgm
    .fill 64, 4, 0xbf810000
L_code_end:
.section .rodata,"a"
.p2align 6
.amdhsa_kernel gated_mix__linear_kernel_hedgehog__glu_gated_swiglu__prompt_kernel
  .amdhsa_next_free_vgpr 256
  .amdhsa_next_free_sgpr 102
  .amdhsa_accum_offset 256
  .amdhsa_group_segment_fixed_size 0
  .amdhsa_kernarg_size 96
  .amdhsa_user_sgpr_count 2
  .amdhsa_user_sgpr_kernarg_segment_ptr 1
  .amdhsa_system_sgpr_workgroup_id_x 1
  .amdhsa_float_denorm_mode_32 3
.end_amdhsa_kernel
```
